```python
import torch

def _softmax(x, axis=-1):
    return torch.softmax(x, dim=axis)
def _gelu(x):
    return torch.nn.functional.gelu(x, approximate="tanh")
def _silu(x):
    return torch.nn.functional.silu(x)
def _sigmoid(x):
    return torch.sigmoid(x)
def _layernorm(x, axis=-1, eps=1e-5):
    m = x.mean(dim=axis, keepdim=True)
    v = x.var(dim=axis, keepdim=True, unbiased=False)
    return (x - m) / torch.sqrt(v + eps)
def _scatter_add(tgt, idx, src, axis=0):
    return tgt.clone().index_add_(axis, idx, src)
def _segment_sum(src, seg, n):
    out = torch.zeros((n,) + src.shape[1:], dtype=src.dtype)
    return out.index_add_(0, seg, src)
def _pad(x, pw):
    flat = tuple(v for pair in reversed(pw) for v in pair)
    return torch.nn.functional.pad(x, flat)

kernel_name = 'standalone__hybrid_graph_tf_graphgps__graph'

def setup_inputs():

    _w = (lambda a: (lambda t: t.to(torch.bfloat16) if t.is_floating_point() else t)(torch.as_tensor(a)))
    N, deg, D = 12500, 64, 64
    E = N * deg
    src = (lambda lo, hi, *s: torch.randint(lo, hi, s))(0, N, E).to(torch.int64)
    dst = (lambda lo, hi, *s: torch.randint(lo, hi, s))(0, N, E).to(torch.int64)
    deg_cnt = torch.bincount(dst, minlength=N).to(float) + 1.0
    sc = 1.0 / float(D) ** 0.5
    return {
        "x": _w((lambda *s: torch.randn(*s, dtype=torch.bfloat16) * 0.05)(N, D)),
        "src": _w(src),
        "dst": _w(dst),
        "deg_inv": _w((1.0 / deg_cnt).to(float)),
        "w_msg": _w((lambda *s: torch.randn(*s, dtype=torch.bfloat16) * 0.4)(D, D) * sc),
        "wq": _w((lambda *s: torch.randn(*s, dtype=torch.bfloat16) * 1.6)(D, D) * sc),
        "wk": _w((lambda *s: torch.randn(*s, dtype=torch.bfloat16) * 1.6)(D, D) * sc),
        "wv": _w((lambda *s: torch.randn(*s, dtype=torch.bfloat16) * 0.2)(D, D) * sc),
        "w_out": _w((lambda *s: torch.randn(*s, dtype=torch.bfloat16) * 0.2)(D, D) * sc),
    }

def reference(x, src, dst, deg_inv, w_msg, wq, wk, wv, w_out):
    N, D = x.shape[0], x.shape[1]
    h = _layernorm(x, axis=-1)
    m_e = torch.einsum('nd,de->ne', h, w_msg)
    h_local = _segment_sum(m_e[src], dst, N) * deg_inv[:, None]
    q = torch.einsum('nd,de->ne', h, wq)
    k = torch.einsum('nd,de->ne', h, wk)
    v = torch.einsum('nd,de->ne', h, wv)
    logits = torch.einsum('id,jd->ij', q, k) / (float(D) ** 0.5)
    attn = _softmax(logits, axis=-1)
    h_global = torch.einsum('ij,jd->id', attn, v)
    y = torch.einsum('nd,de->ne', h_local + h_global, w_out)
    return x + y
```

```asm
; @launch grid=(252,1,1) block=(512,1,1) lds=130112
.amdgcn_target "amdgcn-amd-amdhsa--gfx950"
.text
.globl standalone__hybrid_graph_tf_graphgps__graph_kernel
.p2align 8
.type standalone__hybrid_graph_tf_graphgps__graph_kernel,@function
standalone__hybrid_graph_tf_graphgps__graph_kernel:
    s_cmp_ge_u32 s2, 252
    s_cbranch_scc1 F_END
    s_load_dwordx16 s[4:19], s[0:1], 0
    s_load_dwordx8 s[20:27], s[0:1], 64
    s_memrealtime s[90:91]
    v_lshrrev_b32 v1, 6, v0
    v_and_b32 v0, 63, v0
    s_lshr_b32 s29, s2, 3
    v_readfirstlane_b32 s3, v1
    s_getpc_b64 s[30:31]
F_CPC:
    s_cmp_lg_u32 s3, 4
    s_cbranch_scc1 F_CPD
    s_sub_u32 s30, s30, F_CPC-standalone__hybrid_graph_tf_graphgps__graph_kernel
    s_subb_u32 s31, s31, 0
    s_and_b32 s28, s29, 7
    s_lshl_b32 s28, s28, 13
    v_lshlrev_b32 v1, 7, v0
    v_add_u32 v1, s28, v1
    v_min_u32 v1, F_CODE_END-standalone__hybrid_graph_tf_graphgps__graph_kernel-4, v1
    v_mov_b32 v193, s31
    v_add_co_u32 v192, vcc, s30, v1
    s_nop 1
    v_addc_co_u32 v193, vcc, 0, v193, vcc
    global_load_dword v194, v[192:193], off
F_CPD:
    s_cmp_ge_u32 s2, 240
    s_cbranch_scc1 F_MAPD
    s_and_b32 s28, s2, 7
    s_mul_i32 s30, s29, 52
    s_lshr_b32 s30, s30, 8
    s_mul_i32 s31, s30, 5
    s_sub_u32 s29, s29, s31
    s_lshl_b32 s30, s30, 3
    s_add_u32 s28, s28, s30
    s_mul_i32 s28, s28, 5
    s_add_u32 s2, s28, s29
F_MAPD:
    s_mul_hi_u32 s44, s2, 0x33333334
    s_mul_i32 s45, s44, 5
    s_sub_u32 s45, s2, s45
    v_and_b32 v1, 15, v0
    v_lshrrev_b32 v2, 4, v0
    v_lshlrev_b32 v247, 7, v1
    v_lshl_add_u32 v247, v2, 5, v247
    s_lshl_b32 s30, s44, 4
    s_cmp_ge_u32 s3, 4
    s_cbranch_scc1 F_RO1
    s_add_u32 s28, s45, s3
    s_cmp_ge_u32 s28, 5
    s_cselect_b32 s29, 5, 0
    s_sub_u32 s53, s28, s29
    s_lshl_b32 s31, s3, 2
    s_mov_b32 s74, 0
    s_add_u32 s30, s30, s31
    s_add_u32 s28, s53, 0
    s_and_b32 s28, s28, 3
    s_add_u32 s28, s28, s30
    s_lshl_b32 s70, s28, 11
    s_add_u32 s28, s53, 1
    s_and_b32 s28, s28, 3
    s_add_u32 s28, s28, s30
    s_lshl_b32 s71, s28, 11
    s_add_u32 s28, s53, 2
    s_and_b32 s28, s28, 3
    s_add_u32 s28, s28, s30
    s_lshl_b32 s72, s28, 11
    s_add_u32 s28, s53, 3
    s_and_b32 s28, s28, 3
    s_add_u32 s28, s28, s30
    s_lshl_b32 s73, s28, 11
    s_branch F_RO2
F_RO1:
    s_sub_u32 s31, s3, 4
    s_mul_i32 s28, s31, 5
    s_add_u32 s28, s28, s45
    s_cmp_gt_u32 s28, 15
    s_cselect_b32 s47, 0, 1
    s_min_u32 s28, s28, 15
    s_add_u32 s28, s28, s30
    s_lshl_b32 s70, s28, 11
    s_mul_i32 s52, s45, 320000
    s_lshl_b32 s31, s31, 12
    s_add_u32 s71, s52, s31
    s_add_u32 s72, s71, 2048
    s_mov_b32 s73, 0x10000000
    s_mov_b32 s74, 48
    v_lshlrev_b32 v247, 7, v1
    v_lshl_add_u32 v247, v2, 4, v247
F_RO2:
    s_waitcnt lgkmcnt(0)
    s_mov_b32 s32, s4
    s_mov_b32 s33, s5
    s_mov_b32 s34, 1600000
    s_mov_b32 s35, 0x00020000
    v_add_u32 v246, s74, v247
    buffer_load_dwordx4 v[160:163], v247, s[32:35], s70 offen offset:0
    buffer_load_dwordx4 v[164:167], v246, s[32:35], s70 offen offset:16
    buffer_load_dwordx4 v[168:171], v247, s[32:35], s71 offen offset:0
    buffer_load_dwordx4 v[172:175], v246, s[32:35], s71 offen offset:16
    buffer_load_dwordx4 v[176:179], v247, s[32:35], s72 offen offset:0
    buffer_load_dwordx4 v[180:183], v246, s[32:35], s72 offen offset:16
    buffer_load_dwordx4 v[184:187], v247, s[32:35], s73 offen offset:0
    buffer_load_dwordx4 v[188:191], v246, s[32:35], s73 offen offset:16
    v_mov_b32 v15, 130048
    s_cmp_ge_u32 s2, 245
    s_cbranch_scc1 F_SP
    s_cmp_lt_u32 s3, 4
    s_cbranch_scc1 F_ATT
    s_cmp_lt_u32 s3, 6
    s_cselect_b32 s36, s14, s16
    s_cselect_b32 s37, s15, s17
    s_mov_b32 s38, 8192
    s_mov_b32 s39, 0x00020000
    s_and_b32 s28, s3, 1
    s_lshl_b32 s28, s28, 12
    s_add_u32 s29, s31, 32768
    s_mov_b32 m0, s29
    s_lshr_b32 s29, s28, 6
    v_and_b32 v243, 7, v0
    v_lshlrev_b32 v243, 4, v243
    v_and_b32 v244, 16, v0
    v_lshl_or_b32 v244, v244, 1, s29
    v_xor_b32 v243, v243, v244
    v_lshrrev_b32 v244, 3, v0
    v_lshl_add_u32 v243, v244, 7, v243
    v_xor_b32 v244, 16, v243
    buffer_load_dwordx4 v243, s[36:39], s28 offen offset:0 lds
    buffer_load_dwordx4 v243, s[36:39], s28 offen offset:1024 lds
    buffer_load_dwordx4 v244, s[36:39], s28 offen offset:2048 lds
    buffer_load_dwordx4 v244, s[36:39], s28 offen offset:3072 lds
F_SP:
    v_mov_b32 v3, 1
    v_mov_b32 v4, 0
    v_mov_b32 v5, 0
    v_mov_b32 v6, 0
    v_mov_b32 v7, 0
    s_cmp_eq_u32 s2, 251
    s_cbranch_scc1 F_WEIGHTS
    s_cmp_gt_u32 s3, 4
    s_cbranch_scc1 F_H2
    s_cmp_lt_u32 s3, 4
    s_cbranch_scc1 F_XB
    v_lshlrev_b32 v8, 4, v0
    v_add_u32 v8, 129024, v8
    ds_write_b128 v8, v[4:7]
    s_mov_b64 exec, 15
    ds_write_b128 v8, v[4:7] offset:1024
    s_mov_b64 exec, -1
    s_waitcnt lgkmcnt(0)
    s_cmp_lt_u32 s2, 245
    s_cbranch_scc1 F_PROD
    s_not_b64 s[28:29], s[90:91]
    v_mov_b32 v8, s28
    v_mov_b32 v9, s29
    v_mov_b32 v10, 0
    s_mov_b64 exec, 1
    global_atomic_umax_x2 v10, v[8:9], s[24:25] sc1
    s_mov_b64 exec, -1
F_XB:
    s_barrier
    s_branch F_XAGG
F_H2:
    s_cmp_ge_u32 s2, 250
    s_cbranch_scc1 F_XB
    s_cmp_lt_u32 s2, 245
    s_cbranch_scc1 BN_0
    s_sub_u32 s31, s3, 5
    s_lshl_b32 s28, s31, 6
    v_add_u32 v8, s28, v0
    s_movk_i32 s40, 160
    s_movk_i32 s41, 98
    v_lshlrev_b32 v1, 4, v8
    v_add_u32 v2, 5120, v1
    v_add_u32 v9, 10240, v1
    v_cmp_gt_u32 s[64:65], s40, v8
    v_cmp_gt_u32 s[66:67], s41, v8
    s_mul_i32 s28, s2, 12800
    s_add_u32 s6, s6, s28
    s_addc_u32 s7, s7, 0
    s_add_u32 s8, s8, s28
    s_addc_u32 s9, s9, 0
    v_add_u32 v10, 112128, v1
    v_mov_b32 v11, 112128
    v_lshlrev_b32 v12, 5, v8
    v_add_u32 v13, 112128, v12
    v_mov_b32 v36, 0
    v_mov_b32 v37, 0
    v_mov_b32 v38, 0
    v_mov_b32 v39, 0
    v_mov_b32 v40, 0
    v_mov_b32 v41, 0
    v_mov_b32 v42, 0
    v_mov_b32 v43, 0
    s_mov_b64 exec, s[66:67]
    ds_write_b128 v13, v[4:7]
    ds_write_b128 v13, v[4:7] offset:16
    s_mov_b64 exec, -1
    s_waitcnt lgkmcnt(0)
    s_barrier
    s_cmp_ge_u32 s2, 245
    s_cbranch_scc1 F_ID1X
    s_sub_u32 s28, s3, 5
    s_mul_i32 s61, s28, 12800
    s_add_u32 s61, s61, 65536
    s_mul_i32 s28, s28, 5
    s_add_u32 s28, s28, s45
    s_lshl_b32 s60, s44, 4
    s_add_u32 s60, s60, s28
    s_cmp_eq_u32 s3, 5
    s_cselect_b32 s62, 1, 2
    s_branch F_ID2X
F_ID1X:
    s_sub_u32 s60, s2, 245
    s_lshl_b32 s60, s60, 3
    s_add_u32 s60, s60, s3
    s_lshl_b32 s60, s60, 4
    s_add_u32 s60, s60, 15
    s_mul_i32 s61, s3, 12800
    s_mov_b32 s62, 0
F_ID2X:
    s_waitcnt vmcnt(0)
    v_and_b32 v146, 15, v0
    v_lshlrev_b32 v147, 4, v146
    v_mov_b32 v4, 0x3f80
    v_mov_b32 v5, 0
    v_lshlrev_b64 v[48:49], v147, v[4:5]
    v_mov_b32 v6, v48
    v_mov_b32 v7, v49
    v_cmp_gt_u32 vcc, 4, v146
    v_lshrrev_b32 v147, 2, v146
    v_cmp_eq_u32 s[74:75], 1, v147
    v_cndmask_b32 v48, 0, v6, vcc
    v_cndmask_b32 v49, 0, v7, vcc
    v_cndmask_b32 v50, 0, v6, s[74:75]
    v_cndmask_b32 v51, 0, v7, s[74:75]
    v_lshl_add_u32 v62, v146, 2, s61
    s_add_u32 s28, s61, 256
    v_lshl_add_u32 v63, v146, 8, s28
    v_lshrrev_b32 v147, 3, v0
    v_lshl_add_u32 v60, v147, 1, s61
    v_and_b32 v147, 7, v0
    v_lshlrev_b32 v185, 4, v147
    v_and_b32 v147, 31, v0
    v_lshl_add_u32 v61, v147, 4, s61
    v_mov_b32 v187, v185
    v_mov_b32 v189, v185
    v_mov_b32 v191, v185
    v_mov_b32 v193, v185
    v_mov_b32 v195, v185
    v_mov_b32 v197, v185
    v_mov_b32 v199, v185
    v_mov_b32 v201, v185
    v_mov_b32 v203, v185
    v_mov_b32 v205, v185
    v_mov_b32 v207, v185
    v_mov_b32 v209, v185
    v_mov_b32 v211, v185
    v_mov_b32 v213, v185
    v_mov_b32 v215, v185
    v_mov_b32 v217, v185
    v_mov_b32 v219, v185
    v_mov_b32 v221, v185
    v_mov_b32 v223, v185
    v_mov_b32 v225, v185
    v_mov_b32 v227, v185
    v_mov_b32 v229, v185
    v_mov_b32 v231, v185
    v_mov_b32 v233, v185
    v_mov_b32 v235, v185
    v_mov_b32 v237, v185
    v_mov_b32 v239, v185
    v_mov_b32 v241, v185
    v_mov_b32 v243, v185
    v_lshlrev_b32 v140, 6, v0
    v_add_u32 v141, 4096, v140
    v_add_u32 v144, 8192, v140
    v_min_u32 v142, 52, v0
    v_lshlrev_b32 v142, 6, v142
    v_add_u32 v142, 12288, v142
    v_add_u32 v143, 12288, v140
    v_lshrrev_b32 v146, 1, v0
    v_cmp_eq_u32 vcc, 29, v146
    v_mul_u32_u24 v148, 3136, v0
    v_mul_u32_u24 v149, 12800, v0
    v_cndmask_b32 v143, v143, v140, vcc
    v_mov_b32 v4, 819212500
    v_mov_b32 v5, v4
    v_mov_b32 v6, v4
    v_mov_b32 v7, v4
    v_lshlrev_b32 v146, 4, v0
    v_add_u32 v146, s61, v146
    ds_write_b128 v146, v[4:7] offset:256
    ds_write_b128 v146, v[4:7] offset:1280
    ds_write_b128 v146, v[4:7] offset:2304
    ds_write_b128 v146, v[4:7] offset:3328
    ds_write_b32 v62, v63
    v_mov_b32 v4, 0
    v_mov_b32 v5, 0
    v_mov_b32 v6, 0
    v_mov_b32 v7, 0
    ds_write_b128 v146, v[4:7] offset:4352
    ds_write_b128 v146, v[4:7] offset:5376
    ds_write_b128 v146, v[4:7] offset:6400
    ds_write_b128 v146, v[4:7] offset:7424
    ds_write_b128 v146, v[4:7] offset:8448
    ds_write_b128 v146, v[4:7] offset:9472
    ds_write_b128 v146, v[4:7] offset:10496
    ds_write_b128 v146, v[4:7] offset:11520
    s_mov_b32 exec_hi, 0
    s_mov_b32 exec_lo, 0xffff
    ds_write_b128 v146, v[4:7] offset:12544
    s_mov_b64 exec, -1
    v_mov_b32 v6, 2
    v_mov_b32 v7, s61
    v_mov_b32 v3, 1
    s_branch BN_GO
BN_0:
    s_setprio 3
    s_mov_b32 s36, s26
    s_mov_b32 s37, s27
    s_mov_b32 s38, 1605632
    s_mov_b32 s39, 0x00020000
    v_mov_b32 v240, v1
    v_lshlrev_b32 v242, 7, v1
    v_add_u32 v242, s31, v242
    v_bfe_u32 v243, v1, 1, 3
    v_xor_b32 v243, v243, v2
    v_lshl_add_u32 v245, v243, 4, v242
    v_xor_b32 v246, 64, v245
    v_cmp_eq_u32 s[54:55], 3, v2
    s_mov_b32 s49, s70
    s_mov_b32 s46, 0xffff0000
    s_mov_b32 s48, 0x3727c5ac
    s_mov_b32 s51, 0x3c800000
    v_mov_b32 v220, 0x3f803f80
    v_mov_b32 v221, 0x3f803f80
    v_mov_b32 v222, 0x3f803f80
    v_mov_b32 v223, 0x3f803f80
    s_sub_u32 s31, s3, 5
    s_lshl_b32 s28, s31, 6
    v_add_u32 v8, s28, v0
    s_movk_i32 s40, 160
    s_movk_i32 s41, 98
    v_lshlrev_b32 v1, 4, v8
    v_add_u32 v2, 5120, v1
    v_add_u32 v9, 10240, v1
    v_cmp_gt_u32 s[64:65], s40, v8
    v_cmp_gt_u32 s[66:67], s41, v8
    s_mul_i32 s28, s2, 12800
    s_add_u32 s6, s6, s28
    s_addc_u32 s7, s7, 0
    s_add_u32 s8, s8, s28
    s_addc_u32 s9, s9, 0
    v_add_u32 v10, 112128, v1
    v_mov_b32 v11, 112128
    v_lshlrev_b32 v12, 5, v8
    v_add_u32 v13, 112128, v12
    v_mov_b32 v36, 0
    v_mov_b32 v37, 0
    v_mov_b32 v38, 0
    v_mov_b32 v39, 0
    v_mov_b32 v40, 0
    v_mov_b32 v41, 0
    v_mov_b32 v42, 0
    v_mov_b32 v43, 0
    s_mov_b64 exec, s[66:67]
    ds_write_b128 v13, v[4:7]
    ds_write_b128 v13, v[4:7] offset:16
    s_mov_b64 exec, -1
    s_waitcnt lgkmcnt(0)
    s_barrier
    s_waitcnt vmcnt(10)
    v_mfma_f32_16x16x32_bf16 v[224:227], v[220:223], v[160:163], 0
    v_mfma_f32_16x16x32_bf16 v[224:227], v[220:223], v[164:167], v[224:227]
    v_lshlrev_b32 v212, 16, v160
    v_and_b32 v213, s46, v160
    v_lshlrev_b32 v214, 16, v161
    v_and_b32 v215, s46, v161
    v_lshlrev_b32 v216, 16, v162
    v_and_b32 v217, s46, v162
    v_lshlrev_b32 v218, 16, v163
    v_and_b32 v219, s46, v163
    v_lshlrev_b32 v236, 16, v164
    v_and_b32 v237, s46, v164
    v_lshlrev_b32 v238, 16, v165
    v_and_b32 v239, s46, v165
    v_lshlrev_b32 v200, 16, v166
    v_and_b32 v201, s46, v166
    v_lshlrev_b32 v202, 16, v167
    v_and_b32 v203, s46, v167
    v_mul_f32 v230, s51, v224
    v_pk_add_f32 v[212:213], v[212:213], v[230:231] op_sel_hi:[1,0] neg_lo:[0,1] neg_hi:[0,1]
    v_pk_add_f32 v[214:215], v[214:215], v[230:231] op_sel_hi:[1,0] neg_lo:[0,1] neg_hi:[0,1]
    v_pk_add_f32 v[216:217], v[216:217], v[230:231] op_sel_hi:[1,0] neg_lo:[0,1] neg_hi:[0,1]
    v_pk_add_f32 v[218:219], v[218:219], v[230:231] op_sel_hi:[1,0] neg_lo:[0,1] neg_hi:[0,1]
    v_pk_add_f32 v[236:237], v[236:237], v[230:231] op_sel_hi:[1,0] neg_lo:[0,1] neg_hi:[0,1]
    v_pk_add_f32 v[238:239], v[238:239], v[230:231] op_sel_hi:[1,0] neg_lo:[0,1] neg_hi:[0,1]
    v_pk_add_f32 v[200:201], v[200:201], v[230:231] op_sel_hi:[1,0] neg_lo:[0,1] neg_hi:[0,1]
    v_pk_add_f32 v[202:203], v[202:203], v[230:231] op_sel_hi:[1,0] neg_lo:[0,1] neg_hi:[0,1]
    v_pk_mul_f32 v[228:229], v[212:213], v[212:213]
    v_pk_mul_f32 v[230:231], v[214:215], v[214:215]
    v_pk_fma_f32 v[228:229], v[216:217], v[216:217], v[228:229]
    v_pk_fma_f32 v[230:231], v[218:219], v[218:219], v[230:231]
    v_pk_fma_f32 v[228:229], v[236:237], v[236:237], v[228:229]
    v_pk_fma_f32 v[230:231], v[238:239], v[238:239], v[230:231]
    v_pk_fma_f32 v[228:229], v[200:201], v[200:201], v[228:229]
    v_pk_fma_f32 v[230:231], v[202:203], v[202:203], v[230:231]
    v_pk_add_f32 v[228:229], v[228:229], v[230:231]
    v_add_f32 v228, v228, v229
    v_mov_b32 v230, v228
    v_mov_b32 v231, v228
    s_nop 1
    v_permlane16_swap_b32 v230, v231
    s_nop 1
    v_add_f32 v228, v230, v231
    v_mov_b32 v230, v228
    v_mov_b32 v231, v228
    s_nop 1
    v_permlane32_swap_b32 v230, v231
    s_nop 1
    v_add_f32 v228, v230, v231
    v_mov_b32 v229, s48
    v_fmac_f32 v229, s51, v228
    v_rsq_f32 v230, v229
    s_nop 0
    v_pk_mul_f32 v[212:213], v[212:213], v[230:231] op_sel_hi:[1,0]
    v_pk_mul_f32 v[214:215], v[214:215], v[230:231] op_sel_hi:[1,0]
    v_pk_mul_f32 v[216:217], v[216:217], v[230:231] op_sel_hi:[1,0]
    v_pk_mul_f32 v[218:219], v[218:219], v[230:231] op_sel_hi:[1,0]
    v_pk_mul_f32 v[236:237], v[236:237], v[230:231] op_sel_hi:[1,0]
    v_pk_mul_f32 v[238:239], v[238:239], v[230:231] op_sel_hi:[1,0]
    v_pk_mul_f32 v[200:201], v[200:201], v[230:231] op_sel_hi:[1,0]
    v_pk_mul_f32 v[202:203], v[202:203], v[230:231] op_sel_hi:[1,0]
    v_cvt_pk_bf16_f32 v232, v212, v213
    v_cvt_pk_bf16_f32 v233, v214, v215
    v_cvt_pk_bf16_f32 v234, v216, v217
    v_cvt_pk_bf16_f32 v235, v218, v219
    v_cvt_pk_bf16_f32 v236, v236, v237
    v_cvt_pk_bf16_f32 v237, v238, v239
    v_cvt_pk_bf16_f32 v238, v200, v201
    v_cvt_pk_bf16_f32 v239, v202, v203
    s_lshr_b32 s28, s49, 7
    s_sub_u32 s28, 12500, s28
    v_cmp_gt_i32 vcc, s28, v240
    v_and_b32 v228, 0xffff, v239
    v_or_b32 v228, 0x3f800000, v228
    s_cmp_eq_u32 s47, 0
    s_cselect_b32 s38, 0, s38
    s_and_b64 vcc, vcc, s[54:55]
    s_nop 0
    v_cndmask_b32 v239, v239, v228, vcc
    buffer_store_dwordx4 v[232:235], v247, s[36:39], s49 offen sc1
    buffer_store_dwordx4 v[236:239], v247, s[36:39], s49 offen offset:64 sc1
    s_waitcnt vmcnt(2)
    s_mov_b64 exec, 1
    ds_add_u32 v15, v3 offset:36
    s_mov_b64 exec, -1
    v_mfma_f32_16x16x32_bf16 v[224:227], v[220:223], v[168:171], 0
    v_mfma_f32_16x16x32_bf16 v[224:227], v[220:223], v[172:175], v[224:227]
    v_lshlrev_b32 v212, 16, v168
    v_and_b32 v213, s46, v168
    v_lshlrev_b32 v214, 16, v169
    v_and_b32 v215, s46, v169
    v_lshlrev_b32 v216, 16, v170
    v_and_b32 v217, s46, v170
    v_lshlrev_b32 v218, 16, v171
    v_and_b32 v219, s46, v171
    v_lshlrev_b32 v208, 16, v172
    v_and_b32 v209, s46, v172
    v_lshlrev_b32 v210, 16, v173
    v_and_b32 v211, s46, v173
    v_lshlrev_b32 v200, 16, v174
    v_and_b32 v201, s46, v174
    v_lshlrev_b32 v202, 16, v175
    v_and_b32 v203, s46, v175
    v_mul_f32 v230, s51, v224
    v_pk_add_f32 v[212:213], v[212:213], v[230:231] op_sel_hi:[1,0] neg_lo:[0,1] neg_hi:[0,1]
    v_pk_add_f32 v[214:215], v[214:215], v[230:231] op_sel_hi:[1,0] neg_lo:[0,1] neg_hi:[0,1]
    v_pk_add_f32 v[216:217], v[216:217], v[230:231] op_sel_hi:[1,0] neg_lo:[0,1] neg_hi:[0,1]
    v_pk_add_f32 v[218:219], v[218:219], v[230:231] op_sel_hi:[1,0] neg_lo:[0,1] neg_hi:[0,1]
    v_pk_add_f32 v[208:209], v[208:209], v[230:231] op_sel_hi:[1,0] neg_lo:[0,1] neg_hi:[0,1]
    v_pk_add_f32 v[210:211], v[210:211], v[230:231] op_sel_hi:[1,0] neg_lo:[0,1] neg_hi:[0,1]
    v_pk_add_f32 v[200:201], v[200:201], v[230:231] op_sel_hi:[1,0] neg_lo:[0,1] neg_hi:[0,1]
    v_pk_add_f32 v[202:203], v[202:203], v[230:231] op_sel_hi:[1,0] neg_lo:[0,1] neg_hi:[0,1]
    v_pk_mul_f32 v[228:229], v[212:213], v[212:213]
    v_pk_mul_f32 v[230:231], v[214:215], v[214:215]
    v_pk_fma_f32 v[228:229], v[216:217], v[216:217], v[228:229]
    v_pk_fma_f32 v[230:231], v[218:219], v[218:219], v[230:231]
    v_pk_fma_f32 v[228:229], v[208:209], v[208:209], v[228:229]
    v_pk_fma_f32 v[230:231], v[210:211], v[210:211], v[230:231]
    v_pk_fma_f32 v[228:229], v[200:201], v[200:201], v[228:229]
    v_pk_fma_f32 v[230:231], v[202:203], v[202:203], v[230:231]
    v_pk_add_f32 v[228:229], v[228:229], v[230:231]
    v_add_f32 v228, v228, v229
    v_mov_b32 v230, v228
    v_mov_b32 v231, v228
    s_nop 1
    v_permlane16_swap_b32 v230, v231
    s_nop 1
    v_add_f32 v228, v230, v231
    v_mov_b32 v230, v228
    v_mov_b32 v231, v228
    s_nop 1
    v_permlane32_swap_b32 v230, v231
    s_nop 1
    v_add_f32 v228, v230, v231
    v_mov_b32 v229, s48
    v_fmac_f32 v229, s51, v228
    v_rsq_f32 v230, v229
    s_nop 0
    v_pk_mul_f32 v[212:213], v[212:213], v[230:231] op_sel_hi:[1,0]
    v_pk_mul_f32 v[214:215], v[214:215], v[230:231] op_sel_hi:[1,0]
    v_pk_mul_f32 v[216:217], v[216:217], v[230:231] op_sel_hi:[1,0]
    v_pk_mul_f32 v[218:219], v[218:219], v[230:231] op_sel_hi:[1,0]
    v_pk_mul_f32 v[208:209], v[208:209], v[230:231] op_sel_hi:[1,0]
    v_pk_mul_f32 v[210:211], v[210:211], v[230:231] op_sel_hi:[1,0]
    v_pk_mul_f32 v[200:201], v[200:201], v[230:231] op_sel_hi:[1,0]
    v_pk_mul_f32 v[202:203], v[202:203], v[230:231] op_sel_hi:[1,0]
    v_cvt_pk_bf16_f32 v204, v212, v213
    v_cvt_pk_bf16_f32 v205, v214, v215
    v_cvt_pk_bf16_f32 v206, v216, v217
    v_cvt_pk_bf16_f32 v207, v218, v219
    v_cvt_pk_bf16_f32 v208, v208, v209
    v_cvt_pk_bf16_f32 v209, v210, v211
    v_cvt_pk_bf16_f32 v210, v200, v201
    v_cvt_pk_bf16_f32 v211, v202, v203
    v_and_b32 v228, 0xffff, v211
    v_or_b32 v228, 0x3f800000, v228
    v_cndmask_b32 v211, v211, v228, s[54:55]
    ds_write_b128 v245, v[204:207] offset:0
    ds_write_b128 v246, v[208:211] offset:0
    s_waitcnt vmcnt(0)
    s_mov_b64 exec, 1
    ds_add_rtn_u32 v228, v15, v3 offset:4
    s_waitcnt lgkmcnt(0)
    v_readfirstlane_b32 s29, v228
    s_mov_b64 exec, -1
    s_nop 3
    s_cmp_lg_u32 s29, 3
    s_cbranch_scc1 LH_1
    s_lshl_b32 s30, s2, 6
    s_add_u32 s30, s30, 5177344
    s_memrealtime s[82:83]
    v_lshl_add_u32 v230, v0, 3, s30
    s_waitcnt lgkmcnt(0)
    v_mov_b32 v228, s82
    v_mov_b32 v229, s83
    s_mov_b64 exec, 0xff
    global_store_dwordx2 v230, v[228:229], s[26:27] sc1
    s_mov_b64 exec, -1
LH_1:
    v_mfma_f32_16x16x32_bf16 v[224:227], v[220:223], v[176:179], 0
    v_mfma_f32_16x16x32_bf16 v[224:227], v[220:223], v[180:183], v[224:227]
    v_lshlrev_b32 v212, 16, v176
    v_and_b32 v213, s46, v176
    v_lshlrev_b32 v214, 16, v177
    v_and_b32 v215, s46, v177
    v_lshlrev_b32 v216, 16, v178
    v_and_b32 v217, s46, v178
    v_lshlrev_b32 v218, 16, v179
    v_and_b32 v219, s46, v179
    v_lshlrev_b32 v208, 16, v180
    v_and_b32 v209, s46, v180
    v_lshlrev_b32 v210, 16, v181
    v_and_b32 v211, s46, v181
    v_lshlrev_b32 v200, 16, v182
    v_and_b32 v201, s46, v182
    v_lshlrev_b32 v202, 16, v183
    v_and_b32 v203, s46, v183
    v_mul_f32 v230, s51, v224
    v_pk_add_f32 v[212:213], v[212:213], v[230:231] op_sel_hi:[1,0] neg_lo:[0,1] neg_hi:[0,1]
    v_pk_add_f32 v[214:215], v[214:215], v[230:231] op_sel_hi:[1,0] neg_lo:[0,1] neg_hi:[0,1]
    v_pk_add_f32 v[216:217], v[216:217], v[230:231] op_sel_hi:[1,0] neg_lo:[0,1] neg_hi:[0,1]
    v_pk_add_f32 v[218:219], v[218:219], v[230:231] op_sel_hi:[1,0] neg_lo:[0,1] neg_hi:[0,1]
    v_pk_add_f32 v[208:209], v[208:209], v[230:231] op_sel_hi:[1,0] neg_lo:[0,1] neg_hi:[0,1]
    v_pk_add_f32 v[210:211], v[210:211], v[230:231] op_sel_hi:[1,0] neg_lo:[0,1] neg_hi:[0,1]
    v_pk_add_f32 v[200:201], v[200:201], v[230:231] op_sel_hi:[1,0] neg_lo:[0,1] neg_hi:[0,1]
    v_pk_add_f32 v[202:203], v[202:203], v[230:231] op_sel_hi:[1,0] neg_lo:[0,1] neg_hi:[0,1]
    v_pk_mul_f32 v[228:229], v[212:213], v[212:213]
    v_pk_mul_f32 v[230:231], v[214:215], v[214:215]
    v_pk_fma_f32 v[228:229], v[216:217], v[216:217], v[228:229]
    v_pk_fma_f32 v[230:231], v[218:219], v[218:219], v[230:231]
    v_pk_fma_f32 v[228:229], v[208:209], v[208:209], v[228:229]
    v_pk_fma_f32 v[230:231], v[210:211], v[210:211], v[230:231]
    v_pk_fma_f32 v[228:229], v[200:201], v[200:201], v[228:229]
    v_pk_fma_f32 v[230:231], v[202:203], v[202:203], v[230:231]
    v_pk_add_f32 v[228:229], v[228:229], v[230:231]
    v_add_f32 v228, v228, v229
    v_mov_b32 v230, v228
    v_mov_b32 v231, v228
    s_nop 1
    v_permlane16_swap_b32 v230, v231
    s_nop 1
    v_add_f32 v228, v230, v231
    v_mov_b32 v230, v228
    v_mov_b32 v231, v228
    s_nop 1
    v_permlane32_swap_b32 v230, v231
    s_nop 1
    v_add_f32 v228, v230, v231
    v_mov_b32 v229, s48
    v_fmac_f32 v229, s51, v228
    v_rsq_f32 v230, v229
    s_nop 0
    v_pk_mul_f32 v[212:213], v[212:213], v[230:231] op_sel_hi:[1,0]
    v_pk_mul_f32 v[214:215], v[214:215], v[230:231] op_sel_hi:[1,0]
    v_pk_mul_f32 v[216:217], v[216:217], v[230:231] op_sel_hi:[1,0]
    v_pk_mul_f32 v[218:219], v[218:219], v[230:231] op_sel_hi:[1,0]
    v_pk_mul_f32 v[208:209], v[208:209], v[230:231] op_sel_hi:[1,0]
    v_pk_mul_f32 v[210:211], v[210:211], v[230:231] op_sel_hi:[1,0]
    v_pk_mul_f32 v[200:201], v[200:201], v[230:231] op_sel_hi:[1,0]
    v_pk_mul_f32 v[202:203], v[202:203], v[230:231] op_sel_hi:[1,0]
    v_cvt_pk_bf16_f32 v204, v212, v213
    v_cvt_pk_bf16_f32 v205, v214, v215
    v_cvt_pk_bf16_f32 v206, v216, v217
    v_cvt_pk_bf16_f32 v207, v218, v219
    v_cvt_pk_bf16_f32 v208, v208, v209
    v_cvt_pk_bf16_f32 v209, v210, v211
    v_cvt_pk_bf16_f32 v210, v200, v201
    v_cvt_pk_bf16_f32 v211, v202, v203
    v_and_b32 v228, 0xffff, v211
    v_or_b32 v228, 0x3f800000, v228
    v_cndmask_b32 v211, v211, v228, s[54:55]
    ds_write_b128 v245, v[204:207] offset:2048
    ds_write_b128 v246, v[208:211] offset:2048
    s_waitcnt lgkmcnt(0)
    s_mov_b64 exec, 1
    ds_add_rtn_u32 v228, v15, v3 offset:40
    s_waitcnt lgkmcnt(0)
    v_readfirstlane_b32 s29, v228
    s_mov_b64 exec, -1
    s_nop 3
    s_cmp_lg_u32 s29, 3
    s_cbranch_scc1 LA_2
    v_mov_b32 v228, 1
    ds_max_u32 v15, v228 offset:0
LA_2:
    s_setprio 0
    s_cmp_ge_u32 s2, 245
    s_cbranch_scc1 F_ID1
    s_sub_u32 s28, s3, 5
    s_mul_i32 s61, s28, 12800
    s_add_u32 s61, s61, 65536
    s_mul_i32 s28, s28, 5
    s_add_u32 s28, s28, s45
    s_lshl_b32 s60, s44, 4
    s_add_u32 s60, s60, s28
    s_cmp_eq_u32 s3, 5
    s_cselect_b32 s62, 1, 2
    s_branch F_ID2
F_ID1:
    s_sub_u32 s60, s2, 245
    s_lshl_b32 s60, s60, 3
    s_add_u32 s60, s60, s3
    s_lshl_b32 s60, s60, 4
    s_add_u32 s60, s60, 15
    s_mul_i32 s61, s3, 12800
    s_mov_b32 s62, 0
F_ID2:
    s_waitcnt vmcnt(0)
    v_and_b32 v146, 15, v0
    v_lshlrev_b32 v147, 4, v146
    v_mov_b32 v4, 0x3f80
    v_mov_b32 v5, 0
    v_lshlrev_b64 v[48:49], v147, v[4:5]
    v_mov_b32 v6, v48
    v_mov_b32 v7, v49
    v_cmp_gt_u32 vcc, 4, v146
    v_lshrrev_b32 v147, 2, v146
    v_cmp_eq_u32 s[74:75], 1, v147
    v_cndmask_b32 v48, 0, v6, vcc
    v_cndmask_b32 v49, 0, v7, vcc
    v_cndmask_b32 v50, 0, v6, s[74:75]
    v_cndmask_b32 v51, 0, v7, s[74:75]
    v_lshl_add_u32 v62, v146, 2, s61
    s_add_u32 s28, s61, 256
    v_lshl_add_u32 v63, v146, 8, s28
    v_lshrrev_b32 v147, 3, v0
    v_lshl_add_u32 v60, v147, 1, s61
    v_and_b32 v147, 7, v0
    v_lshlrev_b32 v185, 4, v147
    v_and_b32 v147, 31, v0
    v_lshl_add_u32 v61, v147, 4, s61
    v_mov_b32 v187, v185
    v_mov_b32 v189, v185
    v_mov_b32 v191, v185
    v_mov_b32 v193, v185
    v_mov_b32 v195, v185
    v_mov_b32 v197, v185
    v_mov_b32 v199, v185
    v_mov_b32 v201, v185
    v_mov_b32 v203, v185
    v_mov_b32 v205, v185
    v_mov_b32 v207, v185
    v_mov_b32 v209, v185
    v_mov_b32 v211, v185
    v_mov_b32 v213, v185
    v_mov_b32 v215, v185
    v_mov_b32 v217, v185
    v_mov_b32 v219, v185
    v_mov_b32 v221, v185
    v_mov_b32 v223, v185
    v_mov_b32 v225, v185
    v_mov_b32 v227, v185
    v_mov_b32 v229, v185
    v_mov_b32 v231, v185
    v_mov_b32 v233, v185
    v_mov_b32 v235, v185
    v_mov_b32 v237, v185
    v_mov_b32 v239, v185
    v_mov_b32 v241, v185
    v_mov_b32 v243, v185
    v_lshlrev_b32 v140, 6, v0
    v_add_u32 v141, 4096, v140
    v_add_u32 v144, 8192, v140
    v_min_u32 v142, 52, v0
    v_lshlrev_b32 v142, 6, v142
    v_add_u32 v142, 12288, v142
    v_add_u32 v143, 12288, v140
    v_lshrrev_b32 v146, 1, v0
    v_cmp_eq_u32 vcc, 29, v146
    v_mul_u32_u24 v148, 3136, v0
    v_mul_u32_u24 v149, 12800, v0
    v_cndmask_b32 v143, v143, v140, vcc
    v_mov_b32 v4, 819212500
    v_mov_b32 v5, v4
    v_mov_b32 v6, v4
    v_mov_b32 v7, v4
    v_lshlrev_b32 v146, 4, v0
    v_add_u32 v146, s61, v146
    ds_write_b128 v146, v[4:7] offset:256
    ds_write_b128 v146, v[4:7] offset:1280
    ds_write_b128 v146, v[4:7] offset:2304
    ds_write_b128 v146, v[4:7] offset:3328
    ds_write_b32 v62, v63
    v_mov_b32 v4, 0
    v_mov_b32 v5, 0
    v_mov_b32 v6, 0
    v_mov_b32 v7, 0
    ds_write_b128 v146, v[4:7] offset:4352
    ds_write_b128 v146, v[4:7] offset:5376
    ds_write_b128 v146, v[4:7] offset:6400
    ds_write_b128 v146, v[4:7] offset:7424
    ds_write_b128 v146, v[4:7] offset:8448
    ds_write_b128 v146, v[4:7] offset:9472
    ds_write_b128 v146, v[4:7] offset:10496
    ds_write_b128 v146, v[4:7] offset:11520
    s_mov_b32 exec_hi, 0
    s_mov_b32 exec_lo, 0xffff
    ds_write_b128 v146, v[4:7] offset:12544
    s_mov_b64 exec, -1
    v_mov_b32 v6, 2
    v_mov_b32 v7, s61
    v_mov_b32 v3, 1
    s_mov_b32 s50, 262144
W_3:
    ds_read_b32 v14, v15 offset:0
    s_waitcnt lgkmcnt(0)
    v_readfirstlane_b32 s29, v14
    s_nop 3
    s_cmp_ge_u32 s29, 2
    s_cbranch_scc1 W_4
    s_sleep 2
    s_sub_u32 s50, s50, 1
    s_cmp_lg_u32 s50, 0
    s_cbranch_scc1 W_3
W_4:
BN_GO:
    s_mov_b64 exec, s[64:65]
    global_load_dwordx4 v[64:67], v1, s[8:9] offset:0
    global_load_dwordx4 v[68:71], v1, s[8:9] offset:2560
    global_load_dwordx4 v[72:75], v2, s[8:9] offset:0
    global_load_dwordx4 v[76:79], v2, s[8:9] offset:2560
    global_load_dwordx4 v[80:83], v9, s[8:9] offset:0
    global_load_dwordx4 v[84:87], v1, s[6:7] offset:0
    global_load_dwordx4 v[88:91], v1, s[6:7] offset:2560
    global_load_dwordx4 v[92:95], v2, s[6:7] offset:0
    global_load_dwordx4 v[96:99], v2, s[6:7] offset:2560
    global_load_dwordx4 v[100:103], v9, s[6:7] offset:0
    s_mov_b64 exec, -1
BN_GO2:
    s_setprio 3
    s_mov_b64 exec, s[64:65]
    s_waitcnt vmcnt(5)
    v_lshrrev_b32 v104, 4, v64
    v_lshl_add_u32 v104, v104, 2, v11
    ds_add_rtn_u32 v150, v104, v3
    v_lshrrev_b32 v105, 4, v65
    v_lshl_add_u32 v105, v105, 2, v11
    ds_add_rtn_u32 v151, v105, v3
    v_lshrrev_b32 v106, 4, v66
    v_lshl_add_u32 v106, v106, 2, v11
    ds_add_rtn_u32 v152, v106, v3
    v_lshrrev_b32 v107, 4, v67
    v_lshl_add_u32 v107, v107, 2, v11
    ds_add_rtn_u32 v153, v107, v3
    v_lshrrev_b32 v108, 4, v68
    v_lshl_add_u32 v108, v108, 2, v11
    ds_add_rtn_u32 v154, v108, v3
    v_lshrrev_b32 v109, 4, v69
    v_lshl_add_u32 v109, v109, 2, v11
    ds_add_rtn_u32 v155, v109, v3
    v_lshrrev_b32 v110, 4, v70
    v_lshl_add_u32 v110, v110, 2, v11
    ds_add_rtn_u32 v156, v110, v3
    v_lshrrev_b32 v111, 4, v71
    v_lshl_add_u32 v111, v111, 2, v11
    ds_add_rtn_u32 v157, v111, v3
    v_lshrrev_b32 v112, 4, v72
    v_lshl_add_u32 v112, v112, 2, v11
    ds_add_rtn_u32 v158, v112, v3
    v_lshrrev_b32 v113, 4, v73
    v_lshl_add_u32 v113, v113, 2, v11
    ds_add_rtn_u32 v159, v113, v3
    v_lshrrev_b32 v114, 4, v74
    v_lshl_add_u32 v114, v114, 2, v11
    ds_add_rtn_u32 v160, v114, v3
    v_lshrrev_b32 v115, 4, v75
    v_lshl_add_u32 v115, v115, 2, v11
    ds_add_rtn_u32 v161, v115, v3
    v_lshrrev_b32 v116, 4, v76
    v_lshl_add_u32 v116, v116, 2, v11
    ds_add_rtn_u32 v162, v116, v3
    v_lshrrev_b32 v117, 4, v77
    v_lshl_add_u32 v117, v117, 2, v11
    ds_add_rtn_u32 v163, v117, v3
    v_lshrrev_b32 v118, 4, v78
    v_lshl_add_u32 v118, v118, 2, v11
    ds_add_rtn_u32 v164, v118, v3
    v_lshrrev_b32 v119, 4, v79
    v_lshl_add_u32 v119, v119, 2, v11
    ds_add_rtn_u32 v165, v119, v3
    v_lshrrev_b32 v120, 4, v80
    v_lshl_add_u32 v120, v120, 2, v11
    ds_add_rtn_u32 v166, v120, v3
    v_lshrrev_b32 v121, 4, v81
    v_lshl_add_u32 v121, v121, 2, v11
    ds_add_rtn_u32 v167, v121, v3
    v_lshrrev_b32 v122, 4, v82
    v_lshl_add_u32 v122, v122, 2, v11
    ds_add_rtn_u32 v168, v122, v3
    v_lshrrev_b32 v123, 4, v83
    v_lshl_add_u32 v123, v123, 2, v11
    ds_add_rtn_u32 v169, v123, v3
    s_waitcnt vmcnt(0)
    v_and_b32 v4, 15, v64
    v_lshl_or_b32 v84, v4, 18, v84
    v_and_b32 v4, 15, v65
    v_lshl_or_b32 v85, v4, 18, v85
    v_and_b32 v4, 15, v66
    v_lshl_or_b32 v86, v4, 18, v86
    v_and_b32 v4, 15, v67
    v_lshl_or_b32 v87, v4, 18, v87
    v_and_b32 v4, 15, v68
    v_lshl_or_b32 v88, v4, 18, v88
    v_and_b32 v4, 15, v69
    v_lshl_or_b32 v89, v4, 18, v89
    v_and_b32 v4, 15, v70
    v_lshl_or_b32 v90, v4, 18, v90
    v_and_b32 v4, 15, v71
    v_lshl_or_b32 v91, v4, 18, v91
    v_and_b32 v4, 15, v72
    v_lshl_or_b32 v92, v4, 18, v92
    v_and_b32 v4, 15, v73
    v_lshl_or_b32 v93, v4, 18, v93
    v_and_b32 v4, 15, v74
    v_lshl_or_b32 v94, v4, 18, v94
    v_and_b32 v4, 15, v75
    v_lshl_or_b32 v95, v4, 18, v95
    v_and_b32 v4, 15, v76
    v_lshl_or_b32 v96, v4, 18, v96
    v_and_b32 v4, 15, v77
    v_lshl_or_b32 v97, v4, 18, v97
    v_and_b32 v4, 15, v78
    v_lshl_or_b32 v98, v4, 18, v98
    v_and_b32 v4, 15, v79
    v_lshl_or_b32 v99, v4, 18, v99
    v_and_b32 v4, 15, v80
    v_lshl_or_b32 v100, v4, 18, v100
    v_and_b32 v4, 15, v81
    v_lshl_or_b32 v101, v4, 18, v101
    v_and_b32 v4, 15, v82
    v_lshl_or_b32 v102, v4, 18, v102
    v_and_b32 v4, 15, v83
    v_lshl_or_b32 v103, v4, 18, v103
    s_mov_b64 exec, 1
    s_waitcnt lgkmcnt(0)
    ds_add_u32 v15, v3 offset:12
    s_mov_b64 exec, -1
    s_mov_b32 s50, 262144
W_5:
    ds_read_b32 v14, v15 offset:12
    s_waitcnt lgkmcnt(0)
    v_readfirstlane_b32 s29, v14
    s_nop 3
    s_cmp_ge_u32 s29, 3
    s_cbranch_scc1 W_6
    s_sleep 0
    s_sub_u32 s50, s50, 1
    s_cmp_lg_u32 s50, 0
    s_cbranch_scc1 W_5
W_6:
    s_mov_b64 exec, s[66:67]
    ds_read_b128 v[36:39], v13
    ds_read_b128 v[40:43], v13 offset:16
    s_mov_b64 exec, -1
    v_mov_b32 v124, 0
    s_waitcnt lgkmcnt(0)
    v_add_u32 v125, v124, v36
    v_add_u32 v126, v125, v37
    v_add_u32 v127, v126, v38
    v_add_u32 v128, v127, v39
    v_add_u32 v129, v128, v40
    v_add_u32 v130, v129, v41
    v_add_u32 v131, v130, v42
    v_add_u32 v5, v131, v43
    v_mov_b32 v6, v5
    s_nop 1
    v_add_u32_dpp v6, v6, v6 row_shr:1 row_mask:0xf bank_mask:0xf bound_ctrl:0
    s_nop 1
    v_add_u32_dpp v6, v6, v6 row_shr:2 row_mask:0xf bank_mask:0xf bound_ctrl:0
    s_nop 1
    v_add_u32_dpp v6, v6, v6 row_shr:4 row_mask:0xf bank_mask:0xf bound_ctrl:0
    s_nop 1
    v_add_u32_dpp v6, v6, v6 row_shr:8 row_mask:0xf bank_mask:0xf bound_ctrl:0
    s_nop 1
    v_add_u32_dpp v6, v6, v6 row_bcast:15 row_mask:0xa bank_mask:0xf
    s_nop 1
    v_add_u32_dpp v6, v6, v6 row_bcast:31 row_mask:0xc bank_mask:0xf
    s_lshl_b32 s28, s31, 2
    v_add_u32 v7, s28, v11
    s_mov_b32 exec_lo, 0
    s_mov_b32 exec_hi, 0x80000000
    ds_write_b32 v7, v6 offset:3200
    s_mov_b64 exec, 1
    s_waitcnt lgkmcnt(0)
    ds_add_u32 v15, v3 offset:12
    s_mov_b64 exec, -1
    s_mov_b32 s50, 262144
W_7:
    ds_read_b32 v14, v15 offset:12
    s_waitcnt lgkmcnt(0)
    v_readfirstlane_b32 s29, v14
    s_nop 3
    s_cmp_ge_u32 s29, 6
    s_cbranch_scc1 W_8
    s_sleep 0
    s_sub_u32 s50, s50, 1
    s_cmp_lg_u32 s50, 0
    s_cbranch_scc1 W_7
W_8:
    ds_read_b32 v7, v11 offset:3200
    v_sub_u32 v6, v6, v5
    s_mul_i32 s28, s2, 3136
    s_add_u32 s28, s28, 4259840
    s_add_u32 s40, s26, s28
    s_addc_u32 s41, s27, 0
    s_mul_i32 s28, s2, 12800
    s_add_u32 s28, s28, 5242880
    s_add_u32 s42, s26, s28
    s_addc_u32 s43, s27, 0
    s_min_u32 s28, s31, 1
    s_waitcnt lgkmcnt(0)
    v_mad_u32_u24 v6, v7, s28, v6
    v_add_u32 v124, v6, v124
    v_add_u32 v125, v6, v125
    v_add_u32 v126, v6, v126
    v_add_u32 v127, v6, v127
    v_add_u32 v128, v6, v128
    v_add_u32 v129, v6, v129
    v_add_u32 v130, v6, v130
    v_add_u32 v131, v6, v131
    v_lshl_or_b32 v132, v36, 16, v124
    v_lshl_or_b32 v133, v37, 16, v125
    v_lshl_or_b32 v134, v38, 16, v126
    v_lshl_or_b32 v135, v39, 16, v127
    v_lshl_or_b32 v136, v40, 16, v128
    v_lshl_or_b32 v137, v41, 16, v129
    v_lshl_or_b32 v138, v42, 16, v130
    v_lshl_or_b32 v139, v43, 16, v131
    s_mov_b64 exec, s[66:67]
    s_cbranch_execz BS_9
    ds_write_b128 v13, v[124:127]
    ds_write_b128 v13, v[128:131] offset:16
BS_9:
    s_mov_b64 exec, 1
    s_waitcnt lgkmcnt(0)
    ds_add_u32 v15, v3 offset:12
    s_mov_b64 exec, -1
    s_mov_b32 s50, 262144
W_10:
    ds_read_b32 v14, v15 offset:12
    s_waitcnt lgkmcnt(0)
    v_readfirstlane_b32 s29, v14
    s_nop 3
    s_cmp_ge_u32 s29, 9
    s_cbranch_scc1 W_11
    s_sleep 0
    s_sub_u32 s50, s50, 1
    s_cmp_lg_u32 s50, 0
    s_cbranch_scc1 W_10
W_11:
    s_mov_b64 exec, s[64:65]
    ds_read_b32 v16, v104
    ds_read_b32 v17, v105
    ds_read_b32 v18, v106
    ds_read_b32 v19, v107
    ds_read_b32 v20, v108
    ds_read_b32 v21, v109
    ds_read_b32 v22, v110
    ds_read_b32 v23, v111
    ds_read_b32 v24, v112
    ds_read_b32 v25, v113
    ds_read_b32 v26, v114
    ds_read_b32 v27, v115
    ds_read_b32 v28, v116
    ds_read_b32 v29, v117
    ds_read_b32 v30, v118
    ds_read_b32 v31, v119
    ds_read_b32 v32, v120
    ds_read_b32 v33, v121
    ds_read_b32 v34, v122
    ds_read_b32 v35, v123
    s_waitcnt lgkmcnt(10)
    v_add_u32 v16, v16, v150
    v_lshl_add_u32 v16, v16, 2, v11
    v_add_u32 v17, v17, v151
    v_lshl_add_u32 v17, v17, 2, v11
    v_add_u32 v18, v18, v152
    v_lshl_add_u32 v18, v18, 2, v11
    v_add_u32 v19, v19, v153
    v_lshl_add_u32 v19, v19, 2, v11
    v_add_u32 v20, v20, v154
    v_lshl_add_u32 v20, v20, 2, v11
    v_add_u32 v21, v21, v155
    v_lshl_add_u32 v21, v21, 2, v11
    v_add_u32 v22, v22, v156
    v_lshl_add_u32 v22, v22, 2, v11
    v_add_u32 v23, v23, v157
    v_lshl_add_u32 v23, v23, 2, v11
    v_add_u32 v24, v24, v158
    v_lshl_add_u32 v24, v24, 2, v11
    v_add_u32 v25, v25, v159
    v_lshl_add_u32 v25, v25, 2, v11
    s_waitcnt lgkmcnt(0)
    v_add_u32 v26, v26, v160
    v_lshl_add_u32 v26, v26, 2, v11
    v_add_u32 v27, v27, v161
    v_lshl_add_u32 v27, v27, 2, v11
    v_add_u32 v28, v28, v162
    v_lshl_add_u32 v28, v28, 2, v11
    v_add_u32 v29, v29, v163
    v_lshl_add_u32 v29, v29, 2, v11
    v_add_u32 v30, v30, v164
    v_lshl_add_u32 v30, v30, 2, v11
    v_add_u32 v31, v31, v165
    v_lshl_add_u32 v31, v31, 2, v11
    v_add_u32 v32, v32, v166
    v_lshl_add_u32 v32, v32, 2, v11
    v_add_u32 v33, v33, v167
    v_lshl_add_u32 v33, v33, 2, v11
    v_add_u32 v34, v34, v168
    v_lshl_add_u32 v34, v34, 2, v11
    v_add_u32 v35, v35, v169
    v_lshl_add_u32 v35, v35, 2, v11
    ds_write_b32 v16, v84 offset:4096
    ds_write_b32 v17, v85 offset:4096
    ds_write_b32 v18, v86 offset:4096
    ds_write_b32 v19, v87 offset:4096
    ds_write_b32 v20, v88 offset:4096
    ds_write_b32 v21, v89 offset:4096
    ds_write_b32 v22, v90 offset:4096
    ds_write_b32 v23, v91 offset:4096
    ds_write_b32 v24, v92 offset:4096
    ds_write_b32 v25, v93 offset:4096
    ds_write_b32 v26, v94 offset:4096
    ds_write_b32 v27, v95 offset:4096
    ds_write_b32 v28, v96 offset:4096
    ds_write_b32 v29, v97 offset:4096
    ds_write_b32 v30, v98 offset:4096
    ds_write_b32 v31, v99 offset:4096
    ds_write_b32 v32, v100 offset:4096
    ds_write_b32 v33, v101 offset:4096
    ds_write_b32 v34, v102 offset:4096
    ds_write_b32 v35, v103 offset:4096
    s_mov_b64 exec, 1
    s_waitcnt lgkmcnt(0)
    ds_add_u32 v15, v3 offset:12
    s_mov_b64 exec, -1
    s_mov_b32 s50, 262144
W_12:
    ds_read_b32 v14, v15 offset:12
    s_waitcnt lgkmcnt(0)
    v_readfirstlane_b32 s29, v14
    s_nop 3
    s_cmp_ge_u32 s29, 12
    s_cbranch_scc1 W_13
    s_sleep 0
    s_sub_u32 s50, s50, 1
    s_cmp_lg_u32 s50, 0
    s_cbranch_scc1 W_12
W_13:
    s_setprio 3
    s_mov_b64 exec, s[66:67]
    s_cbranch_execz BS_14
    global_store_dwordx4 v12, v[132:135], s[40:41] sc1
    global_store_dwordx4 v12, v[136:139], s[40:41] offset:16 sc1
BS_14:
    s_mov_b64 exec, s[64:65]
    ds_read_b128 v[16:19], v10 offset:4096
    ds_read_b128 v[20:23], v10 offset:6656
    ds_read_b128 v[24:27], v10 offset:9216
    ds_read_b128 v[28:31], v10 offset:11776
    ds_read_b128 v[32:35], v10 offset:14336
    s_waitcnt lgkmcnt(4)
    global_store_dwordx4 v1, v[16:19], s[42:43] offset:0 sc1
    s_waitcnt lgkmcnt(3)
    global_store_dwordx4 v1, v[20:23], s[42:43] offset:2560 sc1
    s_waitcnt lgkmcnt(2)
    global_store_dwordx4 v2, v[24:27], s[42:43] offset:0 sc1
    s_waitcnt lgkmcnt(1)
    global_store_dwordx4 v2, v[28:31], s[42:43] offset:2560 sc1
    s_waitcnt lgkmcnt(0)
    global_store_dwordx4 v9, v[32:35], s[42:43] offset:0 sc1
    s_mov_b64 exec, -1
    s_waitcnt vmcnt(0)
    s_mov_b64 exec, 1
    ds_add_rtn_u32 v14, v15, v3 offset:16
    s_waitcnt lgkmcnt(0)
    v_readfirstlane_b32 s29, v14
    s_mov_b64 exec, -1
    s_nop 3
    s_cmp_lg_u32 s29, 2
    s_cbranch_scc1 BA_15
    s_lshl_b32 s30, s2, 6
    s_add_u32 s30, s30, 5210112
    s_memrealtime s[82:83]
    v_lshl_add_u32 v6, v0, 3, s30
    s_waitcnt lgkmcnt(0)
    v_mov_b32 v4, s82
    v_mov_b32 v5, s83
    s_mov_b64 exec, 0xff
    global_store_dwordx2 v6, v[4:5], s[26:27] sc1
    s_mov_b64 exec, -1
BA_15:
    v_mov_b32 v6, 2
    v_mov_b32 v7, s61
    s_cmp_ge_u32 s60, 782
    s_cbranch_scc1 F_END
    s_branch F_AGG
F_XAGG:
    s_sub_u32 s60, s2, 245
    s_lshl_b32 s60, s60, 3
    s_add_u32 s60, s60, s3
    s_lshl_b32 s60, s60, 4
    s_add_u32 s60, s60, 15
    s_mul_i32 s61, s3, 12800
    s_mov_b32 s62, 0
    s_waitcnt vmcnt(0)
    v_and_b32 v146, 15, v0
    v_lshlrev_b32 v147, 4, v146
    v_mov_b32 v4, 0x3f80
    v_mov_b32 v5, 0
    v_lshlrev_b64 v[48:49], v147, v[4:5]
    v_mov_b32 v6, v48
    v_mov_b32 v7, v49
    v_cmp_gt_u32 vcc, 4, v146
    v_lshrrev_b32 v147, 2, v146
    v_cmp_eq_u32 s[74:75], 1, v147
    v_cndmask_b32 v48, 0, v6, vcc
    v_cndmask_b32 v49, 0, v7, vcc
    v_cndmask_b32 v50, 0, v6, s[74:75]
    v_cndmask_b32 v51, 0, v7, s[74:75]
    v_lshl_add_u32 v62, v146, 2, s61
    s_add_u32 s28, s61, 256
    v_lshl_add_u32 v63, v146, 8, s28
    v_lshrrev_b32 v147, 3, v0
    v_lshl_add_u32 v60, v147, 1, s61
    v_and_b32 v147, 7, v0
    v_lshlrev_b32 v185, 4, v147
    v_and_b32 v147, 31, v0
    v_lshl_add_u32 v61, v147, 4, s61
    v_mov_b32 v187, v185
    v_mov_b32 v189, v185
    v_mov_b32 v191, v185
    v_mov_b32 v193, v185
    v_mov_b32 v195, v185
    v_mov_b32 v197, v185
    v_mov_b32 v199, v185
    v_mov_b32 v201, v185
    v_mov_b32 v203, v185
    v_mov_b32 v205, v185
    v_mov_b32 v207, v185
    v_mov_b32 v209, v185
    v_mov_b32 v211, v185
    v_mov_b32 v213, v185
    v_mov_b32 v215, v185
    v_mov_b32 v217, v185
    v_mov_b32 v219, v185
    v_mov_b32 v221, v185
    v_mov_b32 v223, v185
    v_mov_b32 v225, v185
    v_mov_b32 v227, v185
    v_mov_b32 v229, v185
    v_mov_b32 v231, v185
    v_mov_b32 v233, v185
    v_mov_b32 v235, v185
    v_mov_b32 v237, v185
    v_mov_b32 v239, v185
    v_mov_b32 v241, v185
    v_mov_b32 v243, v185
    v_lshlrev_b32 v140, 6, v0
    v_add_u32 v141, 4096, v140
    v_add_u32 v144, 8192, v140
    v_min_u32 v142, 52, v0
    v_lshlrev_b32 v142, 6, v142
    v_add_u32 v142, 12288, v142
    v_add_u32 v143, 12288, v140
    v_lshrrev_b32 v146, 1, v0
    v_cmp_eq_u32 vcc, 29, v146
    v_mul_u32_u24 v148, 3136, v0
    v_mul_u32_u24 v149, 12800, v0
    v_cndmask_b32 v143, v143, v140, vcc
    v_mov_b32 v4, 819212500
    v_mov_b32 v5, v4
    v_mov_b32 v6, v4
    v_mov_b32 v7, v4
    v_lshlrev_b32 v146, 4, v0
    v_add_u32 v146, s61, v146
    ds_write_b128 v146, v[4:7] offset:256
    ds_write_b128 v146, v[4:7] offset:1280
    ds_write_b128 v146, v[4:7] offset:2304
    ds_write_b128 v146, v[4:7] offset:3328
    ds_write_b32 v62, v63
    v_mov_b32 v4, 0
    v_mov_b32 v5, 0
    v_mov_b32 v6, 0
    v_mov_b32 v7, 0
    ds_write_b128 v146, v[4:7] offset:4352
    ds_write_b128 v146, v[4:7] offset:5376
    ds_write_b128 v146, v[4:7] offset:6400
    ds_write_b128 v146, v[4:7] offset:7424
    ds_write_b128 v146, v[4:7] offset:8448
    ds_write_b128 v146, v[4:7] offset:9472
    ds_write_b128 v146, v[4:7] offset:10496
    ds_write_b128 v146, v[4:7] offset:11520
    s_mov_b32 exec_hi, 0
    s_mov_b32 exec_lo, 0xffff
    ds_write_b128 v146, v[4:7] offset:12544
    s_mov_b64 exec, -1
    v_mov_b32 v6, 2
    v_mov_b32 v7, s61
F_AGG:
    s_add_u32 s68, s26, 5242880
    s_addc_u32 s69, s27, 0
    s_add_u32 s56, s26, 0
    s_addc_u32 s57, s27, 0
    s_or_b32 s57, s57, 8388608
    s_mov_b32 s58, 12544
    s_mov_b32 s59, 0x00020000
    s_mov_b32 s63, 0
    s_getpc_b64 s[70:71]
AG_PC:
    s_add_u32 s70, s70, AG_PROC-AG_PC
    s_addc_u32 s71, s71, 0
    s_cmp_eq_u32 s62, 2
    s_cbranch_scc1 AG_TOLD
    s_sub_u32 s72, s90, 1000
    s_subb_u32 s73, s91, 0
    s_add_u32 s74, s90, 0x10000000
    s_addc_u32 s75, s91, 0
    s_sub_u32 s44, s90, 500
    s_subb_u32 s45, s91, 0
    s_add_u32 s46, s90, 0x10000000
    s_addc_u32 s47, s91, 0
    s_setprio 3
    s_add_u32 s76, s26, 5177344
    s_addc_u32 s77, s27, 0
    s_add_u32 s78, s26, 5210112
    s_addc_u32 s79, s27, 0
    s_mov_b32 s50, 262144
AG_W:
    global_load_dwordx2 v[24:25], v140, s[78:79] sc1
    global_load_dwordx2 v[26:27], v141, s[78:79] sc1
    global_load_dwordx2 v[28:29], v144, s[78:79] sc1
    global_load_dwordx2 v[30:31], v143, s[78:79] sc1
    global_load_dwordx2 v[32:33], v140, s[76:77] sc1
    global_load_dwordx2 v[34:35], v141, s[76:77] sc1
    global_load_dwordx2 v[36:37], v144, s[76:77] sc1
    global_load_dwordx2 v[38:39], v142, s[76:77] sc1
    s_mov_b64 s[80:81], -1
    s_waitcnt vmcnt(0)
    v_cmp_le_u64 vcc, s[44:45], v[24:25]
    v_cmp_ge_u64 s[40:41], s[46:47], v[24:25]
    s_nop 3
    s_and_b64 s[40:41], s[40:41], vcc
    s_and_b64 s[80:81], s[80:81], s[40:41]
    v_cmp_le_u64 vcc, s[44:45], v[26:27]
    v_cmp_ge_u64 s[40:41], s[46:47], v[26:27]
    s_nop 3
    s_and_b64 s[40:41], s[40:41], vcc
    s_and_b64 s[80:81], s[80:81], s[40:41]
    v_cmp_le_u64 vcc, s[44:45], v[28:29]
    v_cmp_ge_u64 s[40:41], s[46:47], v[28:29]
    s_nop 3
    s_and_b64 s[40:41], s[40:41], vcc
    s_and_b64 s[80:81], s[80:81], s[40:41]
    v_cmp_le_u64 vcc, s[44:45], v[30:31]
    v_cmp_ge_u64 s[40:41], s[46:47], v[30:31]
    s_nop 3
    s_and_b64 s[40:41], s[40:41], vcc
    s_and_b64 s[80:81], s[80:81], s[40:41]
    v_cmp_le_u64 vcc, s[72:73], v[32:33]
    v_cmp_ge_u64 s[40:41], s[74:75], v[32:33]
    s_nop 3
    s_and_b64 s[40:41], s[40:41], vcc
    s_and_b64 s[80:81], s[80:81], s[40:41]
    v_cmp_le_u64 vcc, s[72:73], v[34:35]
    v_cmp_ge_u64 s[40:41], s[74:75], v[34:35]
    s_nop 3
    s_and_b64 s[40:41], s[40:41], vcc
    s_and_b64 s[80:81], s[80:81], s[40:41]
    v_cmp_le_u64 vcc, s[72:73], v[36:37]
    v_cmp_ge_u64 s[40:41], s[74:75], v[36:37]
    s_nop 3
    s_and_b64 s[40:41], s[40:41], vcc
    s_and_b64 s[80:81], s[80:81], s[40:41]
    v_cmp_le_u64 vcc, s[72:73], v[38:39]
    v_cmp_ge_u64 s[40:41], s[74:75], v[38:39]
    s_nop 3
    s_and_b64 s[40:41], s[40:41], vcc
    s_and_b64 s[80:81], s[80:81], s[40:41]
    s_cmp_eq_u64 s[80:81], -1
    s_cbranch_scc1 AG_GO
    s_sleep 6
    s_sub_u32 s50, s50, 1
    s_and_b32 s28, s50, 31
    s_cmp_lg_u32 s28, 0
    s_cbranch_scc1 EP_16
    v_mov_b32 v42, 0
    global_load_dwordx2 v[40:41], v42, s[24:25] sc1
    s_waitcnt vmcnt(0)
    v_readfirstlane_b32 s28, v40
    v_readfirstlane_b32 s29, v41
    s_nop 3
    s_cmp_eq_u64 s[28:29], 0
    s_cbranch_scc1 EP_16
    s_not_b64 s[72:73], s[28:29]
    s_not_b64 s[44:45], s[28:29]
EP_16:
    s_cmp_lg_u32 s50, 0
    s_cbranch_scc1 AG_W
AG_GO:
    v_mov_b32 v13, 1
    ds_write_b32 v15, v13 offset:20
    s_cmp_eq_u32 s3, 5
    s_cbranch_scc1 AG_WL
    s_branch AG_START
AG_TOLD:
    s_mov_b32 s50, 262144
W_17:
    ds_read_b32 v13, v15 offset:20
    s_waitcnt lgkmcnt(0)
    v_readfirstlane_b32 s29, v13
    s_nop 3
    s_cmp_ge_u32 s29, 1
    s_cbranch_scc1 W_18
    s_sleep 8
    s_sub_u32 s50, s50, 1
    s_cmp_lg_u32 s50, 0
    s_cbranch_scc1 W_17
W_18:
    s_branch AG_START
AG_WL:
    s_add_u32 s72, s26, 4194304
    s_addc_u32 s73, s27, 0
    s_mov_b32 s74, 16384
    s_mov_b32 s75, 0x00020000
    v_lshlrev_b32 v13, 4, v0
    s_mov_b32 s28, 0
    s_mov_b32 s29, 112128
    s_mov_b32 m0, s29
    s_add_u32 s29, s29, 4096
    buffer_load_dwordx4 v13, s[72:75], s28 offen offset:0 sc1 lds
    buffer_load_dwordx4 v13, s[72:75], s28 offen offset:1024 sc1 lds
    buffer_load_dwordx4 v13, s[72:75], s28 offen offset:2048 sc1 lds
    buffer_load_dwordx4 v13, s[72:75], s28 offen offset:3072 sc1 lds
    s_add_u32 s28, s28, 4096
    s_mov_b32 m0, s29
    s_add_u32 s29, s29, 4096
    buffer_load_dwordx4 v13, s[72:75], s28 offen offset:0 sc1 lds
    buffer_load_dwordx4 v13, s[72:75], s28 offen offset:1024 sc1 lds
    buffer_load_dwordx4 v13, s[72:75], s28 offen offset:2048 sc1 lds
    buffer_load_dwordx4 v13, s[72:75], s28 offen offset:3072 sc1 lds
    s_add_u32 s28, s28, 4096
    s_mov_b32 m0, s29
    s_add_u32 s29, s29, 4096
    buffer_load_dwordx4 v13, s[72:75], s28 offen offset:0 sc1 lds
    buffer_load_dwordx4 v13, s[72:75], s28 offen offset:1024 sc1 lds
    buffer_load_dwordx4 v13, s[72:75], s28 offen offset:2048 sc1 lds
    buffer_load_dwordx4 v13, s[72:75], s28 offen offset:3072 sc1 lds
    s_add_u32 s28, s28, 4096
    s_mov_b32 m0, s29
    s_add_u32 s29, s29, 4096
    buffer_load_dwordx4 v13, s[72:75], s28 offen offset:0 sc1 lds
    buffer_load_dwordx4 v13, s[72:75], s28 offen offset:1024 sc1 lds
    buffer_load_dwordx4 v13, s[72:75], s28 offen offset:2048 sc1 lds
    buffer_load_dwordx4 v13, s[72:75], s28 offen offset:3072 sc1 lds
    s_add_u32 s28, s28, 4096
    s_waitcnt vmcnt(0)
    v_mov_b32 v13, 1
    ds_write_b32 v15, v13 offset:32
AG_START:
    s_setprio 0
    s_lshl_b32 s29, s60, 2
    s_add_u32 s64, s26, 4259840
    s_addc_u32 s65, s27, 0
    s_mov_b32 s66, 784000
    s_mov_b32 s67, 0x00020000
    s_add_u32 s28, s29, 0
    buffer_load_dword v8, v148, s[64:67], s28 offen sc1
    s_add_u32 s28, s29, 200704
    buffer_load_dword v9, v148, s[64:67], s28 offen sc1
    s_add_u32 s28, s29, 401408
    buffer_load_dword v10, v148, s[64:67], s28 offen sc1
    s_add_u32 s28, s29, 602112
    buffer_load_dword v11, v148, s[64:67], s28 offen sc1
    v_mov_b32 v3, v149
    s_waitcnt vmcnt(0) lgkmcnt(0)
    v_and_b32 v2, 0xffff, v8
    v_lshl_add_u32 v244, v2, 2, v3
    v_lshrrev_b32 v8, 16, v8
    v_add_u32 v3, 819200, v3
    v_and_b32 v2, 0xffff, v9
    v_lshl_add_u32 v245, v2, 2, v3
    v_lshrrev_b32 v9, 16, v9
    v_add_u32 v3, 819200, v3
    v_and_b32 v2, 0xffff, v10
    v_lshl_add_u32 v246, v2, 2, v3
    v_lshrrev_b32 v10, 16, v10
    v_add_u32 v3, 819200, v3
    v_and_b32 v2, 0xffff, v11
    v_lshl_add_u32 v247, v2, 2, v3
    v_lshrrev_b32 v11, 16, v11
    s_cmp_lg_u32 s63, 0
    s_cbranch_scc1 AG_ROUND
AG_FAST:
    v_cmpx_lt_u32 vcc, 0, v8
    s_cbranch_execz AGL_19
    global_load_dwordx4 v[64:67], v244, s[68:69] offset:0 sc1
    v_cmpx_lt_u32 vcc, 4, v8
    s_cbranch_execz AGL_19
    global_load_dwordx4 v[68:71], v244, s[68:69] offset:16 sc1
    v_cmpx_lt_u32 vcc, 8, v8
    s_cbranch_execz AGL_19
    global_load_dwordx4 v[72:75], v244, s[68:69] offset:32 sc1
AGL_19:
    s_mov_b64 exec, -1
    v_cmpx_lt_u32 vcc, 0, v9
    s_cbranch_execz AGL_20
    global_load_dwordx4 v[76:79], v245, s[68:69] offset:0 sc1
    v_cmpx_lt_u32 vcc, 4, v9
    s_cbranch_execz AGL_20
    global_load_dwordx4 v[80:83], v245, s[68:69] offset:16 sc1
    v_cmpx_lt_u32 vcc, 8, v9
    s_cbranch_execz AGL_20
    global_load_dwordx4 v[84:87], v245, s[68:69] offset:32 sc1
AGL_20:
    s_mov_b64 exec, -1
    v_cmpx_lt_u32 vcc, 0, v10
    s_cbranch_execz AGL_21
    global_load_dwordx4 v[88:91], v246, s[68:69] offset:0 sc1
    v_cmpx_lt_u32 vcc, 4, v10
    s_cbranch_execz AGL_21
    global_load_dwordx4 v[92:95], v246, s[68:69] offset:16 sc1
    v_cmpx_lt_u32 vcc, 8, v10
    s_cbranch_execz AGL_21
    global_load_dwordx4 v[96:99], v246, s[68:69] offset:32 sc1
AGL_21:
    s_mov_b64 exec, -1
    v_cmpx_lt_u32 vcc, 0, v11
    s_cbranch_execz AGL_22
    global_load_dwordx4 v[100:103], v247, s[68:69] offset:0 sc1
    v_cmpx_lt_u32 vcc, 4, v11
    s_cbranch_execz AGL_22
    global_load_dwordx4 v[104:107], v247, s[68:69] offset:16 sc1
    v_cmpx_lt_u32 vcc, 8, v11
    s_cbranch_execz AGL_22
    global_load_dwordx4 v[108:111], v247, s[68:69] offset:32 sc1
AGL_22:
    s_mov_b64 exec, -1
    s_waitcnt vmcnt(0)
    s_mov_b32 s30, 0
    s_mov_b32 s31, 0
    v_cmpx_lt_u32 vcc, 0, v8
    s_cbranch_execz AGO_23
    v_add_u32_sdwa v112, v64, v7 dst_sel:DWORD dst_unused:UNUSED_PAD src0_sel:WORD_1 src1_sel:DWORD
    s_mov_b64 s[32:33], exec
    s_mov_b32 s30, 1
    ds_add_rtn_u32 v112, v112, v6
    v_cmpx_lt_u32 vcc, 1, v8
    s_cbranch_execz AGO_23
    v_add_u32_sdwa v113, v65, v7 dst_sel:DWORD dst_unused:UNUSED_PAD src0_sel:WORD_1 src1_sel:DWORD
    s_mov_b64 s[34:35], exec
    s_mov_b32 s30, 2
    ds_add_rtn_u32 v113, v113, v6
    v_cmpx_lt_u32 vcc, 2, v8
    s_cbranch_execz AGO_23
    v_add_u32_sdwa v114, v66, v7 dst_sel:DWORD dst_unused:UNUSED_PAD src0_sel:WORD_1 src1_sel:DWORD
    s_mov_b64 s[36:37], exec
    s_mov_b32 s30, 3
    ds_add_rtn_u32 v114, v114, v6
    v_cmpx_lt_u32 vcc, 3, v8
    s_cbranch_execz AGO_23
    v_add_u32_sdwa v115, v67, v7 dst_sel:DWORD dst_unused:UNUSED_PAD src0_sel:WORD_1 src1_sel:DWORD
    s_mov_b64 s[38:39], exec
    s_mov_b32 s30, 4
    ds_add_rtn_u32 v115, v115, v6
    v_cmpx_lt_u32 vcc, 4, v8
    s_cbranch_execz AGO_23
    v_add_u32_sdwa v116, v68, v7 dst_sel:DWORD dst_unused:UNUSED_PAD src0_sel:WORD_1 src1_sel:DWORD
    s_mov_b64 s[40:41], exec
    s_mov_b32 s30, 5
    ds_add_rtn_u32 v116, v116, v6
    v_cmpx_lt_u32 vcc, 5, v8
    s_cbranch_execz AGO_23
    v_add_u32_sdwa v117, v69, v7 dst_sel:DWORD dst_unused:UNUSED_PAD src0_sel:WORD_1 src1_sel:DWORD
    s_mov_b64 s[42:43], exec
    s_mov_b32 s30, 6
    ds_add_rtn_u32 v117, v117, v6
    v_cmpx_lt_u32 vcc, 6, v8
    s_cbranch_execz AGO_23
    v_add_u32_sdwa v118, v70, v7 dst_sel:DWORD dst_unused:UNUSED_PAD src0_sel:WORD_1 src1_sel:DWORD
    s_mov_b64 s[44:45], exec
    s_mov_b32 s30, 7
    ds_add_rtn_u32 v118, v118, v6
    v_cmpx_lt_u32 vcc, 7, v8
    s_cbranch_execz AGO_23
    v_add_u32_sdwa v119, v71, v7 dst_sel:DWORD dst_unused:UNUSED_PAD src0_sel:WORD_1 src1_sel:DWORD
    s_mov_b64 s[46:47], exec
    s_mov_b32 s30, 8
    ds_add_rtn_u32 v119, v119, v6
    v_cmpx_lt_u32 vcc, 8, v8
    s_cbranch_execz AGO_23
    v_add_u32_sdwa v120, v72, v7 dst_sel:DWORD dst_unused:UNUSED_PAD src0_sel:WORD_1 src1_sel:DWORD
    s_mov_b64 s[48:49], exec
    s_mov_b32 s30, 9
    ds_add_rtn_u32 v120, v120, v6
    v_cmpx_lt_u32 vcc, 9, v8
    s_cbranch_execz AGO_23
    v_add_u32_sdwa v121, v73, v7 dst_sel:DWORD dst_unused:UNUSED_PAD src0_sel:WORD_1 src1_sel:DWORD
    s_mov_b64 s[50:51], exec
    s_mov_b32 s30, 10
    ds_add_rtn_u32 v121, v121, v6
    v_cmpx_lt_u32 vcc, 10, v8
    s_cbranch_execz AGO_23
    v_add_u32_sdwa v122, v74, v7 dst_sel:DWORD dst_unused:UNUSED_PAD src0_sel:WORD_1 src1_sel:DWORD
    s_mov_b64 s[52:53], exec
    s_mov_b32 s30, 11
    ds_add_rtn_u32 v122, v122, v6
    v_cmpx_lt_u32 vcc, 11, v8
    s_cbranch_execz AGO_23
    v_add_u32_sdwa v123, v75, v7 dst_sel:DWORD dst_unused:UNUSED_PAD src0_sel:WORD_1 src1_sel:DWORD
    s_mov_b64 s[54:55], exec
    s_mov_b32 s30, 12
    ds_add_rtn_u32 v123, v123, v6
AGO_23:
    s_mov_b64 exec, -1
    v_cmpx_lt_u32 vcc, 0, v9
    s_cbranch_execz AGO_24
    v_add_u32_sdwa v124, v76, v7 dst_sel:DWORD dst_unused:UNUSED_PAD src0_sel:WORD_1 src1_sel:DWORD
    s_mov_b64 s[72:73], exec
    s_mov_b32 s31, 1
    ds_add_rtn_u32 v124, v124, v6
    v_cmpx_lt_u32 vcc, 1, v9
    s_cbranch_execz AGO_24
    v_add_u32_sdwa v125, v77, v7 dst_sel:DWORD dst_unused:UNUSED_PAD src0_sel:WORD_1 src1_sel:DWORD
    s_mov_b64 s[74:75], exec
    s_mov_b32 s31, 2
    ds_add_rtn_u32 v125, v125, v6
    v_cmpx_lt_u32 vcc, 2, v9
    s_cbranch_execz AGO_24
    v_add_u32_sdwa v126, v78, v7 dst_sel:DWORD dst_unused:UNUSED_PAD src0_sel:WORD_1 src1_sel:DWORD
    s_mov_b64 s[76:77], exec
    s_mov_b32 s31, 3
    ds_add_rtn_u32 v126, v126, v6
    v_cmpx_lt_u32 vcc, 3, v9
    s_cbranch_execz AGO_24
    v_add_u32_sdwa v127, v79, v7 dst_sel:DWORD dst_unused:UNUSED_PAD src0_sel:WORD_1 src1_sel:DWORD
    s_mov_b64 s[78:79], exec
    s_mov_b32 s31, 4
    ds_add_rtn_u32 v127, v127, v6
    v_cmpx_lt_u32 vcc, 4, v9
    s_cbranch_execz AGO_24
    v_add_u32_sdwa v128, v80, v7 dst_sel:DWORD dst_unused:UNUSED_PAD src0_sel:WORD_1 src1_sel:DWORD
    s_mov_b64 s[80:81], exec
    s_mov_b32 s31, 5
    ds_add_rtn_u32 v128, v128, v6
    v_cmpx_lt_u32 vcc, 5, v9
    s_cbranch_execz AGO_24
    v_add_u32_sdwa v129, v81, v7 dst_sel:DWORD dst_unused:UNUSED_PAD src0_sel:WORD_1 src1_sel:DWORD
    s_mov_b64 s[82:83], exec
    s_mov_b32 s31, 6
    ds_add_rtn_u32 v129, v129, v6
    v_cmpx_lt_u32 vcc, 6, v9
    s_cbranch_execz AGO_24
    v_add_u32_sdwa v130, v82, v7 dst_sel:DWORD dst_unused:UNUSED_PAD src0_sel:WORD_1 src1_sel:DWORD
    s_mov_b64 s[84:85], exec
    s_mov_b32 s31, 7
    ds_add_rtn_u32 v130, v130, v6
    v_cmpx_lt_u32 vcc, 7, v9
    s_cbranch_execz AGO_24
    v_add_u32_sdwa v131, v83, v7 dst_sel:DWORD dst_unused:UNUSED_PAD src0_sel:WORD_1 src1_sel:DWORD
    s_mov_b64 s[86:87], exec
    s_mov_b32 s31, 8
    ds_add_rtn_u32 v131, v131, v6
    v_cmpx_lt_u32 vcc, 8, v9
    s_cbranch_execz AGO_24
    v_add_u32_sdwa v132, v84, v7 dst_sel:DWORD dst_unused:UNUSED_PAD src0_sel:WORD_1 src1_sel:DWORD
    s_mov_b64 s[88:89], exec
    s_mov_b32 s31, 9
    ds_add_rtn_u32 v132, v132, v6
    v_cmpx_lt_u32 vcc, 9, v9
    s_cbranch_execz AGO_24
    v_add_u32_sdwa v133, v85, v7 dst_sel:DWORD dst_unused:UNUSED_PAD src0_sel:WORD_1 src1_sel:DWORD
    s_mov_b64 s[64:65], exec
    s_mov_b32 s31, 10
    ds_add_rtn_u32 v133, v133, v6
    v_cmpx_lt_u32 vcc, 10, v9
    s_cbranch_execz AGO_24
    v_add_u32_sdwa v134, v86, v7 dst_sel:DWORD dst_unused:UNUSED_PAD src0_sel:WORD_1 src1_sel:DWORD
    s_mov_b64 s[66:67], exec
    s_mov_b32 s31, 11
    ds_add_rtn_u32 v134, v134, v6
    v_cmpx_lt_u32 vcc, 11, v9
    s_cbranch_execz AGO_24
    v_add_u32_sdwa v135, v87, v7 dst_sel:DWORD dst_unused:UNUSED_PAD src0_sel:WORD_1 src1_sel:DWORD
    s_mov_b64 s[28:29], exec
    s_mov_b32 s31, 12
    ds_add_rtn_u32 v135, v135, v6
AGO_24:
    s_mov_b64 exec, -1
    s_waitcnt lgkmcnt(0)
    s_cmp_le_u32 s30, 0
    s_cbranch_scc1 AGO_25
    s_mov_b64 exec, s[32:33]
    ds_write_b16 v112, v64
    s_cmp_le_u32 s30, 1
    s_cbranch_scc1 AGO_25
    s_mov_b64 exec, s[34:35]
    ds_write_b16 v113, v65
    s_cmp_le_u32 s30, 2
    s_cbranch_scc1 AGO_25
    s_mov_b64 exec, s[36:37]
    ds_write_b16 v114, v66
    s_cmp_le_u32 s30, 3
    s_cbranch_scc1 AGO_25
    s_mov_b64 exec, s[38:39]
    ds_write_b16 v115, v67
    s_cmp_le_u32 s30, 4
    s_cbranch_scc1 AGO_25
    s_mov_b64 exec, s[40:41]
    ds_write_b16 v116, v68
    s_cmp_le_u32 s30, 5
    s_cbranch_scc1 AGO_25
    s_mov_b64 exec, s[42:43]
    ds_write_b16 v117, v69
    s_cmp_le_u32 s30, 6
    s_cbranch_scc1 AGO_25
    s_mov_b64 exec, s[44:45]
    ds_write_b16 v118, v70
    s_cmp_le_u32 s30, 7
    s_cbranch_scc1 AGO_25
    s_mov_b64 exec, s[46:47]
    ds_write_b16 v119, v71
    s_cmp_le_u32 s30, 8
    s_cbranch_scc1 AGO_25
    s_mov_b64 exec, s[48:49]
    ds_write_b16 v120, v72
    s_cmp_le_u32 s30, 9
    s_cbranch_scc1 AGO_25
    s_mov_b64 exec, s[50:51]
    ds_write_b16 v121, v73
    s_cmp_le_u32 s30, 10
    s_cbranch_scc1 AGO_25
    s_mov_b64 exec, s[52:53]
    ds_write_b16 v122, v74
    s_cmp_le_u32 s30, 11
    s_cbranch_scc1 AGO_25
    s_mov_b64 exec, s[54:55]
    ds_write_b16 v123, v75
AGO_25:
    s_mov_b64 exec, -1
    s_cmp_le_u32 s31, 0
    s_cbranch_scc1 AGO_26
    s_mov_b64 exec, s[72:73]
    ds_write_b16 v124, v76
    s_cmp_le_u32 s31, 1
    s_cbranch_scc1 AGO_26
    s_mov_b64 exec, s[74:75]
    ds_write_b16 v125, v77
    s_cmp_le_u32 s31, 2
    s_cbranch_scc1 AGO_26
    s_mov_b64 exec, s[76:77]
    ds_write_b16 v126, v78
    s_cmp_le_u32 s31, 3
    s_cbranch_scc1 AGO_26
    s_mov_b64 exec, s[78:79]
    ds_write_b16 v127, v79
    s_cmp_le_u32 s31, 4
    s_cbranch_scc1 AGO_26
    s_mov_b64 exec, s[80:81]
    ds_write_b16 v128, v80
    s_cmp_le_u32 s31, 5
    s_cbranch_scc1 AGO_26
    s_mov_b64 exec, s[82:83]
    ds_write_b16 v129, v81
    s_cmp_le_u32 s31, 6
    s_cbranch_scc1 AGO_26
    s_mov_b64 exec, s[84:85]
    ds_write_b16 v130, v82
    s_cmp_le_u32 s31, 7
    s_cbranch_scc1 AGO_26
    s_mov_b64 exec, s[86:87]
    ds_write_b16 v131, v83
    s_cmp_le_u32 s31, 8
    s_cbranch_scc1 AGO_26
    s_mov_b64 exec, s[88:89]
    ds_write_b16 v132, v84
    s_cmp_le_u32 s31, 9
    s_cbranch_scc1 AGO_26
    s_mov_b64 exec, s[64:65]
    ds_write_b16 v133, v85
    s_cmp_le_u32 s31, 10
    s_cbranch_scc1 AGO_26
    s_mov_b64 exec, s[66:67]
    ds_write_b16 v134, v86
    s_cmp_le_u32 s31, 11
    s_cbranch_scc1 AGO_26
    s_mov_b64 exec, s[28:29]
    ds_write_b16 v135, v87
AGO_26:
    s_mov_b64 exec, -1
    s_mov_b32 s30, 0
    s_mov_b32 s31, 0
    v_cmpx_lt_u32 vcc, 0, v10
    s_cbranch_execz AGO_27
    v_add_u32_sdwa v112, v88, v7 dst_sel:DWORD dst_unused:UNUSED_PAD src0_sel:WORD_1 src1_sel:DWORD
    s_mov_b64 s[32:33], exec
    s_mov_b32 s30, 1
    ds_add_rtn_u32 v112, v112, v6
    v_cmpx_lt_u32 vcc, 1, v10
    s_cbranch_execz AGO_27
    v_add_u32_sdwa v113, v89, v7 dst_sel:DWORD dst_unused:UNUSED_PAD src0_sel:WORD_1 src1_sel:DWORD
    s_mov_b64 s[34:35], exec
    s_mov_b32 s30, 2
    ds_add_rtn_u32 v113, v113, v6
    v_cmpx_lt_u32 vcc, 2, v10
    s_cbranch_execz AGO_27
    v_add_u32_sdwa v114, v90, v7 dst_sel:DWORD dst_unused:UNUSED_PAD src0_sel:WORD_1 src1_sel:DWORD
    s_mov_b64 s[36:37], exec
    s_mov_b32 s30, 3
    ds_add_rtn_u32 v114, v114, v6
    v_cmpx_lt_u32 vcc, 3, v10
    s_cbranch_execz AGO_27
    v_add_u32_sdwa v115, v91, v7 dst_sel:DWORD dst_unused:UNUSED_PAD src0_sel:WORD_1 src1_sel:DWORD
    s_mov_b64 s[38:39], exec
    s_mov_b32 s30, 4
    ds_add_rtn_u32 v115, v115, v6
    v_cmpx_lt_u32 vcc, 4, v10
    s_cbranch_execz AGO_27
    v_add_u32_sdwa v116, v92, v7 dst_sel:DWORD dst_unused:UNUSED_PAD src0_sel:WORD_1 src1_sel:DWORD
    s_mov_b64 s[40:41], exec
    s_mov_b32 s30, 5
    ds_add_rtn_u32 v116, v116, v6
    v_cmpx_lt_u32 vcc, 5, v10
    s_cbranch_execz AGO_27
    v_add_u32_sdwa v117, v93, v7 dst_sel:DWORD dst_unused:UNUSED_PAD src0_sel:WORD_1 src1_sel:DWORD
    s_mov_b64 s[42:43], exec
    s_mov_b32 s30, 6
    ds_add_rtn_u32 v117, v117, v6
    v_cmpx_lt_u32 vcc, 6, v10
    s_cbranch_execz AGO_27
    v_add_u32_sdwa v118, v94, v7 dst_sel:DWORD dst_unused:UNUSED_PAD src0_sel:WORD_1 src1_sel:DWORD
    s_mov_b64 s[44:45], exec
    s_mov_b32 s30, 7
    ds_add_rtn_u32 v118, v118, v6
    v_cmpx_lt_u32 vcc, 7, v10
    s_cbranch_execz AGO_27
    v_add_u32_sdwa v119, v95, v7 dst_sel:DWORD dst_unused:UNUSED_PAD src0_sel:WORD_1 src1_sel:DWORD
    s_mov_b64 s[46:47], exec
    s_mov_b32 s30, 8
    ds_add_rtn_u32 v119, v119, v6
    v_cmpx_lt_u32 vcc, 8, v10
    s_cbranch_execz AGO_27
    v_add_u32_sdwa v120, v96, v7 dst_sel:DWORD dst_unused:UNUSED_PAD src0_sel:WORD_1 src1_sel:DWORD
    s_mov_b64 s[48:49], exec
    s_mov_b32 s30, 9
    ds_add_rtn_u32 v120, v120, v6
    v_cmpx_lt_u32 vcc, 9, v10
    s_cbranch_execz AGO_27
    v_add_u32_sdwa v121, v97, v7 dst_sel:DWORD dst_unused:UNUSED_PAD src0_sel:WORD_1 src1_sel:DWORD
    s_mov_b64 s[50:51], exec
    s_mov_b32 s30, 10
    ds_add_rtn_u32 v121, v121, v6
    v_cmpx_lt_u32 vcc, 10, v10
    s_cbranch_execz AGO_27
    v_add_u32_sdwa v122, v98, v7 dst_sel:DWORD dst_unused:UNUSED_PAD src0_sel:WORD_1 src1_sel:DWORD
    s_mov_b64 s[52:53], exec
    s_mov_b32 s30, 11
    ds_add_rtn_u32 v122, v122, v6
    v_cmpx_lt_u32 vcc, 11, v10
    s_cbranch_execz AGO_27
    v_add_u32_sdwa v123, v99, v7 dst_sel:DWORD dst_unused:UNUSED_PAD src0_sel:WORD_1 src1_sel:DWORD
    s_mov_b64 s[54:55], exec
    s_mov_b32 s30, 12
    ds_add_rtn_u32 v123, v123, v6
AGO_27:
    s_mov_b64 exec, -1
    v_cmpx_lt_u32 vcc, 0, v11
    s_cbranch_execz AGO_28
    v_add_u32_sdwa v124, v100, v7 dst_sel:DWORD dst_unused:UNUSED_PAD src0_sel:WORD_1 src1_sel:DWORD
    s_mov_b64 s[72:73], exec
    s_mov_b32 s31, 1
    ds_add_rtn_u32 v124, v124, v6
    v_cmpx_lt_u32 vcc, 1, v11
    s_cbranch_execz AGO_28
    v_add_u32_sdwa v125, v101, v7 dst_sel:DWORD dst_unused:UNUSED_PAD src0_sel:WORD_1 src1_sel:DWORD
    s_mov_b64 s[74:75], exec
    s_mov_b32 s31, 2
    ds_add_rtn_u32 v125, v125, v6
    v_cmpx_lt_u32 vcc, 2, v11
    s_cbranch_execz AGO_28
    v_add_u32_sdwa v126, v102, v7 dst_sel:DWORD dst_unused:UNUSED_PAD src0_sel:WORD_1 src1_sel:DWORD
    s_mov_b64 s[76:77], exec
    s_mov_b32 s31, 3
    ds_add_rtn_u32 v126, v126, v6
    v_cmpx_lt_u32 vcc, 3, v11
    s_cbranch_execz AGO_28
    v_add_u32_sdwa v127, v103, v7 dst_sel:DWORD dst_unused:UNUSED_PAD src0_sel:WORD_1 src1_sel:DWORD
    s_mov_b64 s[78:79], exec
    s_mov_b32 s31, 4
    ds_add_rtn_u32 v127, v127, v6
    v_cmpx_lt_u32 vcc, 4, v11
    s_cbranch_execz AGO_28
    v_add_u32_sdwa v128, v104, v7 dst_sel:DWORD dst_unused:UNUSED_PAD src0_sel:WORD_1 src1_sel:DWORD
    s_mov_b64 s[80:81], exec
    s_mov_b32 s31, 5
    ds_add_rtn_u32 v128, v128, v6
    v_cmpx_lt_u32 vcc, 5, v11
    s_cbranch_execz AGO_28
    v_add_u32_sdwa v129, v105, v7 dst_sel:DWORD dst_unused:UNUSED_PAD src0_sel:WORD_1 src1_sel:DWORD
    s_mov_b64 s[82:83], exec
    s_mov_b32 s31, 6
    ds_add_rtn_u32 v129, v129, v6
    v_cmpx_lt_u32 vcc, 6, v11
    s_cbranch_execz AGO_28
    v_add_u32_sdwa v130, v106, v7 dst_sel:DWORD dst_unused:UNUSED_PAD src0_sel:WORD_1 src1_sel:DWORD
    s_mov_b64 s[84:85], exec
    s_mov_b32 s31, 7
    ds_add_rtn_u32 v130, v130, v6
    v_cmpx_lt_u32 vcc, 7, v11
    s_cbranch_execz AGO_28
    v_add_u32_sdwa v131, v107, v7 dst_sel:DWORD dst_unused:UNUSED_PAD src0_sel:WORD_1 src1_sel:DWORD
    s_mov_b64 s[86:87], exec
    s_mov_b32 s31, 8
    ds_add_rtn_u32 v131, v131, v6
    v_cmpx_lt_u32 vcc, 8, v11
    s_cbranch_execz AGO_28
    v_add_u32_sdwa v132, v108, v7 dst_sel:DWORD dst_unused:UNUSED_PAD src0_sel:WORD_1 src1_sel:DWORD
    s_mov_b64 s[88:89], exec
    s_mov_b32 s31, 9
    ds_add_rtn_u32 v132, v132, v6
    v_cmpx_lt_u32 vcc, 9, v11
    s_cbranch_execz AGO_28
    v_add_u32_sdwa v133, v109, v7 dst_sel:DWORD dst_unused:UNUSED_PAD src0_sel:WORD_1 src1_sel:DWORD
    s_mov_b64 s[64:65], exec
    s_mov_b32 s31, 10
    ds_add_rtn_u32 v133, v133, v6
    v_cmpx_lt_u32 vcc, 10, v11
    s_cbranch_execz AGO_28
    v_add_u32_sdwa v134, v110, v7 dst_sel:DWORD dst_unused:UNUSED_PAD src0_sel:WORD_1 src1_sel:DWORD
    s_mov_b64 s[66:67], exec
    s_mov_b32 s31, 11
    ds_add_rtn_u32 v134, v134, v6
    v_cmpx_lt_u32 vcc, 11, v11
    s_cbranch_execz AGO_28
    v_add_u32_sdwa v135, v111, v7 dst_sel:DWORD dst_unused:UNUSED_PAD src0_sel:WORD_1 src1_sel:DWORD
    s_mov_b64 s[28:29], exec
    s_mov_b32 s31, 12
    ds_add_rtn_u32 v135, v135, v6
AGO_28:
    s_mov_b64 exec, -1
    s_waitcnt lgkmcnt(0)
    s_cmp_le_u32 s30, 0
    s_cbranch_scc1 AGO_29
    s_mov_b64 exec, s[32:33]
    ds_write_b16 v112, v88
    s_cmp_le_u32 s30, 1
    s_cbranch_scc1 AGO_29
    s_mov_b64 exec, s[34:35]
    ds_write_b16 v113, v89
    s_cmp_le_u32 s30, 2
    s_cbranch_scc1 AGO_29
    s_mov_b64 exec, s[36:37]
    ds_write_b16 v114, v90
    s_cmp_le_u32 s30, 3
    s_cbranch_scc1 AGO_29
    s_mov_b64 exec, s[38:39]
    ds_write_b16 v115, v91
    s_cmp_le_u32 s30, 4
    s_cbranch_scc1 AGO_29
    s_mov_b64 exec, s[40:41]
    ds_write_b16 v116, v92
    s_cmp_le_u32 s30, 5
    s_cbranch_scc1 AGO_29
    s_mov_b64 exec, s[42:43]
    ds_write_b16 v117, v93
    s_cmp_le_u32 s30, 6
    s_cbranch_scc1 AGO_29
    s_mov_b64 exec, s[44:45]
    ds_write_b16 v118, v94
    s_cmp_le_u32 s30, 7
    s_cbranch_scc1 AGO_29
    s_mov_b64 exec, s[46:47]
    ds_write_b16 v119, v95
    s_cmp_le_u32 s30, 8
    s_cbranch_scc1 AGO_29
    s_mov_b64 exec, s[48:49]
    ds_write_b16 v120, v96
    s_cmp_le_u32 s30, 9
    s_cbranch_scc1 AGO_29
    s_mov_b64 exec, s[50:51]
    ds_write_b16 v121, v97
    s_cmp_le_u32 s30, 10
    s_cbranch_scc1 AGO_29
    s_mov_b64 exec, s[52:53]
    ds_write_b16 v122, v98
    s_cmp_le_u32 s30, 11
    s_cbranch_scc1 AGO_29
    s_mov_b64 exec, s[54:55]
    ds_write_b16 v123, v99
AGO_29:
    s_mov_b64 exec, -1
    s_cmp_le_u32 s31, 0
    s_cbranch_scc1 AGO_30
    s_mov_b64 exec, s[72:73]
    ds_write_b16 v124, v100
    s_cmp_le_u32 s31, 1
    s_cbranch_scc1 AGO_30
    s_mov_b64 exec, s[74:75]
    ds_write_b16 v125, v101
    s_cmp_le_u32 s31, 2
    s_cbranch_scc1 AGO_30
    s_mov_b64 exec, s[76:77]
    ds_write_b16 v126, v102
    s_cmp_le_u32 s31, 3
    s_cbranch_scc1 AGO_30
    s_mov_b64 exec, s[78:79]
    ds_write_b16 v127, v103
    s_cmp_le_u32 s31, 4
    s_cbranch_scc1 AGO_30
    s_mov_b64 exec, s[80:81]
    ds_write_b16 v128, v104
    s_cmp_le_u32 s31, 5
    s_cbranch_scc1 AGO_30
    s_mov_b64 exec, s[82:83]
    ds_write_b16 v129, v105
    s_cmp_le_u32 s31, 6
    s_cbranch_scc1 AGO_30
    s_mov_b64 exec, s[84:85]
    ds_write_b16 v130, v106
    s_cmp_le_u32 s31, 7
    s_cbranch_scc1 AGO_30
    s_mov_b64 exec, s[86:87]
    ds_write_b16 v131, v107
    s_cmp_le_u32 s31, 8
    s_cbranch_scc1 AGO_30
    s_mov_b64 exec, s[88:89]
    ds_write_b16 v132, v108
    s_cmp_le_u32 s31, 9
    s_cbranch_scc1 AGO_30
    s_mov_b64 exec, s[64:65]
    ds_write_b16 v133, v109
    s_cmp_le_u32 s31, 10
    s_cbranch_scc1 AGO_30
    s_mov_b64 exec, s[66:67]
    ds_write_b16 v134, v110
    s_cmp_le_u32 s31, 11
    s_cbranch_scc1 AGO_30
    s_mov_b64 exec, s[28:29]
    ds_write_b16 v135, v111
AGO_30:
    s_mov_b64 exec, -1
    ds_read_b32 v2, v62
    v_max3_u32 v3, v8, v9, v10
    v_max_u32 v3, v3, v11
    v_cmp_lt_u32 s[28:29], 12, v3
    s_movk_i32 s30, 256
    s_waitcnt lgkmcnt(0)
    v_sub_u32 v2, v2, v63
    v_cmp_lt_u32 vcc, s30, v2
    s_nop 4
    s_cbranch_vccnz AG_OVER
    s_cmp_eq_u64 s[28:29], 0
    s_cbranch_scc1 AG_DONE
    v_sub_u32 v8, v8, 12 clamp
    v_add_u32 v244, 48, v244
    v_sub_u32 v9, v9, 12 clamp
    v_add_u32 v245, 48, v245
    v_sub_u32 v10, v10, 12 clamp
    v_add_u32 v246, 48, v246
    v_sub_u32 v11, v11, 12 clamp
    v_add_u32 v247, 48, v247
    s_branch AG_FAST
AG_OVER:
    s_mov_b32 s63, 1
    v_mov_b32 v4, 819212500
    v_mov_b32 v5, v4
    v_mov_b32 v6, v4
    v_mov_b32 v7, v4
    v_lshlrev_b32 v146, 4, v0
    v_add_u32 v146, s61, v146
    ds_write_b128 v146, v[4:7] offset:256
    ds_write_b128 v146, v[4:7] offset:1280
    ds_write_b128 v146, v[4:7] offset:2304
    ds_write_b128 v146, v[4:7] offset:3328
    ds_write_b32 v62, v63
    v_mov_b32 v4, 0
    v_mov_b32 v5, 0
    v_mov_b32 v6, 0
    v_mov_b32 v7, 0
    ds_write_b128 v146, v[4:7] offset:4352
    ds_write_b128 v146, v[4:7] offset:5376
    ds_write_b128 v146, v[4:7] offset:6400
    ds_write_b128 v146, v[4:7] offset:7424
    ds_write_b128 v146, v[4:7] offset:8448
    ds_write_b128 v146, v[4:7] offset:9472
    ds_write_b128 v146, v[4:7] offset:10496
    ds_write_b128 v146, v[4:7] offset:11520
    s_mov_b32 exec_hi, 0
    s_mov_b32 exec_lo, 0xffff
    ds_write_b128 v146, v[4:7] offset:12544
    s_mov_b64 exec, -1
    v_mov_b32 v6, 2
    v_mov_b32 v7, s61
    s_branch AG_START
AG_ROUND:
    v_cmpx_lt_u32 vcc, 0, v8
    s_cbranch_execz AGL_31
    global_load_dwordx4 v[16:19], v244, s[68:69] offset:0 sc1
AGL_31:
    v_cmpx_lt_u32 vcc, 4, v8
    s_cbranch_execz AGL_32
    global_load_dwordx4 v[20:23], v244, s[68:69] offset:16 sc1
AGL_32:
    s_mov_b64 exec, -1
    v_cmpx_lt_u32 vcc, 0, v9
    s_cbranch_execz AGL_33
    global_load_dwordx4 v[24:27], v245, s[68:69] offset:0 sc1
AGL_33:
    v_cmpx_lt_u32 vcc, 4, v9
    s_cbranch_execz AGL_34
    global_load_dwordx4 v[28:31], v245, s[68:69] offset:16 sc1
AGL_34:
    s_mov_b64 exec, -1
    v_cmpx_lt_u32 vcc, 0, v10
    s_cbranch_execz AGL_35
    global_load_dwordx4 v[32:35], v246, s[68:69] offset:0 sc1
AGL_35:
    v_cmpx_lt_u32 vcc, 4, v10
    s_cbranch_execz AGL_36
    global_load_dwordx4 v[36:39], v246, s[68:69] offset:16 sc1
AGL_36:
    s_mov_b64 exec, -1
    v_cmpx_lt_u32 vcc, 0, v11
    s_cbranch_execz AGL_37
    global_load_dwordx4 v[40:43], v247, s[68:69] offset:0 sc1
AGL_37:
    v_cmpx_lt_u32 vcc, 4, v11
    s_cbranch_execz AGL_38
    global_load_dwordx4 v[44:47], v247, s[68:69] offset:16 sc1
AGL_38:
    s_mov_b64 exec, -1
AG_CAREFUL:
    s_waitcnt vmcnt(0)
    v_cmp_lt_u32 s[72:73], 0, v8
    v_cmp_lt_u32 s[74:75], 1, v8
    v_cmp_lt_u32 s[76:77], 2, v8
    v_cmp_lt_u32 s[78:79], 3, v8
    s_nop 3
    s_cmp_eq_u64 s[72:73], 0
    s_cbranch_scc1 AGS_39
AGR_40:
    v_lshrrev_b32 v68, 16, v16
    v_add_u32 v2, s61, v68
    s_mov_b64 exec, s[72:73]
    ds_add_rtn_u32 v64, v2, v6
    s_mov_b64 exec, -1
    v_lshrrev_b32 v69, 16, v17
    v_add_u32 v2, s61, v69
    s_mov_b64 exec, s[74:75]
    ds_add_rtn_u32 v65, v2, v6
    s_mov_b64 exec, -1
    v_lshrrev_b32 v70, 16, v18
    v_add_u32 v2, s61, v70
    s_mov_b64 exec, s[76:77]
    ds_add_rtn_u32 v66, v2, v6
    s_mov_b64 exec, -1
    v_lshrrev_b32 v71, 16, v19
    v_add_u32 v2, s61, v71
    s_mov_b64 exec, s[78:79]
    ds_add_rtn_u32 v67, v2, v6
    s_mov_b64 exec, -1
    s_add_u32 s28, s61, 512
    s_waitcnt lgkmcnt(0)
    v_lshl_add_u32 v2, v68, 6, s28
    v_cmp_gt_u32 vcc, v2, v64
    s_nop 3
    s_and_b64 exec, vcc, s[72:73]
    ds_write_b16 v64, v16
    s_andn2_b64 s[72:73], s[72:73], exec
    s_mov_b64 exec, -1
    v_lshl_add_u32 v2, v69, 6, s28
    v_cmp_gt_u32 vcc, v2, v65
    s_nop 3
    s_and_b64 exec, vcc, s[74:75]
    ds_write_b16 v65, v17
    s_andn2_b64 s[74:75], s[74:75], exec
    s_mov_b64 exec, -1
    v_lshl_add_u32 v2, v70, 6, s28
    v_cmp_gt_u32 vcc, v2, v66
    s_nop 3
    s_and_b64 exec, vcc, s[76:77]
    ds_write_b16 v66, v18
    s_andn2_b64 s[76:77], s[76:77], exec
    s_mov_b64 exec, -1
    v_lshl_add_u32 v2, v71, 6, s28
    v_cmp_gt_u32 vcc, v2, v67
    s_nop 3
    s_and_b64 exec, vcc, s[78:79]
    ds_write_b16 v67, v19
    s_andn2_b64 s[78:79], s[78:79], exec
    s_mov_b64 exec, -1
    s_or_b64 s[80:81], s[72:73], s[74:75]
    s_or_b64 s[82:83], s[76:77], s[78:79]
    s_or_b64 s[80:81], s[80:81], s[82:83]
    s_cbranch_scc0 AGS_39
    s_swappc_b64 s[84:85], s[70:71]
    v_mov_b32 v6, 2
    s_branch AGR_40
AGS_39:
    v_cmp_lt_u32 s[72:73], 4, v8
    v_cmp_lt_u32 s[74:75], 5, v8
    v_cmp_lt_u32 s[76:77], 6, v8
    v_cmp_lt_u32 s[78:79], 7, v8
    s_nop 3
    s_cmp_eq_u64 s[72:73], 0
    s_cbranch_scc1 AGS_41
AGR_42:
    v_lshrrev_b32 v68, 16, v20
    v_add_u32 v2, s61, v68
    s_mov_b64 exec, s[72:73]
    ds_add_rtn_u32 v64, v2, v6
    s_mov_b64 exec, -1
    v_lshrrev_b32 v69, 16, v21
    v_add_u32 v2, s61, v69
    s_mov_b64 exec, s[74:75]
    ds_add_rtn_u32 v65, v2, v6
    s_mov_b64 exec, -1
    v_lshrrev_b32 v70, 16, v22
    v_add_u32 v2, s61, v70
    s_mov_b64 exec, s[76:77]
    ds_add_rtn_u32 v66, v2, v6
    s_mov_b64 exec, -1
    v_lshrrev_b32 v71, 16, v23
    v_add_u32 v2, s61, v71
    s_mov_b64 exec, s[78:79]
    ds_add_rtn_u32 v67, v2, v6
    s_mov_b64 exec, -1
    s_add_u32 s28, s61, 512
    s_waitcnt lgkmcnt(0)
    v_lshl_add_u32 v2, v68, 6, s28
    v_cmp_gt_u32 vcc, v2, v64
    s_nop 3
    s_and_b64 exec, vcc, s[72:73]
    ds_write_b16 v64, v20
    s_andn2_b64 s[72:73], s[72:73], exec
    s_mov_b64 exec, -1
    v_lshl_add_u32 v2, v69, 6, s28
    v_cmp_gt_u32 vcc, v2, v65
    s_nop 3
    s_and_b64 exec, vcc, s[74:75]
    ds_write_b16 v65, v21
    s_andn2_b64 s[74:75], s[74:75], exec
    s_mov_b64 exec, -1
    v_lshl_add_u32 v2, v70, 6, s28
    v_cmp_gt_u32 vcc, v2, v66
    s_nop 3
    s_and_b64 exec, vcc, s[76:77]
    ds_write_b16 v66, v22
    s_andn2_b64 s[76:77], s[76:77], exec
    s_mov_b64 exec, -1
    v_lshl_add_u32 v2, v71, 6, s28
    v_cmp_gt_u32 vcc, v2, v67
    s_nop 3
    s_and_b64 exec, vcc, s[78:79]
    ds_write_b16 v67, v23
    s_andn2_b64 s[78:79], s[78:79], exec
    s_mov_b64 exec, -1
    s_or_b64 s[80:81], s[72:73], s[74:75]
    s_or_b64 s[82:83], s[76:77], s[78:79]
    s_or_b64 s[80:81], s[80:81], s[82:83]
    s_cbranch_scc0 AGS_41
    s_swappc_b64 s[84:85], s[70:71]
    v_mov_b32 v6, 2
    s_branch AGR_42
AGS_41:
    v_cmp_lt_u32 s[72:73], 0, v9
    v_cmp_lt_u32 s[74:75], 1, v9
    v_cmp_lt_u32 s[76:77], 2, v9
    v_cmp_lt_u32 s[78:79], 3, v9
    s_nop 3
    s_cmp_eq_u64 s[72:73], 0
    s_cbranch_scc1 AGS_43
AGR_44:
    v_lshrrev_b32 v68, 16, v24
    v_add_u32 v2, s61, v68
    s_mov_b64 exec, s[72:73]
    ds_add_rtn_u32 v64, v2, v6
    s_mov_b64 exec, -1
    v_lshrrev_b32 v69, 16, v25
    v_add_u32 v2, s61, v69
    s_mov_b64 exec, s[74:75]
    ds_add_rtn_u32 v65, v2, v6
    s_mov_b64 exec, -1
    v_lshrrev_b32 v70, 16, v26
    v_add_u32 v2, s61, v70
    s_mov_b64 exec, s[76:77]
    ds_add_rtn_u32 v66, v2, v6
    s_mov_b64 exec, -1
    v_lshrrev_b32 v71, 16, v27
    v_add_u32 v2, s61, v71
    s_mov_b64 exec, s[78:79]
    ds_add_rtn_u32 v67, v2, v6
    s_mov_b64 exec, -1
    s_add_u32 s28, s61, 512
    s_waitcnt lgkmcnt(0)
    v_lshl_add_u32 v2, v68, 6, s28
    v_cmp_gt_u32 vcc, v2, v64
    s_nop 3
    s_and_b64 exec, vcc, s[72:73]
    ds_write_b16 v64, v24
    s_andn2_b64 s[72:73], s[72:73], exec
    s_mov_b64 exec, -1
    v_lshl_add_u32 v2, v69, 6, s28
    v_cmp_gt_u32 vcc, v2, v65
    s_nop 3
    s_and_b64 exec, vcc, s[74:75]
    ds_write_b16 v65, v25
    s_andn2_b64 s[74:75], s[74:75], exec
    s_mov_b64 exec, -1
    v_lshl_add_u32 v2, v70, 6, s28
    v_cmp_gt_u32 vcc, v2, v66
    s_nop 3
    s_and_b64 exec, vcc, s[76:77]
    ds_write_b16 v66, v26
    s_andn2_b64 s[76:77], s[76:77], exec
    s_mov_b64 exec, -1
    v_lshl_add_u32 v2, v71, 6, s28
    v_cmp_gt_u32 vcc, v2, v67
    s_nop 3
    s_and_b64 exec, vcc, s[78:79]
    ds_write_b16 v67, v27
    s_andn2_b64 s[78:79], s[78:79], exec
    s_mov_b64 exec, -1
    s_or_b64 s[80:81], s[72:73], s[74:75]
    s_or_b64 s[82:83], s[76:77], s[78:79]
    s_or_b64 s[80:81], s[80:81], s[82:83]
    s_cbranch_scc0 AGS_43
    s_swappc_b64 s[84:85], s[70:71]
    v_mov_b32 v6, 2
    s_branch AGR_44
AGS_43:
    v_cmp_lt_u32 s[72:73], 4, v9
    v_cmp_lt_u32 s[74:75], 5, v9
    v_cmp_lt_u32 s[76:77], 6, v9
    v_cmp_lt_u32 s[78:79], 7, v9
    s_nop 3
    s_cmp_eq_u64 s[72:73], 0
    s_cbranch_scc1 AGS_45
AGR_46:
    v_lshrrev_b32 v68, 16, v28
    v_add_u32 v2, s61, v68
    s_mov_b64 exec, s[72:73]
    ds_add_rtn_u32 v64, v2, v6
    s_mov_b64 exec, -1
    v_lshrrev_b32 v69, 16, v29
    v_add_u32 v2, s61, v69
    s_mov_b64 exec, s[74:75]
    ds_add_rtn_u32 v65, v2, v6
    s_mov_b64 exec, -1
    v_lshrrev_b32 v70, 16, v30
    v_add_u32 v2, s61, v70
    s_mov_b64 exec, s[76:77]
    ds_add_rtn_u32 v66, v2, v6
    s_mov_b64 exec, -1
    v_lshrrev_b32 v71, 16, v31
    v_add_u32 v2, s61, v71
    s_mov_b64 exec, s[78:79]
    ds_add_rtn_u32 v67, v2, v6
    s_mov_b64 exec, -1
    s_add_u32 s28, s61, 512
    s_waitcnt lgkmcnt(0)
    v_lshl_add_u32 v2, v68, 6, s28
    v_cmp_gt_u32 vcc, v2, v64
    s_nop 3
    s_and_b64 exec, vcc, s[72:73]
    ds_write_b16 v64, v28
    s_andn2_b64 s[72:73], s[72:73], exec
    s_mov_b64 exec, -1
    v_lshl_add_u32 v2, v69, 6, s28
    v_cmp_gt_u32 vcc, v2, v65
    s_nop 3
    s_and_b64 exec, vcc, s[74:75]
    ds_write_b16 v65, v29
    s_andn2_b64 s[74:75], s[74:75], exec
    s_mov_b64 exec, -1
    v_lshl_add_u32 v2, v70, 6, s28
    v_cmp_gt_u32 vcc, v2, v66
    s_nop 3
    s_and_b64 exec, vcc, s[76:77]
    ds_write_b16 v66, v30
    s_andn2_b64 s[76:77], s[76:77], exec
    s_mov_b64 exec, -1
    v_lshl_add_u32 v2, v71, 6, s28
    v_cmp_gt_u32 vcc, v2, v67
    s_nop 3
    s_and_b64 exec, vcc, s[78:79]
    ds_write_b16 v67, v31
    s_andn2_b64 s[78:79], s[78:79], exec
    s_mov_b64 exec, -1
    s_or_b64 s[80:81], s[72:73], s[74:75]
    s_or_b64 s[82:83], s[76:77], s[78:79]
    s_or_b64 s[80:81], s[80:81], s[82:83]
    s_cbranch_scc0 AGS_45
    s_swappc_b64 s[84:85], s[70:71]
    v_mov_b32 v6, 2
    s_branch AGR_46
AGS_45:
    v_cmp_lt_u32 s[72:73], 0, v10
    v_cmp_lt_u32 s[74:75], 1, v10
    v_cmp_lt_u32 s[76:77], 2, v10
    v_cmp_lt_u32 s[78:79], 3, v10
    s_nop 3
    s_cmp_eq_u64 s[72:73], 0
    s_cbranch_scc1 AGS_47
AGR_48:
    v_lshrrev_b32 v68, 16, v32
    v_add_u32 v2, s61, v68
    s_mov_b64 exec, s[72:73]
    ds_add_rtn_u32 v64, v2, v6
    s_mov_b64 exec, -1
    v_lshrrev_b32 v69, 16, v33
    v_add_u32 v2, s61, v69
    s_mov_b64 exec, s[74:75]
    ds_add_rtn_u32 v65, v2, v6
    s_mov_b64 exec, -1
    v_lshrrev_b32 v70, 16, v34
    v_add_u32 v2, s61, v70
    s_mov_b64 exec, s[76:77]
    ds_add_rtn_u32 v66, v2, v6
    s_mov_b64 exec, -1
    v_lshrrev_b32 v71, 16, v35
    v_add_u32 v2, s61, v71
    s_mov_b64 exec, s[78:79]
    ds_add_rtn_u32 v67, v2, v6
    s_mov_b64 exec, -1
    s_add_u32 s28, s61, 512
    s_waitcnt lgkmcnt(0)
    v_lshl_add_u32 v2, v68, 6, s28
    v_cmp_gt_u32 vcc, v2, v64
    s_nop 3
    s_and_b64 exec, vcc, s[72:73]
    ds_write_b16 v64, v32
    s_andn2_b64 s[72:73], s[72:73], exec
    s_mov_b64 exec, -1
    v_lshl_add_u32 v2, v69, 6, s28
    v_cmp_gt_u32 vcc, v2, v65
    s_nop 3
    s_and_b64 exec, vcc, s[74:75]
    ds_write_b16 v65, v33
    s_andn2_b64 s[74:75], s[74:75], exec
    s_mov_b64 exec, -1
    v_lshl_add_u32 v2, v70, 6, s28
    v_cmp_gt_u32 vcc, v2, v66
    s_nop 3
    s_and_b64 exec, vcc, s[76:77]
    ds_write_b16 v66, v34
    s_andn2_b64 s[76:77], s[76:77], exec
    s_mov_b64 exec, -1
    v_lshl_add_u32 v2, v71, 6, s28
    v_cmp_gt_u32 vcc, v2, v67
    s_nop 3
    s_and_b64 exec, vcc, s[78:79]
    ds_write_b16 v67, v35
    s_andn2_b64 s[78:79], s[78:79], exec
    s_mov_b64 exec, -1
    s_or_b64 s[80:81], s[72:73], s[74:75]
    s_or_b64 s[82:83], s[76:77], s[78:79]
    s_or_b64 s[80:81], s[80:81], s[82:83]
    s_cbranch_scc0 AGS_47
    s_swappc_b64 s[84:85], s[70:71]
    v_mov_b32 v6, 2
    s_branch AGR_48
AGS_47:
    v_cmp_lt_u32 s[72:73], 4, v10
    v_cmp_lt_u32 s[74:75], 5, v10
    v_cmp_lt_u32 s[76:77], 6, v10
    v_cmp_lt_u32 s[78:79], 7, v10
    s_nop 3
    s_cmp_eq_u64 s[72:73], 0
    s_cbranch_scc1 AGS_49
AGR_50:
    v_lshrrev_b32 v68, 16, v36
    v_add_u32 v2, s61, v68
    s_mov_b64 exec, s[72:73]
    ds_add_rtn_u32 v64, v2, v6
    s_mov_b64 exec, -1
    v_lshrrev_b32 v69, 16, v37
    v_add_u32 v2, s61, v69
    s_mov_b64 exec, s[74:75]
    ds_add_rtn_u32 v65, v2, v6
    s_mov_b64 exec, -1
    v_lshrrev_b32 v70, 16, v38
    v_add_u32 v2, s61, v70
    s_mov_b64 exec, s[76:77]
    ds_add_rtn_u32 v66, v2, v6
    s_mov_b64 exec, -1
    v_lshrrev_b32 v71, 16, v39
    v_add_u32 v2, s61, v71
    s_mov_b64 exec, s[78:79]
    ds_add_rtn_u32 v67, v2, v6
    s_mov_b64 exec, -1
    s_add_u32 s28, s61, 512
    s_waitcnt lgkmcnt(0)
    v_lshl_add_u32 v2, v68, 6, s28
    v_cmp_gt_u32 vcc, v2, v64
    s_nop 3
    s_and_b64 exec, vcc, s[72:73]
    ds_write_b16 v64, v36
    s_andn2_b64 s[72:73], s[72:73], exec
    s_mov_b64 exec, -1
    v_lshl_add_u32 v2, v69, 6, s28
    v_cmp_gt_u32 vcc, v2, v65
    s_nop 3
    s_and_b64 exec, vcc, s[74:75]
    ds_write_b16 v65, v37
    s_andn2_b64 s[74:75], s[74:75], exec
    s_mov_b64 exec, -1
    v_lshl_add_u32 v2, v70, 6, s28
    v_cmp_gt_u32 vcc, v2, v66
    s_nop 3
    s_and_b64 exec, vcc, s[76:77]
    ds_write_b16 v66, v38
    s_andn2_b64 s[76:77], s[76:77], exec
    s_mov_b64 exec, -1
    v_lshl_add_u32 v2, v71, 6, s28
    v_cmp_gt_u32 vcc, v2, v67
    s_nop 3
    s_and_b64 exec, vcc, s[78:79]
    ds_write_b16 v67, v39
    s_andn2_b64 s[78:79], s[78:79], exec
    s_mov_b64 exec, -1
    s_or_b64 s[80:81], s[72:73], s[74:75]
    s_or_b64 s[82:83], s[76:77], s[78:79]
    s_or_b64 s[80:81], s[80:81], s[82:83]
    s_cbranch_scc0 AGS_49
    s_swappc_b64 s[84:85], s[70:71]
    v_mov_b32 v6, 2
    s_branch AGR_50
AGS_49:
    v_cmp_lt_u32 s[72:73], 0, v11
    v_cmp_lt_u32 s[74:75], 1, v11
    v_cmp_lt_u32 s[76:77], 2, v11
    v_cmp_lt_u32 s[78:79], 3, v11
    s_nop 3
    s_cmp_eq_u64 s[72:73], 0
    s_cbranch_scc1 AGS_51
AGR_52:
    v_lshrrev_b32 v68, 16, v40
    v_add_u32 v2, s61, v68
    s_mov_b64 exec, s[72:73]
    ds_add_rtn_u32 v64, v2, v6
    s_mov_b64 exec, -1
    v_lshrrev_b32 v69, 16, v41
    v_add_u32 v2, s61, v69
    s_mov_b64 exec, s[74:75]
    ds_add_rtn_u32 v65, v2, v6
    s_mov_b64 exec, -1
    v_lshrrev_b32 v70, 16, v42
    v_add_u32 v2, s61, v70
    s_mov_b64 exec, s[76:77]
    ds_add_rtn_u32 v66, v2, v6
    s_mov_b64 exec, -1
    v_lshrrev_b32 v71, 16, v43
    v_add_u32 v2, s61, v71
    s_mov_b64 exec, s[78:79]
    ds_add_rtn_u32 v67, v2, v6
    s_mov_b64 exec, -1
    s_add_u32 s28, s61, 512
    s_waitcnt lgkmcnt(0)
    v_lshl_add_u32 v2, v68, 6, s28
    v_cmp_gt_u32 vcc, v2, v64
    s_nop 3
    s_and_b64 exec, vcc, s[72:73]
    ds_write_b16 v64, v40
    s_andn2_b64 s[72:73], s[72:73], exec
    s_mov_b64 exec, -1
    v_lshl_add_u32 v2, v69, 6, s28
    v_cmp_gt_u32 vcc, v2, v65
    s_nop 3
    s_and_b64 exec, vcc, s[74:75]
    ds_write_b16 v65, v41
    s_andn2_b64 s[74:75], s[74:75], exec
    s_mov_b64 exec, -1
    v_lshl_add_u32 v2, v70, 6, s28
    v_cmp_gt_u32 vcc, v2, v66
    s_nop 3
    s_and_b64 exec, vcc, s[76:77]
    ds_write_b16 v66, v42
    s_andn2_b64 s[76:77], s[76:77], exec
    s_mov_b64 exec, -1
    v_lshl_add_u32 v2, v71, 6, s28
    v_cmp_gt_u32 vcc, v2, v67
    s_nop 3
    s_and_b64 exec, vcc, s[78:79]
    ds_write_b16 v67, v43
    s_andn2_b64 s[78:79], s[78:79], exec
    s_mov_b64 exec, -1
    s_or_b64 s[80:81], s[72:73], s[74:75]
    s_or_b64 s[82:83], s[76:77], s[78:79]
    s_or_b64 s[80:81], s[80:81], s[82:83]
    s_cbranch_scc0 AGS_51
    s_swappc_b64 s[84:85], s[70:71]
    v_mov_b32 v6, 2
    s_branch AGR_52
AGS_51:
    v_cmp_lt_u32 s[72:73], 4, v11
    v_cmp_lt_u32 s[74:75], 5, v11
    v_cmp_lt_u32 s[76:77], 6, v11
    v_cmp_lt_u32 s[78:79], 7, v11
    s_nop 3
    s_cmp_eq_u64 s[72:73], 0
    s_cbranch_scc1 AGS_53
AGR_54:
    v_lshrrev_b32 v68, 16, v44
    v_add_u32 v2, s61, v68
    s_mov_b64 exec, s[72:73]
    ds_add_rtn_u32 v64, v2, v6
    s_mov_b64 exec, -1
    v_lshrrev_b32 v69, 16, v45
    v_add_u32 v2, s61, v69
    s_mov_b64 exec, s[74:75]
    ds_add_rtn_u32 v65, v2, v6
    s_mov_b64 exec, -1
    v_lshrrev_b32 v70, 16, v46
    v_add_u32 v2, s61, v70
    s_mov_b64 exec, s[76:77]
    ds_add_rtn_u32 v66, v2, v6
    s_mov_b64 exec, -1
    v_lshrrev_b32 v71, 16, v47
    v_add_u32 v2, s61, v71
    s_mov_b64 exec, s[78:79]
    ds_add_rtn_u32 v67, v2, v6
    s_mov_b64 exec, -1
    s_add_u32 s28, s61, 512
    s_waitcnt lgkmcnt(0)
    v_lshl_add_u32 v2, v68, 6, s28
    v_cmp_gt_u32 vcc, v2, v64
    s_nop 3
    s_and_b64 exec, vcc, s[72:73]
    ds_write_b16 v64, v44
    s_andn2_b64 s[72:73], s[72:73], exec
    s_mov_b64 exec, -1
    v_lshl_add_u32 v2, v69, 6, s28
    v_cmp_gt_u32 vcc, v2, v65
    s_nop 3
    s_and_b64 exec, vcc, s[74:75]
    ds_write_b16 v65, v45
    s_andn2_b64 s[74:75], s[74:75], exec
    s_mov_b64 exec, -1
    v_lshl_add_u32 v2, v70, 6, s28
    v_cmp_gt_u32 vcc, v2, v66
    s_nop 3
    s_and_b64 exec, vcc, s[76:77]
    ds_write_b16 v66, v46
    s_andn2_b64 s[76:77], s[76:77], exec
    s_mov_b64 exec, -1
    v_lshl_add_u32 v2, v71, 6, s28
    v_cmp_gt_u32 vcc, v2, v67
    s_nop 3
    s_and_b64 exec, vcc, s[78:79]
    ds_write_b16 v67, v47
    s_andn2_b64 s[78:79], s[78:79], exec
    s_mov_b64 exec, -1
    s_or_b64 s[80:81], s[72:73], s[74:75]
    s_or_b64 s[82:83], s[76:77], s[78:79]
    s_or_b64 s[80:81], s[80:81], s[82:83]
    s_cbranch_scc0 AGS_53
    s_swappc_b64 s[84:85], s[70:71]
    v_mov_b32 v6, 2
    s_branch AGR_54
AGS_53:
AG_NEXT:
    v_sub_u32 v8, v8, 8 clamp
    v_add_u32 v244, 32, v244
    v_sub_u32 v9, v9, 8 clamp
    v_add_u32 v245, 32, v245
    v_sub_u32 v10, v10, 8 clamp
    v_add_u32 v246, 32, v246
    v_sub_u32 v11, v11, 8 clamp
    v_add_u32 v247, 32, v247
    v_or_b32 v2, v8, v9
    v_or3_b32 v2, v2, v10, v11
    v_cmp_ne_u32 vcc, 0, v2
    s_nop 4
    s_cbranch_vccnz AG_ROUND
AG_DONE:
    s_mov_b32 s64, s10
    s_mov_b32 s65, s11
    s_mov_b32 s66, 25000
    s_mov_b32 s67, 0x00020000
    s_mov_b32 s72, s4
    s_mov_b32 s73, s5
    s_mov_b32 s74, 1600000
    s_mov_b32 s75, 0x00020000
    v_and_b32 v1, 15, v0
    v_lshrrev_b32 v2, 4, v0
    s_lshl_b32 s29, s60, 4
    v_add_u32 v14, s29, v1
    v_lshlrev_b32 v13, 1, v14
    v_lshlrev_b32 v12, 7, v14
    v_lshl_add_u32 v12, v2, 5, v12
    buffer_load_ushort v24, v13, s[64:67], 0 offen
    buffer_load_dwordx4 v[16:19], v12, s[72:75], 0 offen offset:0
    buffer_load_dwordx4 v[20:23], v12, s[72:75], 0 offen offset:16
    s_swappc_b64 s[84:85], s[70:71]
    v_lshrrev_b32 v2, 4, v0
    v_lshlrev_b32 v3, 4, v0
    v_mul_u32_u24 v4, 528, v1
    v_lshl_add_u32 v4, v2, 5, v4
    v_add_u32 v4, s61, v4
    s_mov_b32 s76, s22
    s_mov_b32 s77, s23
    s_mov_b32 s78, 1600000
    s_mov_b32 s79, 0x00020000
    ds_read_b128 v[176:179], v4 offset:4352
    ds_read_b128 v[180:183], v4 offset:4608
    ds_read_b128 v[184:187], v4 offset:4368
    ds_read_b128 v[188:191], v4 offset:4624
    ds_read_b128 v[192:195], v4 offset:4480
    ds_read_b128 v[196:199], v4 offset:4736
    ds_read_b128 v[200:203], v4 offset:4496
    ds_read_b128 v[204:207], v4 offset:4752
    s_lshl_b32 s29, s60, 11
    s_add_u32 s29, s29, 11534336
    s_add_u32 s30, s26, s29
    s_addc_u32 s31, s27, 0
    v_lshlrev_b32 v13, 2, v14
    v_add_u32 v5, 112128, v3
    v_lshlrev_b32 v136, 16, v24
    s_mov_b32 s50, 262144
W_55:
    ds_read_b32 v6, v15 offset:32
    s_waitcnt lgkmcnt(0)
    v_readfirstlane_b32 s29, v6
    s_nop 3
    s_cmp_ge_u32 s29, 1
    s_cbranch_scc1 W_56
    s_sleep 2
    s_sub_u32 s50, s50, 1
    s_cmp_lg_u32 s50, 0
    s_cbranch_scc1 W_55
W_56:
    ds_read_b128 v[88:91], v5 offset:8192
    ds_read_b128 v[92:95], v5 offset:9216
    ds_read_b128 v[96:99], v5 offset:10240
    ds_read_b128 v[100:103], v5 offset:11264
    ds_read_b128 v[104:107], v5 offset:12288
    ds_read_b128 v[108:111], v5 offset:13312
    ds_read_b128 v[112:115], v5 offset:14336
    ds_read_b128 v[116:119], v5 offset:15360
    ds_read_b128 v[56:59], v5 offset:0
    ds_read_b128 v[60:63], v5 offset:1024
    ds_read_b128 v[64:67], v5 offset:2048
    ds_read_b128 v[68:71], v5 offset:3072
    ds_read_b128 v[72:75], v5 offset:4096
    ds_read_b128 v[76:79], v5 offset:5120
    ds_read_b128 v[80:83], v5 offset:6144
    ds_read_b128 v[84:87], v5 offset:7168
    s_add_u32 s32, s26, 20971520
    s_addc_u32 s33, s27, 0
    v_add_f32 v176, v176, v192
    v_add_f32 v177, v177, v193
    v_add_f32 v178, v178, v194
    v_add_f32 v179, v179, v195
    v_add_f32 v180, v180, v196
    v_add_f32 v181, v181, v197
    v_add_f32 v182, v182, v198
    v_add_f32 v183, v183, v199
    v_add_f32 v184, v184, v200
    v_add_f32 v185, v185, v201
    v_add_f32 v186, v186, v202
    v_add_f32 v187, v187, v203
    v_add_f32 v188, v188, v204
    v_add_f32 v189, v189, v205
    v_add_f32 v190, v190, v206
    v_add_f32 v191, v191, v207
    v_mul_f32 v176, v136, v176
    v_mul_f32 v177, v136, v177
    v_mul_f32 v178, v136, v178
    v_mul_f32 v179, v136, v179
    v_mul_f32 v180, v136, v180
    v_mul_f32 v181, v136, v181
    v_mul_f32 v182, v136, v182
    v_mul_f32 v183, v136, v183
    v_mul_f32 v184, v136, v184
    v_mul_f32 v185, v136, v185
    v_mul_f32 v186, v136, v186
    v_mul_f32 v187, v136, v187
    v_mul_f32 v188, v136, v188
    v_mul_f32 v189, v136, v189
    v_mul_f32 v190, v136, v190
    v_mul_f32 v191, v136, v191
    v_cvt_pk_bf16_f32 v120, v176, v177
    v_cvt_pk_bf16_f32 v121, v178, v179
    v_cvt_pk_bf16_f32 v122, v180, v181
    v_cvt_pk_bf16_f32 v123, v182, v183
    v_cvt_pk_bf16_f32 v124, v184, v185
    v_cvt_pk_bf16_f32 v125, v186, v187
    v_cvt_pk_bf16_f32 v126, v188, v189
    v_cvt_pk_bf16_f32 v127, v190, v191
    s_waitcnt lgkmcnt(8)
    v_mfma_f32_16x16x32_bf16 v[160:163], v[88:91], v[120:123], 0
    v_mfma_f32_16x16x32_bf16 v[160:163], v[92:95], v[124:127], v[160:163]
    v_mfma_f32_16x16x32_bf16 v[164:167], v[96:99], v[120:123], 0
    v_mfma_f32_16x16x32_bf16 v[164:167], v[100:103], v[124:127], v[164:167]
    v_mfma_f32_16x16x32_bf16 v[168:171], v[104:107], v[120:123], 0
    v_mfma_f32_16x16x32_bf16 v[168:171], v[108:111], v[124:127], v[168:171]
    v_mfma_f32_16x16x32_bf16 v[172:175], v[112:115], v[120:123], 0
    v_mfma_f32_16x16x32_bf16 v[172:175], v[116:119], v[124:127], v[172:175]
    s_mov_b32 s56, 0xffff0000
    s_waitcnt lgkmcnt(0)
    v_lshlrev_b32 v176, 16, v16
    v_and_b32 v177, s56, v16
    v_lshlrev_b32 v178, 16, v17
    v_and_b32 v179, s56, v17
    v_lshlrev_b32 v180, 16, v18
    v_and_b32 v181, s56, v18
    v_lshlrev_b32 v182, 16, v19
    v_and_b32 v183, s56, v19
    v_lshlrev_b32 v184, 16, v20
    v_and_b32 v185, s56, v20
    v_lshlrev_b32 v186, 16, v21
    v_and_b32 v187, s56, v21
    v_lshlrev_b32 v188, 16, v22
    v_and_b32 v189, s56, v22
    v_lshlrev_b32 v190, 16, v23
    v_and_b32 v191, s56, v23
    v_add_f32 v176, v176, v160
    v_add_f32 v177, v177, v161
    v_add_f32 v178, v178, v162
    v_add_f32 v179, v179, v163
    v_add_f32 v180, v180, v164
    v_add_f32 v181, v181, v165
    v_add_f32 v182, v182, v166
    v_add_f32 v183, v183, v167
    v_add_f32 v184, v184, v168
    v_add_f32 v185, v185, v169
    v_add_f32 v186, v186, v170
    v_add_f32 v187, v187, v171
    v_add_f32 v188, v188, v172
    v_add_f32 v189, v189, v173
    v_add_f32 v190, v190, v174
    v_add_f32 v191, v191, v175
    s_cmp_lg_u32 s62, 0
    s_cbranch_scc1 FN_TOLD
    s_lshr_b32 s44, s60, 4
    s_add_u32 s64, s90, 500
    s_addc_u32 s65, s91, 0
    s_add_u32 s66, s90, 0x10000000
    s_addc_u32 s67, s91, 0
    s_mul_i32 s28, s44, 320
    s_add_u32 s28, s28, 5193728
    v_min_u32 v8, 4, v0
    v_lshl_add_u32 v8, v8, 6, s28
    s_mov_b32 s50, 262144
PW_57:
    global_load_dwordx2 v[10:11], v8, s[26:27] sc1
    s_waitcnt vmcnt(0)
    v_cmp_le_u64 vcc, s[64:65], v[10:11]
    v_cmp_ge_u64 s[68:69], s[66:67], v[10:11]
    s_nop 3
    s_and_b64 s[68:69], s[68:69], vcc
    s_and_b32 s68, s68, 31
    s_cmp_eq_u32 s68, 31
    s_cbranch_scc1 PW_58
    s_cmp_lg_u32 s68, 0
    s_cbranch_scc1 PW_59
    s_sleep 16
PW_59:
    s_sleep 1
    s_sub_u32 s50, s50, 1
    s_cmp_lg_u32 s50, 0
    s_cbranch_scc1 PW_57
PW_58:
    s_branch FN_GO
FN_TOLD:
    s_mov_b32 s50, 262144
W_60:
    ds_read_b32 v6, v15 offset:24
    s_waitcnt lgkmcnt(0)
    v_readfirstlane_b32 s29, v6
    s_nop 3
    s_cmp_ge_u32 s29, 1
    s_cbranch_scc1 W_61
    s_sleep 8
    s_sub_u32 s50, s50, 1
    s_cmp_lg_u32 s50, 0
    s_cbranch_scc1 W_60
W_61:
    s_mov_b32 s50, 262144
W_62:
    ds_read_b32 v6, v15 offset:28
    s_waitcnt lgkmcnt(0)
    v_readfirstlane_b32 s29, v6
    s_nop 3
    s_cmp_ge_u32 s29, 1
    s_cbranch_scc1 W_63
    s_sleep 1
    s_sub_u32 s50, s50, 1
    s_cmp_lg_u32 s50, 0
    s_cbranch_scc1 W_62
W_63:
FN_GO:
    s_setprio 3
    global_load_dword v136, v13, s[32:33] sc1
    s_add_u32 s32, s32, 50176
    s_addc_u32 s33, s33, 0
    global_load_dword v137, v13, s[32:33] sc1
    s_add_u32 s32, s32, 50176
    s_addc_u32 s33, s33, 0
    global_load_dword v138, v13, s[32:33] sc1
    s_add_u32 s32, s32, 50176
    s_addc_u32 s33, s33, 0
    global_load_dword v139, v13, s[32:33] sc1
    s_add_u32 s32, s32, 50176
    s_addc_u32 s33, s33, 0
    global_load_dword v140, v13, s[32:33] sc1
    global_load_dwordx4 v[16:19], v3, s[30:31] offset:0 sc1
    global_load_dwordx4 v[20:23], v3, s[30:31] offset:1024 sc1
    s_add_u32 s30, s30, 1605632
    s_addc_u32 s31, s31, 0
    global_load_dwordx4 v[24:27], v3, s[30:31] offset:0 sc1
    global_load_dwordx4 v[28:31], v3, s[30:31] offset:1024 sc1
    s_add_u32 s30, s30, 1605632
    s_addc_u32 s31, s31, 0
    global_load_dwordx4 v[32:35], v3, s[30:31] offset:0 sc1
    global_load_dwordx4 v[36:39], v3, s[30:31] offset:1024 sc1
    s_add_u32 s30, s30, 1605632
    s_addc_u32 s31, s31, 0
    global_load_dwordx4 v[40:43], v3, s[30:31] offset:0 sc1
    global_load_dwordx4 v[44:47], v3, s[30:31] offset:1024 sc1
    s_add_u32 s30, s30, 1605632
    s_addc_u32 s31, s31, 0
    global_load_dwordx4 v[48:51], v3, s[30:31] offset:0 sc1
    global_load_dwordx4 v[52:55], v3, s[30:31] offset:1024 sc1
    s_mov_b32 s52, 0x1f800000
    s_movk_i32 s53, 12500
    v_cmp_gt_u32 s[54:55], s53, v14
    s_waitcnt vmcnt(10)
    v_add_f32 v136, v136, v137
    v_add_f32 v138, v138, v139
    v_add_f32 v136, v136, v140
    v_add_f32 v136, v136, v138
    v_cmp_nle_f32 vcc, s52, v136
    v_rcp_f32 v137, v136
    s_nop 3
    s_and_b64 vcc, vcc, s[54:55]
    s_cbranch_vccnz FN_SLOW
    s_waitcnt vmcnt(8)
    v_mfma_f32_16x16x32_bf16 v[144:147], v[56:59], v[16:19], 0
    v_mfma_f32_16x16x32_bf16 v[144:147], v[60:63], v[20:23], v[144:147]
    v_mfma_f32_16x16x32_bf16 v[148:151], v[64:67], v[16:19], 0
    v_mfma_f32_16x16x32_bf16 v[148:151], v[68:71], v[20:23], v[148:151]
    v_mfma_f32_16x16x32_bf16 v[152:155], v[72:75], v[16:19], 0
    v_mfma_f32_16x16x32_bf16 v[152:155], v[76:79], v[20:23], v[152:155]
    v_mfma_f32_16x16x32_bf16 v[156:159], v[80:83], v[16:19], 0
    v_mfma_f32_16x16x32_bf16 v[156:159], v[84:87], v[20:23], v[156:159]
    s_waitcnt vmcnt(6)
    v_mfma_f32_16x16x32_bf16 v[144:147], v[56:59], v[24:27], v[144:147]
    v_mfma_f32_16x16x32_bf16 v[144:147], v[60:63], v[28:31], v[144:147]
    v_mfma_f32_16x16x32_bf16 v[148:151], v[64:67], v[24:27], v[148:151]
    v_mfma_f32_16x16x32_bf16 v[148:151], v[68:71], v[28:31], v[148:151]
    v_mfma_f32_16x16x32_bf16 v[152:155], v[72:75], v[24:27], v[152:155]
    v_mfma_f32_16x16x32_bf16 v[152:155], v[76:79], v[28:31], v[152:155]
    v_mfma_f32_16x16x32_bf16 v[156:159], v[80:83], v[24:27], v[156:159]
    v_mfma_f32_16x16x32_bf16 v[156:159], v[84:87], v[28:31], v[156:159]
    s_waitcnt vmcnt(4)
    v_mfma_f32_16x16x32_bf16 v[144:147], v[56:59], v[32:35], v[144:147]
    v_mfma_f32_16x16x32_bf16 v[144:147], v[60:63], v[36:39], v[144:147]
    v_mfma_f32_16x16x32_bf16 v[148:151], v[64:67], v[32:35], v[148:151]
    v_mfma_f32_16x16x32_bf16 v[148:151], v[68:71], v[36:39], v[148:151]
    v_mfma_f32_16x16x32_bf16 v[152:155], v[72:75], v[32:35], v[152:155]
    v_mfma_f32_16x16x32_bf16 v[152:155], v[76:79], v[36:39], v[152:155]
    v_mfma_f32_16x16x32_bf16 v[156:159], v[80:83], v[32:35], v[156:159]
    v_mfma_f32_16x16x32_bf16 v[156:159], v[84:87], v[36:39], v[156:159]
    s_waitcnt vmcnt(2)
    v_mfma_f32_16x16x32_bf16 v[144:147], v[56:59], v[40:43], v[144:147]
    v_mfma_f32_16x16x32_bf16 v[144:147], v[60:63], v[44:47], v[144:147]
    v_mfma_f32_16x16x32_bf16 v[148:151], v[64:67], v[40:43], v[148:151]
    v_mfma_f32_16x16x32_bf16 v[148:151], v[68:71], v[44:47], v[148:151]
    v_mfma_f32_16x16x32_bf16 v[152:155], v[72:75], v[40:43], v[152:155]
    v_mfma_f32_16x16x32_bf16 v[152:155], v[76:79], v[44:47], v[152:155]
    v_mfma_f32_16x16x32_bf16 v[156:159], v[80:83], v[40:43], v[156:159]
    v_mfma_f32_16x16x32_bf16 v[156:159], v[84:87], v[44:47], v[156:159]
    s_waitcnt vmcnt(0)
    v_mfma_f32_16x16x32_bf16 v[144:147], v[56:59], v[48:51], v[144:147]
    v_mfma_f32_16x16x32_bf16 v[144:147], v[60:63], v[52:55], v[144:147]
    v_mfma_f32_16x16x32_bf16 v[148:151], v[64:67], v[48:51], v[148:151]
    v_mfma_f32_16x16x32_bf16 v[148:151], v[68:71], v[52:55], v[148:151]
    v_mfma_f32_16x16x32_bf16 v[152:155], v[72:75], v[48:51], v[152:155]
    v_mfma_f32_16x16x32_bf16 v[152:155], v[76:79], v[52:55], v[152:155]
    v_mfma_f32_16x16x32_bf16 v[156:159], v[80:83], v[48:51], v[156:159]
    v_mfma_f32_16x16x32_bf16 v[156:159], v[84:87], v[52:55], v[156:159]
FN_JOIN:
    s_nop 1
    v_fmac_f32 v176, v144, v137
    v_fmac_f32 v177, v145, v137
    v_fmac_f32 v178, v146, v137
    v_fmac_f32 v179, v147, v137
    v_fmac_f32 v180, v148, v137
    v_fmac_f32 v181, v149, v137
    v_fmac_f32 v182, v150, v137
    v_fmac_f32 v183, v151, v137
    v_fmac_f32 v184, v152, v137
    v_fmac_f32 v185, v153, v137
    v_fmac_f32 v186, v154, v137
    v_fmac_f32 v187, v155, v137
    v_fmac_f32 v188, v156, v137
    v_fmac_f32 v189, v157, v137
    v_fmac_f32 v190, v158, v137
    v_fmac_f32 v191, v159, v137
    v_cvt_pk_bf16_f32 v128, v176, v177
    v_cvt_pk_bf16_f32 v129, v178, v179
    v_cvt_pk_bf16_f32 v130, v180, v181
    v_cvt_pk_bf16_f32 v131, v182, v183
    v_cvt_pk_bf16_f32 v132, v184, v185
    v_cvt_pk_bf16_f32 v133, v186, v187
    v_cvt_pk_bf16_f32 v134, v188, v189
    v_cvt_pk_bf16_f32 v135, v190, v191
    buffer_store_dwordx4 v[128:131], v12, s[76:79], 0 offen offset:0
    buffer_store_dwordx4 v[132:135], v12, s[76:79], 0 offen offset:16
    s_endpgm
FN_SLOW:
    s_waitcnt vmcnt(0)
    s_add_u32 s58, s26, 2097152
    s_addc_u32 s59, s27, 0
    s_add_u32 s80, s26, 0
    s_addc_u32 s81, s27, 0
    global_load_dwordx4 v[192:195], v12, s[58:59] offset:0 sc1
    global_load_dwordx4 v[196:199], v12, s[58:59] offset:16 sc1
    v_mov_b32 v236, v12
    s_add_u32 s62, s61, 256
    v_and_b32 v6, 1, v1
    v_bfe_u32 v7, v1, 3, 1
    v_lshl_or_b32 v6, v7, 1, v6
    v_bfe_u32 v7, v1, 1, 2
    v_lshl_or_b32 v6, v7, 2, v6
    v_bfe_u32 v7, v6, 1, 3
    v_lshlrev_b32 v12, 1, v2
    v_xor_b32 v7, v7, v12
    v_lshlrev_b32 v7, 4, v7
    v_lshl_add_u32 v4, v6, 7, v7
    v_xor_b32 v5, 16, v4
    v_lshrrev_b32 v12, 2, v1
    v_lshl_or_b32 v12, v2, 2, v12
    v_and_b32 v6, 1, v12
    v_bfe_u32 v7, v12, 3, 1
    v_lshl_or_b32 v6, v7, 1, v6
    v_bfe_u32 v7, v12, 1, 2
    v_lshl_or_b32 v6, v7, 2, v6
    v_bfe_u32 v7, v6, 1, 3
    v_bfe_u32 v13, v1, 1, 1
    v_xor_b32 v7, v7, v13
    v_lshlrev_b32 v7, 4, v7
    v_lshl_add_u32 v7, v6, 7, v7
    v_and_b32 v13, 1, v1
    v_lshl_add_u32 v8, v13, 3, v7
    v_xor_b32 v9, 32, v8
    v_xor_b32 v10, 64, v8
    v_xor_b32 v11, 0x60, v8
    v_add_u32 v4, s62, v4
    v_add_u32 v5, s62, v5
    v_add_u32 v8, s62, v8
    v_add_u32 v9, s62, v9
    v_add_u32 v10, s62, v10
    v_add_u32 v11, s62, v11
    v_add_u32 v6, s62, v3
    v_lshrrev_b32 v7, 1, v2
    v_lshlrev_b32 v7, 1, v7
    v_and_b32 v12, 1, v2
    v_lshl_or_b32 v7, v12, 3, v7
    v_mov_b32 v12, v236
    v_mov_b32 v228, 0xff61b1e6
    v_mov_b32 v229, 0xff61b1e6
    s_movk_i32 s63, 12500
    v_mov_b32 v200, 0
    v_mov_b32 v201, 0
    v_mov_b32 v202, 0
    v_mov_b32 v203, 0
    v_mov_b32 v204, 0
    v_mov_b32 v205, 0
    v_mov_b32 v206, 0
    v_mov_b32 v207, 0
    v_mov_b32 v208, 0
    v_mov_b32 v209, 0
    v_mov_b32 v210, 0
    v_mov_b32 v211, 0
    v_mov_b32 v212, 0
    v_mov_b32 v213, 0
    v_mov_b32 v214, 0
    v_mov_b32 v215, 0
    v_and_b32 v233, 7, v0
    v_lshrrev_b32 v235, 4, v0
    v_xor_b32 v233, v233, v235
    v_lshlrev_b32 v233, 4, v233
    v_lshrrev_b32 v235, 3, v0
    v_lshl_add_u32 v233, v235, 7, v233
    v_xor_b32 v234, 64, v233
FN_SL:
    global_load_dwordx4 v[160:163], v233, s[80:81] offset:0 sc1
    global_load_dwordx4 v[164:167], v234, s[80:81] offset:1024 sc1
    global_load_dwordx4 v[168:171], v233, s[80:81] offset:2048 sc1
    global_load_dwordx4 v[172:175], v234, s[80:81] offset:3072 sc1
    s_add_u32 s80, s80, 4096
    s_addc_u32 s81, s81, 0
    s_waitcnt vmcnt(0)
    ds_write_b128 v6, v[160:163] offset:0
    ds_write_b128 v6, v[164:167] offset:1024
    ds_write_b128 v6, v[168:171] offset:2048
    ds_write_b128 v6, v[172:175] offset:3072
    s_waitcnt lgkmcnt(0)
    ds_read_b128 v[16:19], v4 offset:0
    ds_read_b128 v[20:23], v5 offset:0
    ds_read_b128 v[24:27], v4 offset:2048
    ds_read_b128 v[28:31], v5 offset:2048
    ds_read_b64_tr_b16 v[32:33], v8 offset:0
    ds_read_b64_tr_b16 v[34:35], v8 offset:2048
    ds_read_b64_tr_b16 v[36:37], v9 offset:0
    ds_read_b64_tr_b16 v[38:39], v9 offset:2048
    ds_read_b64_tr_b16 v[40:41], v10 offset:0
    ds_read_b64_tr_b16 v[42:43], v10 offset:2048
    ds_read_b64_tr_b16 v[44:45], v11 offset:0
    ds_read_b64_tr_b16 v[46:47], v11 offset:2048
    s_waitcnt lgkmcnt(0)
    v_mfma_f32_16x16x32_bf16 v[216:219], v[16:19], v[192:195], 0
    v_mfma_f32_16x16x32_bf16 v[216:219], v[20:23], v[196:199], v[216:219]
    v_mfma_f32_16x16x32_bf16 v[220:223], v[24:27], v[192:195], 0
    v_mfma_f32_16x16x32_bf16 v[220:223], v[28:31], v[196:199], v[220:223]
    s_nop 7
    s_nop 1
    s_sub_i32 s64, s63, 0
    v_cmp_gt_i32 vcc, s64, v7
    s_nop 1
    v_cndmask_b32 v216, v229, v216, vcc
    s_sub_i32 s64, s63, 1
    v_cmp_gt_i32 vcc, s64, v7
    s_nop 1
    v_cndmask_b32 v217, v229, v217, vcc
    s_sub_i32 s64, s63, 4
    v_cmp_gt_i32 vcc, s64, v7
    s_nop 1
    v_cndmask_b32 v218, v229, v218, vcc
    s_sub_i32 s64, s63, 5
    v_cmp_gt_i32 vcc, s64, v7
    s_nop 1
    v_cndmask_b32 v219, v229, v219, vcc
    s_sub_i32 s64, s63, 16
    v_cmp_gt_i32 vcc, s64, v7
    s_nop 1
    v_cndmask_b32 v220, v229, v220, vcc
    s_sub_i32 s64, s63, 17
    v_cmp_gt_i32 vcc, s64, v7
    s_nop 1
    v_cndmask_b32 v221, v229, v221, vcc
    s_sub_i32 s64, s63, 20
    v_cmp_gt_i32 vcc, s64, v7
    s_nop 1
    v_cndmask_b32 v222, v229, v222, vcc
    s_sub_i32 s64, s63, 21
    v_cmp_gt_i32 vcc, s64, v7
    s_nop 1
    v_cndmask_b32 v223, v229, v223, vcc
    v_max3_f32 v230, v216, v217, v228
    v_max3_f32 v230, v218, v219, v230
    v_max3_f32 v230, v220, v221, v230
    v_max3_f32 v230, v222, v223, v230
    v_mov_b32 v231, v230
    v_mov_b32 v232, v230
    s_nop 1
    v_permlane16_swap_b32 v231, v232
    s_nop 1
    v_max_f32 v230, v231, v232
    v_mov_b32 v231, v230
    v_mov_b32 v232, v230
    s_nop 1
    v_permlane32_swap_b32 v231, v232
    s_nop 1
    v_max_f32 v230, v231, v232
    v_sub_f32 v231, v228, v230
    v_exp_f32 v231, v231
    v_mov_b32 v228, v230
    v_sub_f32 v216, v216, v228
    v_sub_f32 v217, v217, v228
    v_sub_f32 v218, v218, v228
    v_sub_f32 v219, v219, v228
    v_sub_f32 v220, v220, v228
    v_sub_f32 v221, v221, v228
    v_sub_f32 v222, v222, v228
    v_sub_f32 v223, v223, v228
    v_exp_f32 v216, v216
    v_exp_f32 v217, v217
    v_exp_f32 v218, v218
    v_exp_f32 v219, v219
    v_exp_f32 v220, v220
    v_exp_f32 v221, v221
    v_exp_f32 v222, v222
    v_exp_f32 v223, v223
    v_mul_f32 v200, v231, v200
    v_mul_f32 v201, v231, v201
    v_mul_f32 v202, v231, v202
    v_mul_f32 v203, v231, v203
    v_mul_f32 v204, v231, v204
    v_mul_f32 v205, v231, v205
    v_mul_f32 v206, v231, v206
    v_mul_f32 v207, v231, v207
    v_mul_f32 v208, v231, v208
    v_mul_f32 v209, v231, v209
    v_mul_f32 v210, v231, v210
    v_mul_f32 v211, v231, v211
    v_mul_f32 v212, v231, v212
    v_mul_f32 v213, v231, v213
    v_mul_f32 v214, v231, v214
    v_mul_f32 v215, v231, v215
    v_cvt_pk_bf16_f32 v224, v216, v217
    v_cvt_pk_bf16_f32 v225, v218, v219
    v_cvt_pk_bf16_f32 v226, v220, v221
    v_cvt_pk_bf16_f32 v227, v222, v223
    s_nop 1
    v_mfma_f32_16x16x32_bf16 v[200:203], v[32:35], v[224:227], v[200:203]
    v_mfma_f32_16x16x32_bf16 v[204:207], v[36:39], v[224:227], v[204:207]
    v_mfma_f32_16x16x32_bf16 v[208:211], v[40:43], v[224:227], v[208:211]
    v_mfma_f32_16x16x32_bf16 v[212:215], v[44:47], v[224:227], v[212:215]
    s_sub_i32 s63, s63, 32
    s_cmp_gt_i32 s63, 0
    s_cbranch_scc1 FN_SL
    v_add_u32 v4, 48, v1
    v_lshlrev_b32 v4, 2, v4
    s_nop 7
    ds_bpermute_b32 v13, v4, v215
    s_waitcnt lgkmcnt(0)
    v_rcp_f32 v13, v13
    s_nop 0
    v_mul_f32 v200, v13, v200
    v_mul_f32 v201, v13, v201
    v_mul_f32 v202, v13, v202
    v_mul_f32 v203, v13, v203
    v_mul_f32 v204, v13, v204
    v_mul_f32 v205, v13, v205
    v_mul_f32 v206, v13, v206
    v_mul_f32 v207, v13, v207
    v_mul_f32 v208, v13, v208
    v_mul_f32 v209, v13, v209
    v_mul_f32 v210, v13, v210
    v_mul_f32 v211, v13, v211
    v_mul_f32 v212, v13, v212
    v_mul_f32 v213, v13, v213
    v_mul_f32 v214, v13, v214
    v_mul_f32 v215, v13, v215
    v_cvt_pk_bf16_f32 v216, v200, v201
    v_cvt_pk_bf16_f32 v217, v202, v203
    v_cvt_pk_bf16_f32 v218, v204, v205
    v_cvt_pk_bf16_f32 v219, v206, v207
    v_cvt_pk_bf16_f32 v220, v208, v209
    v_cvt_pk_bf16_f32 v221, v210, v211
    v_cvt_pk_bf16_f32 v222, v212, v213
    v_cvt_pk_bf16_f32 v223, v214, v215
    v_mov_b32 v137, 1.0
    s_nop 0
    v_mfma_f32_16x16x32_bf16 v[144:147], v[56:59], v[216:219], 0
    v_mfma_f32_16x16x32_bf16 v[148:151], v[64:67], v[216:219], 0
    v_mfma_f32_16x16x32_bf16 v[152:155], v[72:75], v[216:219], 0
    v_mfma_f32_16x16x32_bf16 v[156:159], v[80:83], v[216:219], 0
    v_mfma_f32_16x16x32_bf16 v[144:147], v[60:63], v[220:223], v[144:147]
    v_mfma_f32_16x16x32_bf16 v[148:151], v[68:71], v[220:223], v[148:151]
    v_mfma_f32_16x16x32_bf16 v[152:155], v[76:79], v[220:223], v[152:155]
    v_mfma_f32_16x16x32_bf16 v[156:159], v[84:87], v[220:223], v[156:159]
    s_nop 7
    s_branch FN_JOIN
AG_PROC:
    s_setprio 0
    s_waitcnt lgkmcnt(0)
    ds_read_b32 v2, v62
    v_mov_b32 v56, v60
    v_add_u32 v57, 3296, v61
    s_movk_i32 s28, 160
    ds_read_u16 v184, v56 offset:256
    ds_read_u16 v186, v56 offset:272
    ds_read_u16 v188, v56 offset:288
    ds_read_u16 v190, v56 offset:304
    ds_read_u16 v192, v56 offset:320
    ds_read_u16 v194, v56 offset:336
    ds_read_u16 v196, v56 offset:352
    ds_read_u16 v198, v56 offset:368
    ds_read_u16 v200, v56 offset:384
    ds_read_u16 v202, v56 offset:400
    v_add_u32 v56, 0x100, v56
    s_waitcnt lgkmcnt(10)
    v_sub_u32 v2, v2, v63
    v_cmp_lt_u32 vcc, s28, v2
    s_mov_b32 s30, 0
    s_mov_b32 s31, 0
    s_mov_b32 s29, 5
    s_nop 1
    s_and_b32 s86, vcc_lo, 0xffff
    s_lshl_b32 s86, s86, 2
    s_mov_b32 s33, 14
    v_mov_b32 v58, 129792
AG_PL:
    ds_read_b32 v59, v58
    s_waitcnt lgkmcnt(0)
    v_readfirstlane_b32 s32, v59
    s_add_u32 s33, s33, 1
    buffer_load_dwordx4 v[64:67], v[184:185], s[56:59], 0 idxen offen sc1
    buffer_load_dwordx4 v[68:71], v[186:187], s[56:59], 0 idxen offen sc1
    buffer_load_dwordx4 v[72:75], v[188:189], s[56:59], 0 idxen offen sc1
    buffer_load_dwordx4 v[76:79], v[190:191], s[56:59], 0 idxen offen sc1
    buffer_load_dwordx4 v[80:83], v[192:193], s[56:59], 0 idxen offen sc1
    buffer_load_dwordx4 v[84:87], v[194:195], s[56:59], 0 idxen offen sc1
    buffer_load_dwordx4 v[88:91], v[196:197], s[56:59], 0 idxen offen sc1
    buffer_load_dwordx4 v[92:95], v[198:199], s[56:59], 0 idxen offen sc1
    buffer_load_dwordx4 v[96:99], v[200:201], s[56:59], 0 idxen offen sc1
    buffer_load_dwordx4 v[100:103], v[202:203], s[56:59], 0 idxen offen sc1
    s_cmp_lt_u32 s32, s33
    s_cbranch_scc1 AG_PN
    s_setprio 3
AG_PN:
    ds_read_b128 v[52:55], v57
    ds_read_u16 v204, v56 offset:256
    ds_read_u16 v206, v56 offset:272
    ds_read_u16 v208, v56 offset:288
    ds_read_u16 v210, v56 offset:304
    ds_read_u16 v212, v56 offset:320
    ds_read_u16 v214, v56 offset:336
    ds_read_u16 v216, v56 offset:352
    ds_read_u16 v218, v56 offset:368
    ds_read_u16 v220, v56 offset:384
    ds_read_u16 v222, v56 offset:400
    v_add_u32 v56, 0x100, v56
    s_waitcnt vmcnt(20) lgkmcnt(10)
    v_mfma_f32_16x16x32_bf16 v[52:55], v[48:51], v[104:107], v[52:55]
    v_mfma_f32_16x16x32_bf16 v[52:55], v[48:51], v[108:111], v[52:55]
    v_mfma_f32_16x16x32_bf16 v[52:55], v[48:51], v[112:115], v[52:55]
    v_mfma_f32_16x16x32_bf16 v[52:55], v[48:51], v[116:119], v[52:55]
    v_mfma_f32_16x16x32_bf16 v[52:55], v[48:51], v[120:123], v[52:55]
    v_mfma_f32_16x16x32_bf16 v[52:55], v[48:51], v[124:127], v[52:55]
    v_mfma_f32_16x16x32_bf16 v[52:55], v[48:51], v[128:131], v[52:55]
    v_mfma_f32_16x16x32_bf16 v[52:55], v[48:51], v[132:135], v[52:55]
    v_mfma_f32_16x16x32_bf16 v[52:55], v[48:51], v[136:139], v[52:55]
    v_mfma_f32_16x16x32_bf16 v[52:55], v[48:51], v[140:143], v[52:55]
    s_bitcmp1_b32 s86, s30
    s_cbranch_scc1 AGX_64
AGY_65:
    s_add_u32 s30, s30, 1
    s_mov_b32 exec_lo, s31
    s_mov_b32 exec_hi, 0
    s_nop 3
    ds_write_b128 v57, v[52:55]
    s_mov_b64 exec, -1
    v_add_u32 v57, 528, v57
    s_waitcnt lgkmcnt(0)
    buffer_load_dwordx4 v[104:107], v[204:205], s[56:59], 0 idxen offen sc1
    buffer_load_dwordx4 v[108:111], v[206:207], s[56:59], 0 idxen offen sc1
    buffer_load_dwordx4 v[112:115], v[208:209], s[56:59], 0 idxen offen sc1
    buffer_load_dwordx4 v[116:119], v[210:211], s[56:59], 0 idxen offen sc1
    buffer_load_dwordx4 v[120:123], v[212:213], s[56:59], 0 idxen offen sc1
    buffer_load_dwordx4 v[124:127], v[214:215], s[56:59], 0 idxen offen sc1
    buffer_load_dwordx4 v[128:131], v[216:217], s[56:59], 0 idxen offen sc1
    buffer_load_dwordx4 v[132:135], v[218:219], s[56:59], 0 idxen offen sc1
    buffer_load_dwordx4 v[136:139], v[220:221], s[56:59], 0 idxen offen sc1
    buffer_load_dwordx4 v[140:143], v[222:223], s[56:59], 0 idxen offen sc1
    ds_read_b128 v[52:55], v57
    ds_read_u16 v224, v56 offset:256
    ds_read_u16 v226, v56 offset:272
    ds_read_u16 v228, v56 offset:288
    ds_read_u16 v230, v56 offset:304
    ds_read_u16 v232, v56 offset:320
    ds_read_u16 v234, v56 offset:336
    ds_read_u16 v236, v56 offset:352
    ds_read_u16 v238, v56 offset:368
    ds_read_u16 v240, v56 offset:384
    ds_read_u16 v242, v56 offset:400
    v_add_u32 v56, 0x100, v56
    s_waitcnt vmcnt(20) lgkmcnt(10)
    v_mfma_f32_16x16x32_bf16 v[52:55], v[48:51], v[144:147], v[52:55]
    v_mfma_f32_16x16x32_bf16 v[52:55], v[48:51], v[148:151], v[52:55]
    v_mfma_f32_16x16x32_bf16 v[52:55], v[48:51], v[152:155], v[52:55]
    v_mfma_f32_16x16x32_bf16 v[52:55], v[48:51], v[156:159], v[52:55]
    v_mfma_f32_16x16x32_bf16 v[52:55], v[48:51], v[160:163], v[52:55]
    v_mfma_f32_16x16x32_bf16 v[52:55], v[48:51], v[164:167], v[52:55]
    v_mfma_f32_16x16x32_bf16 v[52:55], v[48:51], v[168:171], v[52:55]
    v_mfma_f32_16x16x32_bf16 v[52:55], v[48:51], v[172:175], v[52:55]
    v_mfma_f32_16x16x32_bf16 v[52:55], v[48:51], v[176:179], v[52:55]
    v_mfma_f32_16x16x32_bf16 v[52:55], v[48:51], v[180:183], v[52:55]
    s_bitcmp1_b32 s86, s30
    s_cbranch_scc1 AGX_66
AGY_67:
    s_add_u32 s30, s30, 1
    s_mov_b32 exec_lo, s31
    s_mov_b32 exec_hi, 0
    s_nop 3
    ds_write_b128 v57, v[52:55]
    s_mov_b64 exec, -1
    v_add_u32 v57, 528, v57
    s_mov_b32 s31, -1
    s_waitcnt lgkmcnt(0)
    buffer_load_dwordx4 v[144:147], v[224:225], s[56:59], 0 idxen offen sc1
    buffer_load_dwordx4 v[148:151], v[226:227], s[56:59], 0 idxen offen sc1
    buffer_load_dwordx4 v[152:155], v[228:229], s[56:59], 0 idxen offen sc1
    buffer_load_dwordx4 v[156:159], v[230:231], s[56:59], 0 idxen offen sc1
    buffer_load_dwordx4 v[160:163], v[232:233], s[56:59], 0 idxen offen sc1
    buffer_load_dwordx4 v[164:167], v[234:235], s[56:59], 0 idxen offen sc1
    buffer_load_dwordx4 v[168:171], v[236:237], s[56:59], 0 idxen offen sc1
    buffer_load_dwordx4 v[172:175], v[238:239], s[56:59], 0 idxen offen sc1
    buffer_load_dwordx4 v[176:179], v[240:241], s[56:59], 0 idxen offen sc1
    buffer_load_dwordx4 v[180:183], v[242:243], s[56:59], 0 idxen offen sc1
    ds_read_b128 v[52:55], v57
    ds_read_u16 v184, v56 offset:256
    ds_read_u16 v186, v56 offset:272
    ds_read_u16 v188, v56 offset:288
    ds_read_u16 v190, v56 offset:304
    ds_read_u16 v192, v56 offset:320
    ds_read_u16 v194, v56 offset:336
    ds_read_u16 v196, v56 offset:352
    ds_read_u16 v198, v56 offset:368
    ds_read_u16 v200, v56 offset:384
    ds_read_u16 v202, v56 offset:400
    v_add_u32 v56, 0x100, v56
    s_waitcnt vmcnt(20) lgkmcnt(10)
    v_mfma_f32_16x16x32_bf16 v[52:55], v[48:51], v[64:67], v[52:55]
    v_mfma_f32_16x16x32_bf16 v[52:55], v[48:51], v[68:71], v[52:55]
    v_mfma_f32_16x16x32_bf16 v[52:55], v[48:51], v[72:75], v[52:55]
    v_mfma_f32_16x16x32_bf16 v[52:55], v[48:51], v[76:79], v[52:55]
    v_mfma_f32_16x16x32_bf16 v[52:55], v[48:51], v[80:83], v[52:55]
    v_mfma_f32_16x16x32_bf16 v[52:55], v[48:51], v[84:87], v[52:55]
    v_mfma_f32_16x16x32_bf16 v[52:55], v[48:51], v[88:91], v[52:55]
    v_mfma_f32_16x16x32_bf16 v[52:55], v[48:51], v[92:95], v[52:55]
    v_mfma_f32_16x16x32_bf16 v[52:55], v[48:51], v[96:99], v[52:55]
    v_mfma_f32_16x16x32_bf16 v[52:55], v[48:51], v[100:103], v[52:55]
    s_bitcmp1_b32 s86, s30
    s_cbranch_scc1 AGX_68
AGY_69:
    s_add_u32 s30, s30, 1
    s_mov_b32 exec_lo, s31
    s_mov_b32 exec_hi, 0
    s_nop 3
    ds_write_b128 v57, v[52:55]
    s_mov_b64 exec, -1
    v_add_u32 v57, 528, v57
    s_sub_u32 s29, s29, 1
    s_cmp_lg_u32 s29, 0
    s_cbranch_scc1 AG_PL
    s_waitcnt lgkmcnt(0)
    buffer_load_dwordx4 v[64:67], v[184:185], s[56:59], 0 idxen offen sc1
    buffer_load_dwordx4 v[68:71], v[186:187], s[56:59], 0 idxen offen sc1
    buffer_load_dwordx4 v[72:75], v[188:189], s[56:59], 0 idxen offen sc1
    buffer_load_dwordx4 v[76:79], v[190:191], s[56:59], 0 idxen offen sc1
    buffer_load_dwordx4 v[80:83], v[192:193], s[56:59], 0 idxen offen sc1
    buffer_load_dwordx4 v[84:87], v[194:195], s[56:59], 0 idxen offen sc1
    buffer_load_dwordx4 v[88:91], v[196:197], s[56:59], 0 idxen offen sc1
    buffer_load_dwordx4 v[92:95], v[198:199], s[56:59], 0 idxen offen sc1
    buffer_load_dwordx4 v[96:99], v[200:201], s[56:59], 0 idxen offen sc1
    buffer_load_dwordx4 v[100:103], v[202:203], s[56:59], 0 idxen offen sc1
    ds_read_b128 v[52:55], v57
    s_waitcnt vmcnt(20) lgkmcnt(0)
    v_mfma_f32_16x16x32_bf16 v[52:55], v[48:51], v[104:107], v[52:55]
    v_mfma_f32_16x16x32_bf16 v[52:55], v[48:51], v[108:111], v[52:55]
    v_mfma_f32_16x16x32_bf16 v[52:55], v[48:51], v[112:115], v[52:55]
    v_mfma_f32_16x16x32_bf16 v[52:55], v[48:51], v[116:119], v[52:55]
    v_mfma_f32_16x16x32_bf16 v[52:55], v[48:51], v[120:123], v[52:55]
    v_mfma_f32_16x16x32_bf16 v[52:55], v[48:51], v[124:127], v[52:55]
    v_mfma_f32_16x16x32_bf16 v[52:55], v[48:51], v[128:131], v[52:55]
    v_mfma_f32_16x16x32_bf16 v[52:55], v[48:51], v[132:135], v[52:55]
    v_mfma_f32_16x16x32_bf16 v[52:55], v[48:51], v[136:139], v[52:55]
    v_mfma_f32_16x16x32_bf16 v[52:55], v[48:51], v[140:143], v[52:55]
    s_bitcmp1_b32 s86, s30
    s_cbranch_scc1 AGX_70
AGY_71:
    s_add_u32 s30, s30, 1
    s_mov_b32 exec_lo, s31
    s_mov_b32 exec_hi, 0
    s_nop 3
    ds_write_b128 v57, v[52:55]
    s_mov_b64 exec, -1
    v_add_u32 v57, 528, v57
    ds_read_b128 v[52:55], v57
    s_waitcnt vmcnt(10) lgkmcnt(0)
    v_mfma_f32_16x16x32_bf16 v[52:55], v[48:51], v[144:147], v[52:55]
    v_mfma_f32_16x16x32_bf16 v[52:55], v[48:51], v[148:151], v[52:55]
    v_mfma_f32_16x16x32_bf16 v[52:55], v[48:51], v[152:155], v[52:55]
    v_mfma_f32_16x16x32_bf16 v[52:55], v[48:51], v[156:159], v[52:55]
    v_mfma_f32_16x16x32_bf16 v[52:55], v[48:51], v[160:163], v[52:55]
    v_mfma_f32_16x16x32_bf16 v[52:55], v[48:51], v[164:167], v[52:55]
    v_mfma_f32_16x16x32_bf16 v[52:55], v[48:51], v[168:171], v[52:55]
    v_mfma_f32_16x16x32_bf16 v[52:55], v[48:51], v[172:175], v[52:55]
    v_mfma_f32_16x16x32_bf16 v[52:55], v[48:51], v[176:179], v[52:55]
    v_mfma_f32_16x16x32_bf16 v[52:55], v[48:51], v[180:183], v[52:55]
    s_bitcmp1_b32 s86, s30
    s_cbranch_scc1 AGX_72
AGY_73:
    s_add_u32 s30, s30, 1
    s_mov_b32 exec_lo, s31
    s_mov_b32 exec_hi, 0
    s_nop 3
    ds_write_b128 v57, v[52:55]
    s_mov_b64 exec, -1
    v_add_u32 v57, 528, v57
    ds_read_b128 v[52:55], v57
    s_waitcnt vmcnt(0) lgkmcnt(0)
    v_mfma_f32_16x16x32_bf16 v[52:55], v[48:51], v[64:67], v[52:55]
    v_mfma_f32_16x16x32_bf16 v[52:55], v[48:51], v[68:71], v[52:55]
    v_mfma_f32_16x16x32_bf16 v[52:55], v[48:51], v[72:75], v[52:55]
    v_mfma_f32_16x16x32_bf16 v[52:55], v[48:51], v[76:79], v[52:55]
    v_mfma_f32_16x16x32_bf16 v[52:55], v[48:51], v[80:83], v[52:55]
    v_mfma_f32_16x16x32_bf16 v[52:55], v[48:51], v[84:87], v[52:55]
    v_mfma_f32_16x16x32_bf16 v[52:55], v[48:51], v[88:91], v[52:55]
    v_mfma_f32_16x16x32_bf16 v[52:55], v[48:51], v[92:95], v[52:55]
    v_mfma_f32_16x16x32_bf16 v[52:55], v[48:51], v[96:99], v[52:55]
    v_mfma_f32_16x16x32_bf16 v[52:55], v[48:51], v[100:103], v[52:55]
    s_bitcmp1_b32 s86, s30
    s_cbranch_scc1 AGX_74
AGY_75:
    s_add_u32 s30, s30, 1
    s_mov_b32 exec_lo, s31
    s_mov_b32 exec_hi, 0
    s_nop 3
    ds_write_b128 v57, v[52:55]
    s_mov_b64 exec, -1
    v_add_u32 v57, 528, v57
    v_mov_b32 v4, 819212500
    v_mov_b32 v5, v4
    v_mov_b32 v6, v4
    v_mov_b32 v7, v4
    v_lshlrev_b32 v146, 4, v0
    v_add_u32 v146, s61, v146
    ds_write_b128 v146, v[4:7] offset:256
    ds_write_b128 v146, v[4:7] offset:1280
    ds_write_b128 v146, v[4:7] offset:2304
    ds_write_b128 v146, v[4:7] offset:3328
    ds_write_b32 v62, v63
    s_waitcnt lgkmcnt(0)
    s_setpc_b64 s[84:85]
AGX_64:
    v_subrev_u32 v2, 1024, v56
    ds_read_u16 v224, v2 offset:416
    ds_read_u16 v226, v2 offset:432
    ds_read_u16 v228, v2 offset:448
    ds_read_u16 v230, v2 offset:464
    ds_read_u16 v232, v2 offset:480
    ds_read_u16 v234, v2 offset:496
    s_waitcnt lgkmcnt(0)
    buffer_load_dwordx4 v[104:107], v[224:225], s[56:59], 0 idxen offen sc1
    buffer_load_dwordx4 v[108:111], v[226:227], s[56:59], 0 idxen offen sc1
    buffer_load_dwordx4 v[112:115], v[228:229], s[56:59], 0 idxen offen sc1
    buffer_load_dwordx4 v[116:119], v[230:231], s[56:59], 0 idxen offen sc1
    buffer_load_dwordx4 v[120:123], v[232:233], s[56:59], 0 idxen offen sc1
    buffer_load_dwordx4 v[124:127], v[234:235], s[56:59], 0 idxen offen sc1
    s_waitcnt vmcnt(0)
    v_mfma_f32_16x16x32_bf16 v[52:55], v[48:51], v[104:107], v[52:55]
    v_mfma_f32_16x16x32_bf16 v[52:55], v[48:51], v[108:111], v[52:55]
    v_mfma_f32_16x16x32_bf16 v[52:55], v[48:51], v[112:115], v[52:55]
    v_mfma_f32_16x16x32_bf16 v[52:55], v[48:51], v[116:119], v[52:55]
    v_mfma_f32_16x16x32_bf16 v[52:55], v[48:51], v[120:123], v[52:55]
    v_mfma_f32_16x16x32_bf16 v[52:55], v[48:51], v[124:127], v[52:55]
    s_nop 3
    s_branch AGY_65
AGX_66:
    v_subrev_u32 v2, 1024, v56
    ds_read_u16 v184, v2 offset:416
    ds_read_u16 v186, v2 offset:432
    ds_read_u16 v188, v2 offset:448
    ds_read_u16 v190, v2 offset:464
    ds_read_u16 v192, v2 offset:480
    ds_read_u16 v194, v2 offset:496
    s_waitcnt lgkmcnt(0)
    buffer_load_dwordx4 v[144:147], v[184:185], s[56:59], 0 idxen offen sc1
    buffer_load_dwordx4 v[148:151], v[186:187], s[56:59], 0 idxen offen sc1
    buffer_load_dwordx4 v[152:155], v[188:189], s[56:59], 0 idxen offen sc1
    buffer_load_dwordx4 v[156:159], v[190:191], s[56:59], 0 idxen offen sc1
    buffer_load_dwordx4 v[160:163], v[192:193], s[56:59], 0 idxen offen sc1
    buffer_load_dwordx4 v[164:167], v[194:195], s[56:59], 0 idxen offen sc1
    s_waitcnt vmcnt(0)
    v_mfma_f32_16x16x32_bf16 v[52:55], v[48:51], v[144:147], v[52:55]
    v_mfma_f32_16x16x32_bf16 v[52:55], v[48:51], v[148:151], v[52:55]
    v_mfma_f32_16x16x32_bf16 v[52:55], v[48:51], v[152:155], v[52:55]
    v_mfma_f32_16x16x32_bf16 v[52:55], v[48:51], v[156:159], v[52:55]
    v_mfma_f32_16x16x32_bf16 v[52:55], v[48:51], v[160:163], v[52:55]
    v_mfma_f32_16x16x32_bf16 v[52:55], v[48:51], v[164:167], v[52:55]
    s_nop 3
    s_branch AGY_67
AGX_68:
    v_subrev_u32 v2, 1024, v56
    ds_read_u16 v204, v2 offset:416
    ds_read_u16 v206, v2 offset:432
    ds_read_u16 v208, v2 offset:448
    ds_read_u16 v210, v2 offset:464
    ds_read_u16 v212, v2 offset:480
    ds_read_u16 v214, v2 offset:496
    s_waitcnt lgkmcnt(0)
    buffer_load_dwordx4 v[64:67], v[204:205], s[56:59], 0 idxen offen sc1
    buffer_load_dwordx4 v[68:71], v[206:207], s[56:59], 0 idxen offen sc1
    buffer_load_dwordx4 v[72:75], v[208:209], s[56:59], 0 idxen offen sc1
    buffer_load_dwordx4 v[76:79], v[210:211], s[56:59], 0 idxen offen sc1
    buffer_load_dwordx4 v[80:83], v[212:213], s[56:59], 0 idxen offen sc1
    buffer_load_dwordx4 v[84:87], v[214:215], s[56:59], 0 idxen offen sc1
    s_waitcnt vmcnt(0)
    v_mfma_f32_16x16x32_bf16 v[52:55], v[48:51], v[64:67], v[52:55]
    v_mfma_f32_16x16x32_bf16 v[52:55], v[48:51], v[68:71], v[52:55]
    v_mfma_f32_16x16x32_bf16 v[52:55], v[48:51], v[72:75], v[52:55]
    v_mfma_f32_16x16x32_bf16 v[52:55], v[48:51], v[76:79], v[52:55]
    v_mfma_f32_16x16x32_bf16 v[52:55], v[48:51], v[80:83], v[52:55]
    v_mfma_f32_16x16x32_bf16 v[52:55], v[48:51], v[84:87], v[52:55]
    s_nop 3
    s_branch AGY_69
AGX_70:
    v_subrev_u32 v2, 768, v56
    ds_read_u16 v224, v2 offset:416
    ds_read_u16 v226, v2 offset:432
    ds_read_u16 v228, v2 offset:448
    ds_read_u16 v230, v2 offset:464
    ds_read_u16 v232, v2 offset:480
    ds_read_u16 v234, v2 offset:496
    s_waitcnt lgkmcnt(0)
    buffer_load_dwordx4 v[104:107], v[224:225], s[56:59], 0 idxen offen sc1
    buffer_load_dwordx4 v[108:111], v[226:227], s[56:59], 0 idxen offen sc1
    buffer_load_dwordx4 v[112:115], v[228:229], s[56:59], 0 idxen offen sc1
    buffer_load_dwordx4 v[116:119], v[230:231], s[56:59], 0 idxen offen sc1
    buffer_load_dwordx4 v[120:123], v[232:233], s[56:59], 0 idxen offen sc1
    buffer_load_dwordx4 v[124:127], v[234:235], s[56:59], 0 idxen offen sc1
    s_waitcnt vmcnt(0)
    v_mfma_f32_16x16x32_bf16 v[52:55], v[48:51], v[104:107], v[52:55]
    v_mfma_f32_16x16x32_bf16 v[52:55], v[48:51], v[108:111], v[52:55]
    v_mfma_f32_16x16x32_bf16 v[52:55], v[48:51], v[112:115], v[52:55]
    v_mfma_f32_16x16x32_bf16 v[52:55], v[48:51], v[116:119], v[52:55]
    v_mfma_f32_16x16x32_bf16 v[52:55], v[48:51], v[120:123], v[52:55]
    v_mfma_f32_16x16x32_bf16 v[52:55], v[48:51], v[124:127], v[52:55]
    s_nop 3
    s_branch AGY_71
AGX_72:
    v_subrev_u32 v2, 512, v56
    ds_read_u16 v204, v2 offset:416
    ds_read_u16 v206, v2 offset:432
    ds_read_u16 v208, v2 offset:448
    ds_read_u16 v210, v2 offset:464
    ds_read_u16 v212, v2 offset:480
    ds_read_u16 v214, v2 offset:496
    s_waitcnt lgkmcnt(0)
    buffer_load_dwordx4 v[144:147], v[204:205], s[56:59], 0 idxen offen sc1
    buffer_load_dwordx4 v[148:151], v[206:207], s[56:59], 0 idxen offen sc1
    buffer_load_dwordx4 v[152:155], v[208:209], s[56:59], 0 idxen offen sc1
    buffer_load_dwordx4 v[156:159], v[210:211], s[56:59], 0 idxen offen sc1
    buffer_load_dwordx4 v[160:163], v[212:213], s[56:59], 0 idxen offen sc1
    buffer_load_dwordx4 v[164:167], v[214:215], s[56:59], 0 idxen offen sc1
    s_waitcnt vmcnt(0)
    v_mfma_f32_16x16x32_bf16 v[52:55], v[48:51], v[144:147], v[52:55]
    v_mfma_f32_16x16x32_bf16 v[52:55], v[48:51], v[148:151], v[52:55]
    v_mfma_f32_16x16x32_bf16 v[52:55], v[48:51], v[152:155], v[52:55]
    v_mfma_f32_16x16x32_bf16 v[52:55], v[48:51], v[156:159], v[52:55]
    v_mfma_f32_16x16x32_bf16 v[52:55], v[48:51], v[160:163], v[52:55]
    v_mfma_f32_16x16x32_bf16 v[52:55], v[48:51], v[164:167], v[52:55]
    s_nop 3
    s_branch AGY_73
AGX_74:
    v_subrev_u32 v2, 256, v56
    ds_read_u16 v204, v2 offset:416
    ds_read_u16 v206, v2 offset:432
    ds_read_u16 v208, v2 offset:448
    ds_read_u16 v210, v2 offset:464
    ds_read_u16 v212, v2 offset:480
    ds_read_u16 v214, v2 offset:496
    s_waitcnt lgkmcnt(0)
    buffer_load_dwordx4 v[64:67], v[204:205], s[56:59], 0 idxen offen sc1
    buffer_load_dwordx4 v[68:71], v[206:207], s[56:59], 0 idxen offen sc1
    buffer_load_dwordx4 v[72:75], v[208:209], s[56:59], 0 idxen offen sc1
    buffer_load_dwordx4 v[76:79], v[210:211], s[56:59], 0 idxen offen sc1
    buffer_load_dwordx4 v[80:83], v[212:213], s[56:59], 0 idxen offen sc1
    buffer_load_dwordx4 v[84:87], v[214:215], s[56:59], 0 idxen offen sc1
    s_waitcnt vmcnt(0)
    v_mfma_f32_16x16x32_bf16 v[52:55], v[48:51], v[64:67], v[52:55]
    v_mfma_f32_16x16x32_bf16 v[52:55], v[48:51], v[68:71], v[52:55]
    v_mfma_f32_16x16x32_bf16 v[52:55], v[48:51], v[72:75], v[52:55]
    v_mfma_f32_16x16x32_bf16 v[52:55], v[48:51], v[76:79], v[52:55]
    v_mfma_f32_16x16x32_bf16 v[52:55], v[48:51], v[80:83], v[52:55]
    v_mfma_f32_16x16x32_bf16 v[52:55], v[48:51], v[84:87], v[52:55]
    s_nop 3
    s_branch AGY_75
F_END:
    s_endpgm
F_PROD:
    s_setprio 3
    s_mov_b32 s36, s26
    s_mov_b32 s37, s27
    s_mov_b32 s38, 1605632
    s_mov_b32 s39, 0x00020000
    v_mov_b32 v240, v1
    v_lshlrev_b32 v242, 7, v1
    v_add_u32 v242, s31, v242
    v_bfe_u32 v243, v1, 1, 3
    v_xor_b32 v243, v243, v2
    v_lshl_add_u32 v245, v243, 4, v242
    v_xor_b32 v246, 64, v245
    v_cmp_eq_u32 s[54:55], 3, v2
    s_mov_b32 s49, s70
    s_mov_b32 s46, 0xffff0000
    s_mov_b32 s48, 0x3727c5ac
    s_mov_b32 s51, 0x3c800000
    v_mov_b32 v220, 0x3f803f80
    v_mov_b32 v221, 0x3f803f80
    v_mov_b32 v222, 0x3f803f80
    v_mov_b32 v223, 0x3f803f80
    v_and_b32 v4, 7, v0
    v_lshrrev_b32 v6, 4, v0
    v_xor_b32 v4, v4, v6
    v_lshlrev_b32 v4, 4, v4
    v_lshrrev_b32 v6, 3, v0
    v_lshl_add_u32 v4, v6, 7, v4
    v_xor_b32 v5, 64, v4
    s_add_u32 s53, s52, 16384
    s_mov_b32 s57, 16384
    s_mov_b32 s63, 1
    s_mov_b64 s[58:59], 0
    s_mov_b32 s80, 0
    v_and_b32 v6, 3, v0
    v_lshlrev_b32 v6, 8, v6
    v_add_u32 v6, 129024, v6
    s_lshr_b32 s62, s52, 15
    s_mul_i32 s28, s62, 320
    s_add_u32 s28, s28, 5177344
    v_min_u32 v8, 54, v0
    v_lshl_add_u32 v8, v8, 6, s28
    s_barrier
    s_sub_u32 s64, s90, 1000
    s_subb_u32 s65, s91, 0
    s_add_u32 s66, s90, 0x10000000
    s_addc_u32 s67, s91, 0
    s_waitcnt vmcnt(10)
    v_mfma_f32_16x16x32_bf16 v[224:227], v[220:223], v[160:163], 0
    v_mfma_f32_16x16x32_bf16 v[224:227], v[220:223], v[164:167], v[224:227]
    v_lshlrev_b32 v212, 16, v160
    v_and_b32 v213, s46, v160
    v_lshlrev_b32 v214, 16, v161
    v_and_b32 v215, s46, v161
    v_lshlrev_b32 v216, 16, v162
    v_and_b32 v217, s46, v162
    v_lshlrev_b32 v218, 16, v163
    v_and_b32 v219, s46, v163
    v_lshlrev_b32 v236, 16, v164
    v_and_b32 v237, s46, v164
    v_lshlrev_b32 v238, 16, v165
    v_and_b32 v239, s46, v165
    v_lshlrev_b32 v200, 16, v166
    v_and_b32 v201, s46, v166
    v_lshlrev_b32 v202, 16, v167
    v_and_b32 v203, s46, v167
    v_mul_f32 v230, s51, v224
    v_pk_add_f32 v[212:213], v[212:213], v[230:231] op_sel_hi:[1,0] neg_lo:[0,1] neg_hi:[0,1]
    v_pk_add_f32 v[214:215], v[214:215], v[230:231] op_sel_hi:[1,0] neg_lo:[0,1] neg_hi:[0,1]
    v_pk_add_f32 v[216:217], v[216:217], v[230:231] op_sel_hi:[1,0] neg_lo:[0,1] neg_hi:[0,1]
    v_pk_add_f32 v[218:219], v[218:219], v[230:231] op_sel_hi:[1,0] neg_lo:[0,1] neg_hi:[0,1]
    v_pk_add_f32 v[236:237], v[236:237], v[230:231] op_sel_hi:[1,0] neg_lo:[0,1] neg_hi:[0,1]
    v_pk_add_f32 v[238:239], v[238:239], v[230:231] op_sel_hi:[1,0] neg_lo:[0,1] neg_hi:[0,1]
    v_pk_add_f32 v[200:201], v[200:201], v[230:231] op_sel_hi:[1,0] neg_lo:[0,1] neg_hi:[0,1]
    v_pk_add_f32 v[202:203], v[202:203], v[230:231] op_sel_hi:[1,0] neg_lo:[0,1] neg_hi:[0,1]
    v_pk_mul_f32 v[228:229], v[212:213], v[212:213]
    v_pk_mul_f32 v[230:231], v[214:215], v[214:215]
    v_pk_fma_f32 v[228:229], v[216:217], v[216:217], v[228:229]
    v_pk_fma_f32 v[230:231], v[218:219], v[218:219], v[230:231]
    v_pk_fma_f32 v[228:229], v[236:237], v[236:237], v[228:229]
    v_pk_fma_f32 v[230:231], v[238:239], v[238:239], v[230:231]
    v_pk_fma_f32 v[228:229], v[200:201], v[200:201], v[228:229]
    v_pk_fma_f32 v[230:231], v[202:203], v[202:203], v[230:231]
    v_pk_add_f32 v[228:229], v[228:229], v[230:231]
    v_add_f32 v228, v228, v229
    v_mov_b32 v230, v228
    v_mov_b32 v231, v228
    s_nop 1
    v_permlane16_swap_b32 v230, v231
    s_nop 1
    v_add_f32 v228, v230, v231
    v_mov_b32 v230, v228
    v_mov_b32 v231, v228
    s_nop 1
    v_permlane32_swap_b32 v230, v231
    s_nop 1
    v_add_f32 v228, v230, v231
    v_mov_b32 v229, s48
    v_fmac_f32 v229, s51, v228
    v_rsq_f32 v230, v229
    s_nop 0
    v_pk_mul_f32 v[212:213], v[212:213], v[230:231] op_sel_hi:[1,0]
    v_pk_mul_f32 v[214:215], v[214:215], v[230:231] op_sel_hi:[1,0]
    v_pk_mul_f32 v[216:217], v[216:217], v[230:231] op_sel_hi:[1,0]
    v_pk_mul_f32 v[218:219], v[218:219], v[230:231] op_sel_hi:[1,0]
    v_pk_mul_f32 v[236:237], v[236:237], v[230:231] op_sel_hi:[1,0]
    v_pk_mul_f32 v[238:239], v[238:239], v[230:231] op_sel_hi:[1,0]
    v_pk_mul_f32 v[200:201], v[200:201], v[230:231] op_sel_hi:[1,0]
    v_pk_mul_f32 v[202:203], v[202:203], v[230:231] op_sel_hi:[1,0]
    v_cvt_pk_bf16_f32 v232, v212, v213
    v_cvt_pk_bf16_f32 v233, v214, v215
    v_cvt_pk_bf16_f32 v234, v216, v217
    v_cvt_pk_bf16_f32 v235, v218, v219
    v_cvt_pk_bf16_f32 v236, v236, v237
    v_cvt_pk_bf16_f32 v237, v238, v239
    v_cvt_pk_bf16_f32 v238, v200, v201
    v_cvt_pk_bf16_f32 v239, v202, v203
    s_lshr_b32 s28, s49, 7
    s_sub_u32 s28, 12500, s28
    v_cmp_gt_i32 vcc, s28, v240
    v_and_b32 v228, 0xffff, v239
    v_or_b32 v228, 0x3f800000, v228
    s_cmp_eq_u32 s47, 0
    s_cselect_b32 s38, 0, s38
    s_and_b64 vcc, vcc, s[54:55]
    s_nop 0
    v_cndmask_b32 v239, v239, v228, vcc
    buffer_store_dwordx4 v[232:235], v247, s[36:39], s49 offen sc1
    buffer_store_dwordx4 v[236:239], v247, s[36:39], s49 offen offset:64 sc1
    s_waitcnt vmcnt(2)
    s_mov_b64 exec, 1
    ds_add_u32 v15, v3 offset:36
    s_mov_b64 exec, -1
    v_mfma_f32_16x16x32_bf16 v[224:227], v[220:223], v[168:171], 0
    v_mfma_f32_16x16x32_bf16 v[224:227], v[220:223], v[172:175], v[224:227]
    v_lshlrev_b32 v212, 16, v168
    v_and_b32 v213, s46, v168
    v_lshlrev_b32 v214, 16, v169
    v_and_b32 v215, s46, v169
    v_lshlrev_b32 v216, 16, v170
    v_and_b32 v217, s46, v170
    v_lshlrev_b32 v218, 16, v171
    v_and_b32 v219, s46, v171
    v_lshlrev_b32 v208, 16, v172
    v_and_b32 v209, s46, v172
    v_lshlrev_b32 v210, 16, v173
    v_and_b32 v211, s46, v173
    v_lshlrev_b32 v200, 16, v174
    v_and_b32 v201, s46, v174
    v_lshlrev_b32 v202, 16, v175
    v_and_b32 v203, s46, v175
    v_mul_f32 v230, s51, v224
    v_pk_add_f32 v[212:213], v[212:213], v[230:231] op_sel_hi:[1,0] neg_lo:[0,1] neg_hi:[0,1]
    v_pk_add_f32 v[214:215], v[214:215], v[230:231] op_sel_hi:[1,0] neg_lo:[0,1] neg_hi:[0,1]
    v_pk_add_f32 v[216:217], v[216:217], v[230:231] op_sel_hi:[1,0] neg_lo:[0,1] neg_hi:[0,1]
    v_pk_add_f32 v[218:219], v[218:219], v[230:231] op_sel_hi:[1,0] neg_lo:[0,1] neg_hi:[0,1]
    v_pk_add_f32 v[208:209], v[208:209], v[230:231] op_sel_hi:[1,0] neg_lo:[0,1] neg_hi:[0,1]
    v_pk_add_f32 v[210:211], v[210:211], v[230:231] op_sel_hi:[1,0] neg_lo:[0,1] neg_hi:[0,1]
    v_pk_add_f32 v[200:201], v[200:201], v[230:231] op_sel_hi:[1,0] neg_lo:[0,1] neg_hi:[0,1]
    v_pk_add_f32 v[202:203], v[202:203], v[230:231] op_sel_hi:[1,0] neg_lo:[0,1] neg_hi:[0,1]
    v_pk_mul_f32 v[228:229], v[212:213], v[212:213]
    v_pk_mul_f32 v[230:231], v[214:215], v[214:215]
    v_pk_fma_f32 v[228:229], v[216:217], v[216:217], v[228:229]
    v_pk_fma_f32 v[230:231], v[218:219], v[218:219], v[230:231]
    v_pk_fma_f32 v[228:229], v[208:209], v[208:209], v[228:229]
    v_pk_fma_f32 v[230:231], v[210:211], v[210:211], v[230:231]
    v_pk_fma_f32 v[228:229], v[200:201], v[200:201], v[228:229]
    v_pk_fma_f32 v[230:231], v[202:203], v[202:203], v[230:231]
    v_pk_add_f32 v[228:229], v[228:229], v[230:231]
    v_add_f32 v228, v228, v229
    v_mov_b32 v230, v228
    v_mov_b32 v231, v228
    s_nop 1
    v_permlane16_swap_b32 v230, v231
    s_nop 1
    v_add_f32 v228, v230, v231
    v_mov_b32 v230, v228
    v_mov_b32 v231, v228
    s_nop 1
    v_permlane32_swap_b32 v230, v231
    s_nop 1
    v_add_f32 v228, v230, v231
    v_mov_b32 v229, s48
    v_fmac_f32 v229, s51, v228
    v_rsq_f32 v230, v229
    s_nop 0
    v_pk_mul_f32 v[212:213], v[212:213], v[230:231] op_sel_hi:[1,0]
    v_pk_mul_f32 v[214:215], v[214:215], v[230:231] op_sel_hi:[1,0]
    v_pk_mul_f32 v[216:217], v[216:217], v[230:231] op_sel_hi:[1,0]
    v_pk_mul_f32 v[218:219], v[218:219], v[230:231] op_sel_hi:[1,0]
    v_pk_mul_f32 v[208:209], v[208:209], v[230:231] op_sel_hi:[1,0]
    v_pk_mul_f32 v[210:211], v[210:211], v[230:231] op_sel_hi:[1,0]
    v_pk_mul_f32 v[200:201], v[200:201], v[230:231] op_sel_hi:[1,0]
    v_pk_mul_f32 v[202:203], v[202:203], v[230:231] op_sel_hi:[1,0]
    v_cvt_pk_bf16_f32 v204, v212, v213
    v_cvt_pk_bf16_f32 v205, v214, v215
    v_cvt_pk_bf16_f32 v206, v216, v217
    v_cvt_pk_bf16_f32 v207, v218, v219
    v_cvt_pk_bf16_f32 v208, v208, v209
    v_cvt_pk_bf16_f32 v209, v210, v211
    v_cvt_pk_bf16_f32 v210, v200, v201
    v_cvt_pk_bf16_f32 v211, v202, v203
    v_and_b32 v228, 0xffff, v211
    v_or_b32 v228, 0x3f800000, v228
    v_cndmask_b32 v211, v211, v228, s[54:55]
    ds_write_b128 v245, v[204:207] offset:0
    ds_write_b128 v246, v[208:211] offset:0
    s_waitcnt vmcnt(0)
    s_mov_b64 exec, 1
    ds_add_rtn_u32 v228, v15, v3 offset:4
    s_waitcnt lgkmcnt(0)
    v_readfirstlane_b32 s29, v228
    s_mov_b64 exec, -1
    s_nop 3
    s_cmp_lg_u32 s29, 3
    s_cbranch_scc1 LH_76
    s_lshl_b32 s30, s2, 6
    s_add_u32 s30, s30, 5177344
    s_memrealtime s[82:83]
    v_lshl_add_u32 v230, v0, 3, s30
    s_waitcnt lgkmcnt(0)
    v_mov_b32 v228, s82
    v_mov_b32 v229, s83
    s_mov_b64 exec, 0xff
    global_store_dwordx2 v230, v[228:229], s[26:27] sc1
    s_mov_b64 exec, -1
LH_76:
    v_mfma_f32_16x16x32_bf16 v[224:227], v[220:223], v[176:179], 0
    v_mfma_f32_16x16x32_bf16 v[224:227], v[220:223], v[180:183], v[224:227]
    v_lshlrev_b32 v212, 16, v176
    v_and_b32 v213, s46, v176
    v_lshlrev_b32 v214, 16, v177
    v_and_b32 v215, s46, v177
    v_lshlrev_b32 v216, 16, v178
    v_and_b32 v217, s46, v178
    v_lshlrev_b32 v218, 16, v179
    v_and_b32 v219, s46, v179
    v_lshlrev_b32 v208, 16, v180
    v_and_b32 v209, s46, v180
    v_lshlrev_b32 v210, 16, v181
    v_and_b32 v211, s46, v181
    v_lshlrev_b32 v200, 16, v182
    v_and_b32 v201, s46, v182
    v_lshlrev_b32 v202, 16, v183
    v_and_b32 v203, s46, v183
    v_mul_f32 v230, s51, v224
    v_pk_add_f32 v[212:213], v[212:213], v[230:231] op_sel_hi:[1,0] neg_lo:[0,1] neg_hi:[0,1]
    v_pk_add_f32 v[214:215], v[214:215], v[230:231] op_sel_hi:[1,0] neg_lo:[0,1] neg_hi:[0,1]
    v_pk_add_f32 v[216:217], v[216:217], v[230:231] op_sel_hi:[1,0] neg_lo:[0,1] neg_hi:[0,1]
    v_pk_add_f32 v[218:219], v[218:219], v[230:231] op_sel_hi:[1,0] neg_lo:[0,1] neg_hi:[0,1]
    v_pk_add_f32 v[208:209], v[208:209], v[230:231] op_sel_hi:[1,0] neg_lo:[0,1] neg_hi:[0,1]
    v_pk_add_f32 v[210:211], v[210:211], v[230:231] op_sel_hi:[1,0] neg_lo:[0,1] neg_hi:[0,1]
    v_pk_add_f32 v[200:201], v[200:201], v[230:231] op_sel_hi:[1,0] neg_lo:[0,1] neg_hi:[0,1]
    v_pk_add_f32 v[202:203], v[202:203], v[230:231] op_sel_hi:[1,0] neg_lo:[0,1] neg_hi:[0,1]
    v_pk_mul_f32 v[228:229], v[212:213], v[212:213]
    v_pk_mul_f32 v[230:231], v[214:215], v[214:215]
    v_pk_fma_f32 v[228:229], v[216:217], v[216:217], v[228:229]
    v_pk_fma_f32 v[230:231], v[218:219], v[218:219], v[230:231]
    v_pk_fma_f32 v[228:229], v[208:209], v[208:209], v[228:229]
    v_pk_fma_f32 v[230:231], v[210:211], v[210:211], v[230:231]
    v_pk_fma_f32 v[228:229], v[200:201], v[200:201], v[228:229]
    v_pk_fma_f32 v[230:231], v[202:203], v[202:203], v[230:231]
    v_pk_add_f32 v[228:229], v[228:229], v[230:231]
    v_add_f32 v228, v228, v229
    v_mov_b32 v230, v228
    v_mov_b32 v231, v228
    s_nop 1
    v_permlane16_swap_b32 v230, v231
    s_nop 1
    v_add_f32 v228, v230, v231
    v_mov_b32 v230, v228
    v_mov_b32 v231, v228
    s_nop 1
    v_permlane32_swap_b32 v230, v231
    s_nop 1
    v_add_f32 v228, v230, v231
    v_mov_b32 v229, s48
    v_fmac_f32 v229, s51, v228
    v_rsq_f32 v230, v229
    s_nop 0
    v_pk_mul_f32 v[212:213], v[212:213], v[230:231] op_sel_hi:[1,0]
    v_pk_mul_f32 v[214:215], v[214:215], v[230:231] op_sel_hi:[1,0]
    v_pk_mul_f32 v[216:217], v[216:217], v[230:231] op_sel_hi:[1,0]
    v_pk_mul_f32 v[218:219], v[218:219], v[230:231] op_sel_hi:[1,0]
    v_pk_mul_f32 v[208:209], v[208:209], v[230:231] op_sel_hi:[1,0]
    v_pk_mul_f32 v[210:211], v[210:211], v[230:231] op_sel_hi:[1,0]
    v_pk_mul_f32 v[200:201], v[200:201], v[230:231] op_sel_hi:[1,0]
    v_pk_mul_f32 v[202:203], v[202:203], v[230:231] op_sel_hi:[1,0]
    v_cvt_pk_bf16_f32 v204, v212, v213
    v_cvt_pk_bf16_f32 v205, v214, v215
    v_cvt_pk_bf16_f32 v206, v216, v217
    v_cvt_pk_bf16_f32 v207, v218, v219
    v_cvt_pk_bf16_f32 v208, v208, v209
    v_cvt_pk_bf16_f32 v209, v210, v211
    v_cvt_pk_bf16_f32 v210, v200, v201
    v_cvt_pk_bf16_f32 v211, v202, v203
    v_and_b32 v228, 0xffff, v211
    v_or_b32 v228, 0x3f800000, v228
    v_cndmask_b32 v211, v211, v228, s[54:55]
    ds_write_b128 v245, v[204:207] offset:2048
    ds_write_b128 v246, v[208:211] offset:2048
    s_waitcnt lgkmcnt(0)
    s_mov_b64 exec, 1
    ds_add_rtn_u32 v228, v15, v3 offset:40
    s_waitcnt lgkmcnt(0)
    v_readfirstlane_b32 s29, v228
    s_mov_b64 exec, -1
    s_nop 3
    s_cmp_lg_u32 s29, 3
    s_cbranch_scc1 LA_77
    v_mov_b32 v228, 1
    ds_max_u32 v15, v228 offset:0
LA_77:
    s_mov_b32 s50, 262144
W_78:
    ds_read_b32 v7, v15 offset:40
    s_waitcnt lgkmcnt(0)
    v_readfirstlane_b32 s29, v7
    s_nop 3
    s_cmp_ge_u32 s29, 4
    s_cbranch_scc1 W_79
    s_sleep 1
    s_sub_u32 s50, s50, 1
    s_cmp_lg_u32 s50, 0
    s_cbranch_scc1 W_78
W_79:
    s_mov_b32 s36, s26
    s_mov_b32 s37, s27
    s_mov_b32 s38, 1605632
    s_mov_b32 s39, 0x00020000
    s_add_u32 s38, s52, 320000
    s_sub_u32 s49, s38, 1
    s_setprio 3
    s_lshr_b32 s60, s53, 15
    s_add_u32 s61, s53, 16383
    s_lshr_b32 s61, s61, 15
    s_cmp_gt_u32 s61, s60
    s_cselect_b32 s61, 0x3ff, 0x1f
    s_sub_u32 s60, s60, s62
    s_mul_i32 s60, s60, 5
    s_mov_b32 s50, 262143
    global_load_dwordx2 v[16:17], v8, s[26:27] sc1
    s_sleep 3
    global_load_dwordx2 v[18:19], v8, s[26:27] sc1
    s_sleep 3
    global_load_dwordx2 v[20:21], v8, s[26:27] sc1
    s_sleep 3
F_P0:
    global_load_dwordx2 v[22:23], v8, s[26:27] sc1
    s_add_u32 s80, s80, 1
    s_waitcnt vmcnt(3)
    v_cmp_le_u64 vcc, s[64:65], v[16:17]
    v_cmp_ge_u64 s[58:59], s[66:67], v[16:17]
    s_nop 3
    s_and_b64 s[58:59], s[58:59], vcc
    s_lshr_b64 s[30:31], s[58:59], s60
    s_and_b32 s30, s30, s61
    s_cmp_eq_u32 s30, s61
    s_cbranch_scc1 F_PL
    s_sleep 2
    global_load_dwordx2 v[16:17], v8, s[26:27] sc1
    s_add_u32 s80, s80, 1
    s_waitcnt vmcnt(3)
    v_cmp_le_u64 vcc, s[64:65], v[18:19]
    v_cmp_ge_u64 s[58:59], s[66:67], v[18:19]
    s_nop 3
    s_and_b64 s[58:59], s[58:59], vcc
    s_lshr_b64 s[30:31], s[58:59], s60
    s_and_b32 s30, s30, s61
    s_cmp_eq_u32 s30, s61
    s_cbranch_scc1 F_PL
    s_sleep 2
    global_load_dwordx2 v[18:19], v8, s[26:27] sc1
    s_add_u32 s80, s80, 1
    s_waitcnt vmcnt(3)
    v_cmp_le_u64 vcc, s[64:65], v[20:21]
    v_cmp_ge_u64 s[58:59], s[66:67], v[20:21]
    s_nop 3
    s_and_b64 s[58:59], s[58:59], vcc
    s_lshr_b64 s[30:31], s[58:59], s60
    s_and_b32 s30, s30, s61
    s_cmp_eq_u32 s30, s61
    s_cbranch_scc1 F_PL
    s_sleep 2
    global_load_dwordx2 v[20:21], v8, s[26:27] sc1
    s_add_u32 s80, s80, 1
    s_waitcnt vmcnt(3)
    v_cmp_le_u64 vcc, s[64:65], v[22:23]
    v_cmp_ge_u64 s[58:59], s[66:67], v[22:23]
    s_nop 3
    s_and_b64 s[58:59], s[58:59], vcc
    s_lshr_b64 s[30:31], s[58:59], s60
    s_and_b32 s30, s30, s61
    s_cmp_eq_u32 s30, s61
    s_cbranch_scc1 F_PL
    s_sleep 2
    s_and_b32 s28, s50, 31
    s_cmp_lg_u32 s28, 0
    s_cbranch_scc1 EP_80
    v_mov_b32 v26, 0
    global_load_dwordx2 v[24:25], v26, s[24:25] sc1
    s_waitcnt vmcnt(0)
    v_readfirstlane_b32 s28, v24
    v_readfirstlane_b32 s29, v25
    s_nop 3
    s_cmp_eq_u64 s[28:29], 0
    s_cbranch_scc1 EP_80
    s_not_b64 s[64:65], s[28:29]
EP_80:
    s_sub_u32 s50, s50, 1
    s_cmp_lg_u32 s50, 0
    s_cbranch_scc1 F_P0
F_PL:
    s_cmp_lg_u32 s63, 2
    s_cbranch_scc1 F_PL2
    s_mov_b32 s50, 262144
W_81:
    ds_read_b32 v7, v15 offset:8
    s_waitcnt lgkmcnt(0)
    v_readfirstlane_b32 s29, v7
    s_nop 3
    s_cmp_ge_u32 s29, 4
    s_cbranch_scc1 W_82
    s_sleep 1
    s_sub_u32 s50, s50, 1
    s_cmp_lg_u32 s50, 0
    s_cbranch_scc1 W_81
W_82:
F_PL2:
    s_cmp_lt_u32 s63, 4
    s_cbranch_scc1 F_PH
    s_sub_u32 s56, s63, 3
    s_mov_b32 s50, 262144
    s_sleep 32
F_PP:
    ds_read_b32 v7, v6
    s_waitcnt lgkmcnt(0)
    v_cmp_gt_u32 vcc, s56, v7
    s_nop 4
    s_cbranch_vccz F_PH
    s_sleep 8
    s_sub_u32 s50, s50, 1
    s_cmp_lg_u32 s50, 0
    s_cbranch_scc1 F_PP
F_PH:
    s_lshr_b32 s60, s53, 15
    s_add_u32 s61, s53, 16383
    s_min_u32 s61, s61, s49
    s_lshr_b32 s61, s61, 15
    s_cmp_gt_u32 s61, s60
    s_cselect_b32 s61, 0x3ff, 0x1f
    s_sub_u32 s60, s60, s62
    s_mul_i32 s60, s60, 5
    s_mov_b32 s50, 262144
F_PH1:
    s_lshr_b64 s[30:31], s[58:59], s60
    s_and_b32 s30, s30, s61
    s_cmp_eq_u32 s30, s61
    s_cbranch_scc1 F_PGO
    s_add_u32 s80, s80, 1
    global_load_dwordx2 v[10:11], v8, s[26:27] sc1
    v_mov_b32 v9, s63
    s_waitcnt vmcnt(0)
    ds_max_u32 v15, v9 offset:0
    v_cmp_le_u64 vcc, s[64:65], v[10:11]
    v_cmp_ge_u64 s[58:59], s[66:67], v[10:11]
    s_nop 3
    s_and_b64 s[58:59], s[58:59], vcc
    s_sub_u32 s50, s50, 1
    s_and_b32 s28, s50, 31
    s_cmp_lg_u32 s28, 0
    s_cbranch_scc1 EP_83
    v_mov_b32 v26, 0
    global_load_dwordx2 v[24:25], v26, s[24:25] sc1
    s_waitcnt vmcnt(0)
    v_readfirstlane_b32 s28, v24
    v_readfirstlane_b32 s29, v25
    s_nop 3
    s_cmp_eq_u64 s[28:29], 0
    s_cbranch_scc1 EP_83
    s_not_b64 s[64:65], s[28:29]
EP_83:
    s_cmp_lg_u32 s50, 0
    s_cbranch_scc1 F_PH1
F_PGO:
    s_and_b32 s57, s57, 0xffff
    s_mov_b32 m0, s57
    s_add_u32 s57, s57, 4096
    buffer_load_dwordx4 v4, s[36:39], s53 offen offset:0 sc1 lds
    buffer_load_dwordx4 v5, s[36:39], s53 offen offset:1024 sc1 lds
    buffer_load_dwordx4 v4, s[36:39], s53 offen offset:2048 sc1 lds
    buffer_load_dwordx4 v5, s[36:39], s53 offen offset:3072 sc1 lds
    s_add_u32 s53, s53, 4096
    s_mov_b32 m0, s57
    s_add_u32 s57, s57, 4096
    buffer_load_dwordx4 v4, s[36:39], s53 offen offset:0 sc1 lds
    buffer_load_dwordx4 v5, s[36:39], s53 offen offset:1024 sc1 lds
    buffer_load_dwordx4 v4, s[36:39], s53 offen offset:2048 sc1 lds
    buffer_load_dwordx4 v5, s[36:39], s53 offen offset:3072 sc1 lds
    s_add_u32 s53, s53, 4096
    s_mov_b32 m0, s57
    s_add_u32 s57, s57, 4096
    buffer_load_dwordx4 v4, s[36:39], s53 offen offset:0 sc1 lds
    buffer_load_dwordx4 v5, s[36:39], s53 offen offset:1024 sc1 lds
    buffer_load_dwordx4 v4, s[36:39], s53 offen offset:2048 sc1 lds
    buffer_load_dwordx4 v5, s[36:39], s53 offen offset:3072 sc1 lds
    s_add_u32 s53, s53, 4096
    s_mov_b32 m0, s57
    s_add_u32 s57, s57, 4096
    buffer_load_dwordx4 v4, s[36:39], s53 offen offset:0 sc1 lds
    buffer_load_dwordx4 v5, s[36:39], s53 offen offset:1024 sc1 lds
    buffer_load_dwordx4 v4, s[36:39], s53 offen offset:2048 sc1 lds
    buffer_load_dwordx4 v5, s[36:39], s53 offen offset:3072 sc1 lds
    s_add_u32 s53, s53, 4096
    v_mov_b32 v9, s63
    s_cmp_eq_u32 s63, 1
    s_cbranch_scc1 F_PN
    s_waitcnt vmcnt(16)
    ds_max_u32 v15, v9 offset:0
F_PN:
    s_add_u32 s63, s63, 1
    s_cmp_lt_u32 s63, 20
    s_cbranch_scc1 F_PL
    v_mov_b32 v9, 0x7fffffff
    s_waitcnt vmcnt(0)
    ds_max_u32 v15, v9 offset:0
    s_mov_b32 s50, 262144
W_84:
    ds_read_b32 v7, v15 offset:24
    s_waitcnt lgkmcnt(0)
    v_readfirstlane_b32 s29, v7
    s_nop 3
    s_cmp_ge_u32 s29, 1
    s_cbranch_scc1 W_85
    s_sleep 8
    s_sub_u32 s50, s50, 1
    s_cmp_lg_u32 s50, 0
    s_cbranch_scc1 W_84
W_85:
    s_mov_b32 s50, 262144
W_86:
    ds_read_b32 v7, v15 offset:24
    s_waitcnt lgkmcnt(0)
    v_readfirstlane_b32 s29, v7
    s_nop 3
    s_cmp_ge_u32 s29, 4
    s_cbranch_scc1 W_87
    s_sleep 1
    s_sub_u32 s50, s50, 1
    s_cmp_lg_u32 s50, 0
    s_cbranch_scc1 W_86
W_87:
    s_add_u32 s64, s90, 500
    s_addc_u32 s65, s91, 0
    s_add_u32 s66, s90, 0x10000000
    s_addc_u32 s67, s91, 0
    s_mul_i32 s28, s44, 320
    s_add_u32 s28, s28, 5193728
    v_min_u32 v8, 4, v0
    v_lshl_add_u32 v8, v8, 6, s28
    s_mov_b32 s50, 262144
PW_88:
    global_load_dwordx2 v[10:11], v8, s[26:27] sc1
    s_waitcnt vmcnt(0)
    v_cmp_le_u64 vcc, s[64:65], v[10:11]
    v_cmp_ge_u64 s[68:69], s[66:67], v[10:11]
    s_nop 3
    s_and_b64 s[68:69], s[68:69], vcc
    s_and_b32 s68, s68, 31
    s_cmp_eq_u32 s68, 31
    s_cbranch_scc1 PW_89
    s_sleep 1
    s_sub_u32 s50, s50, 1
    s_cmp_lg_u32 s50, 0
    s_cbranch_scc1 PW_88
PW_89:
    ds_write_b32 v15, v3 offset:28
    s_waitcnt lgkmcnt(0)
    s_endpgm
F_WEIGHTS:
    s_cmp_ge_u32 s3, 4
    s_cbranch_scc1 F_END
    v_and_b32 v3, 15, v0
    v_lshrrev_b32 v4, 4, v0
    v_lshrrev_b32 v5, 2, v3
    v_lshlrev_b32 v5, 11, v5
    v_and_b32 v6, 3, v3
    v_lshl_add_u32 v5, v6, 7, v5
    v_lshl_add_u32 v5, v4, 5, v5
    v_add_u32 v7, 48, v3
    v_lshlrev_b32 v7, 2, v7
    v_lshrrev_b32 v1, 2, v3
    v_lshlrev_b32 v1, 4, v1
    v_add_u32 v1, v1, v6
    s_lshl_b32 s28, s3, 2
    v_add_u32 v1, s28, v1
    v_lshlrev_b32 v1, 1, v1
    v_lshl_add_u32 v1, v4, 11, v1
    v_lshlrev_b32 v6, 7, v3
    v_lshl_add_u32 v6, v4, 5, v6
    v_add_u32 v120, 4096, v6
    global_load_ushort v124, v1, s[20:21] offset:0
    global_load_ushort v125, v1, s[20:21] offset:128
    global_load_ushort v126, v1, s[20:21] offset:256
    global_load_ushort v127, v1, s[20:21] offset:384
    global_load_ushort v128, v1, s[20:21] offset:512
    global_load_ushort v129, v1, s[20:21] offset:640
    global_load_ushort v130, v1, s[20:21] offset:768
    global_load_ushort v131, v1, s[20:21] offset:896
    global_load_ushort v132, v1, s[20:21] offset:1024
    global_load_ushort v133, v1, s[20:21] offset:1152
    global_load_ushort v134, v1, s[20:21] offset:1280
    global_load_ushort v135, v1, s[20:21] offset:1408
    global_load_ushort v136, v1, s[20:21] offset:1536
    global_load_ushort v137, v1, s[20:21] offset:1664
    global_load_ushort v138, v1, s[20:21] offset:1792
    global_load_ushort v139, v1, s[20:21] offset:1920
    global_load_dwordx4 v[16:19], v6, s[18:19] offset:0
    global_load_dwordx4 v[48:51], v5, s[12:13] offset:0
    global_load_dwordx4 v[20:23], v6, s[18:19] offset:16
    global_load_dwordx4 v[52:55], v5, s[12:13] offset:16
    global_load_dwordx4 v[24:27], v6, s[18:19] offset:2048
    global_load_dwordx4 v[56:59], v5, s[12:13] offset:512
    global_load_dwordx4 v[28:31], v6, s[18:19] offset:2064
    global_load_dwordx4 v[60:63], v5, s[12:13] offset:528
    global_load_dwordx4 v[32:35], v120, s[18:19] offset:0
    global_load_dwordx4 v[64:67], v5, s[12:13] offset:1024
    global_load_dwordx4 v[36:39], v120, s[18:19] offset:16
    global_load_dwordx4 v[68:71], v5, s[12:13] offset:1040
    global_load_dwordx4 v[40:43], v120, s[18:19] offset:2048
    global_load_dwordx4 v[72:75], v5, s[12:13] offset:1536
    global_load_dwordx4 v[44:47], v120, s[18:19] offset:2064
    global_load_dwordx4 v[76:79], v5, s[12:13] offset:1552
    s_lshl_b32 s28, s3, 11
    s_add_u32 s28, s28, 4194304
    s_add_u32 s40, s26, s28
    s_addc_u32 s41, s27, 0
    v_lshlrev_b32 v1, 4, v0
    v_add_u32 v6, 8192, v1
    s_waitcnt vmcnt(0)
    v_lshl_or_b32 v8, v125, 16, v124
    v_lshl_or_b32 v9, v127, 16, v126
    v_lshl_or_b32 v10, v129, 16, v128
    v_lshl_or_b32 v11, v131, 16, v130
    v_lshl_or_b32 v12, v133, 16, v132
    v_lshl_or_b32 v13, v135, 16, v134
    v_lshl_or_b32 v14, v137, 16, v136
    v_lshl_or_b32 v15, v139, 16, v138
    s_nop 1
    v_mfma_f32_16x16x32_bf16 v[80:83], v[16:19], v[8:11], 0
    v_mfma_f32_16x16x32_bf16 v[84:87], v[24:27], v[8:11], 0
    v_mfma_f32_16x16x32_bf16 v[88:91], v[32:35], v[8:11], 0
    v_mfma_f32_16x16x32_bf16 v[92:95], v[40:43], v[8:11], 0
    v_mfma_f32_16x16x32_bf16 v[80:83], v[20:23], v[12:15], v[80:83]
    v_mfma_f32_16x16x32_bf16 v[84:87], v[28:31], v[12:15], v[84:87]
    v_mfma_f32_16x16x32_bf16 v[88:91], v[36:39], v[12:15], v[88:91]
    v_mfma_f32_16x16x32_bf16 v[92:95], v[44:47], v[12:15], v[92:95]
    v_mfma_f32_16x16x32_bf16 v[96:99], v[48:51], v[8:11], 0
    v_mfma_f32_16x16x32_bf16 v[100:103], v[56:59], v[8:11], 0
    v_mfma_f32_16x16x32_bf16 v[104:107], v[64:67], v[8:11], 0
    v_mfma_f32_16x16x32_bf16 v[108:111], v[72:75], v[8:11], 0
    v_mfma_f32_16x16x32_bf16 v[96:99], v[52:55], v[12:15], v[96:99]
    v_mfma_f32_16x16x32_bf16 v[100:103], v[60:63], v[12:15], v[100:103]
    v_mfma_f32_16x16x32_bf16 v[104:107], v[68:71], v[12:15], v[104:107]
    v_mfma_f32_16x16x32_bf16 v[108:111], v[76:79], v[12:15], v[108:111]
    s_nop 7
    s_nop 1
    ds_bpermute_b32 v112, v7, v95
    ds_bpermute_b32 v113, v7, v111
    s_waitcnt lgkmcnt(0)
    v_sub_f32 v80, v80, v112
    v_sub_f32 v81, v81, v112
    v_sub_f32 v82, v82, v112
    v_sub_f32 v83, v83, v112
    v_sub_f32 v84, v84, v112
    v_sub_f32 v85, v85, v112
    v_sub_f32 v86, v86, v112
    v_sub_f32 v87, v87, v112
    v_sub_f32 v88, v88, v112
    v_sub_f32 v89, v89, v112
    v_sub_f32 v90, v90, v112
    v_sub_f32 v91, v91, v112
    v_sub_f32 v92, v92, v112
    v_sub_f32 v93, v93, v112
    v_sub_f32 v94, v94, v112
    v_sub_f32 v95, v95, v112
    v_cvt_pk_bf16_f32 v16, v80, v81
    v_cvt_pk_bf16_f32 v17, v82, v83
    v_cvt_pk_bf16_f32 v18, v84, v85
    v_cvt_pk_bf16_f32 v19, v86, v87
    v_cvt_pk_bf16_f32 v20, v88, v89
    v_cvt_pk_bf16_f32 v21, v90, v91
    v_cvt_pk_bf16_f32 v22, v92, v93
    v_cvt_pk_bf16_f32 v23, v94, v95
    global_store_dwordx4 v1, v[16:19], s[40:41] offset:0 sc1
    global_store_dwordx4 v1, v[20:23], s[40:41] offset:1024 sc1
    v_sub_f32 v96, v96, v113
    v_sub_f32 v97, v97, v113
    v_sub_f32 v98, v98, v113
    v_sub_f32 v99, v99, v113
    v_sub_f32 v100, v100, v113
    v_sub_f32 v101, v101, v113
    v_sub_f32 v102, v102, v113
    v_sub_f32 v103, v103, v113
    v_sub_f32 v104, v104, v113
    v_sub_f32 v105, v105, v113
    v_sub_f32 v106, v106, v113
    v_sub_f32 v107, v107, v113
    v_sub_f32 v108, v108, v113
    v_sub_f32 v109, v109, v113
    v_sub_f32 v110, v110, v113
    v_sub_f32 v111, v111, v113
    v_cvt_pk_bf16_f32 v24, v96, v97
    v_cvt_pk_bf16_f32 v25, v98, v99
    v_cvt_pk_bf16_f32 v26, v100, v101
    v_cvt_pk_bf16_f32 v27, v102, v103
    v_cvt_pk_bf16_f32 v28, v104, v105
    v_cvt_pk_bf16_f32 v29, v106, v107
    v_cvt_pk_bf16_f32 v30, v108, v109
    v_cvt_pk_bf16_f32 v31, v110, v111
    global_store_dwordx4 v6, v[24:27], s[40:41] offset:0 sc1
    global_store_dwordx4 v6, v[28:31], s[40:41] offset:1024 sc1
    s_waitcnt vmcnt(0)
    s_lshl_b32 s30, s3, 6
    s_add_u32 s30, s30, 5226240
    s_memrealtime s[82:83]
    v_lshl_add_u32 v4, v0, 3, s30
    s_waitcnt lgkmcnt(0)
    v_mov_b32 v2, s82
    v_mov_b32 v3, s83
    s_mov_b64 exec, 0xff
    global_store_dwordx2 v4, v[2:3], s[26:27] sc1
    s_mov_b64 exec, -1
    s_not_b64 s[28:29], s[90:91]
    v_mov_b32 v8, s28
    v_mov_b32 v9, s29
    v_mov_b32 v10, 0
    s_mov_b64 exec, 1
    global_atomic_umax_x2 v10, v[8:9], s[24:25] sc1
    s_mov_b64 exec, -1
    s_endpgm
F_ATT:
    v_mov_b32 v3, v247
    s_barrier
    s_setprio 3
    s_mov_b32 s47, 0x3e38aa3b
    s_mov_b32 s49, 0xc1026666
    s_mov_b32 s56, 0x42700000
    v_cmp_eq_u32 s[54:55], 3, v2
    s_mov_b32 s46, 0xffff0000
    s_mov_b32 s48, 0x3727c5ac
    s_mov_b32 s51, 0x3c800000
    s_add_u32 s60, s26, 2097152
    s_addc_u32 s61, s27, 0
    s_mov_b32 s62, 1605632
    s_mov_b32 s63, 0x00020000
    s_mov_b32 s39, 0x00020000
    v_and_b32 v6, 1, v1
    v_bfe_u32 v7, v1, 3, 1
    v_lshl_or_b32 v6, v7, 1, v6
    v_bfe_u32 v7, v1, 1, 2
    v_lshl_or_b32 v6, v7, 2, v6
    v_bfe_u32 v7, v6, 1, 3
    v_lshlrev_b32 v12, 1, v2
    v_xor_b32 v7, v7, v12
    v_lshlrev_b32 v7, 4, v7
    v_lshl_add_u32 v4, v6, 7, v7
    v_xor_b32 v5, 16, v4
    v_lshrrev_b32 v12, 2, v1
    v_lshl_or_b32 v12, v2, 2, v12
    v_and_b32 v6, 1, v12
    v_bfe_u32 v7, v12, 3, 1
    v_lshl_or_b32 v6, v7, 1, v6
    v_bfe_u32 v7, v12, 1, 2
    v_lshl_or_b32 v6, v7, 2, v6
    v_bfe_u32 v7, v6, 1, 3
    v_bfe_u32 v13, v1, 1, 1
    v_xor_b32 v7, v7, v13
    v_lshlrev_b32 v7, 4, v7
    v_lshl_add_u32 v7, v6, 7, v7
    v_and_b32 v13, 1, v1
    v_lshl_add_u32 v8, v13, 3, v7
    v_xor_b32 v9, 32, v8
    v_xor_b32 v10, 64, v8
    v_xor_b32 v11, 0x60, v8
    v_mov_b32 v144, 0x3f803f80
    v_mov_b32 v145, 0x3f803f80
    v_mov_b32 v146, 0x3f803f80
    v_mov_b32 v147, 0x3f803f80
    v_mov_b32 v48, 0
    v_mov_b32 v49, 0
    v_mov_b32 v50, 0
    v_mov_b32 v51, 0
    v_mov_b32 v52, 0
    v_mov_b32 v53, 0
    v_mov_b32 v54, 0
    v_mov_b32 v55, 0
    v_mov_b32 v56, 0
    v_mov_b32 v57, 0
    v_mov_b32 v58, 0
    v_mov_b32 v59, 0
    v_mov_b32 v60, 0
    v_mov_b32 v61, 0
    v_mov_b32 v62, 0
    v_mov_b32 v63, 0
    v_mov_b32 v64, 0
    v_mov_b32 v65, 0
    v_mov_b32 v66, 0
    v_mov_b32 v67, 0
    v_mov_b32 v68, 0
    v_mov_b32 v69, 0
    v_mov_b32 v70, 0
    v_mov_b32 v71, 0
    v_mov_b32 v72, 0
    v_mov_b32 v73, 0
    v_mov_b32 v74, 0
    v_mov_b32 v75, 0
    v_mov_b32 v76, 0
    v_mov_b32 v77, 0
    v_mov_b32 v78, 0
    v_mov_b32 v79, 0
    v_mov_b32 v80, 0
    v_mov_b32 v81, 0
    v_mov_b32 v82, 0
    v_mov_b32 v83, 0
    v_mov_b32 v84, 0
    v_mov_b32 v85, 0
    v_mov_b32 v86, 0
    v_mov_b32 v87, 0
    v_mov_b32 v88, 0
    v_mov_b32 v89, 0
    v_mov_b32 v90, 0
    v_mov_b32 v91, 0
    v_mov_b32 v92, 0
    v_mov_b32 v93, 0
    v_mov_b32 v94, 0
    v_mov_b32 v95, 0
    v_mov_b32 v96, 0
    v_mov_b32 v97, 0
    v_mov_b32 v98, 0
    v_mov_b32 v99, 0
    v_mov_b32 v100, 0
    v_mov_b32 v101, 0
    v_mov_b32 v102, 0
    v_mov_b32 v103, 0
    v_mov_b32 v104, 0
    v_mov_b32 v105, 0
    v_mov_b32 v106, 0
    v_mov_b32 v107, 0
    v_mov_b32 v108, 0
    v_mov_b32 v109, 0
    v_mov_b32 v110, 0
    v_mov_b32 v111, 0
    v_mov_b32 v192, 0
    v_mov_b32 v193, 0
    v_mov_b32 v194, 0
    v_mov_b32 v195, 0
    v_mov_b32 v196, 0
    v_mov_b32 v197, 0
    v_mov_b32 v198, 0
    v_mov_b32 v199, 0
    v_mov_b32 v200, 0
    v_mov_b32 v201, 0
    v_mov_b32 v202, 0
    v_mov_b32 v203, 0
    v_mov_b32 v204, 0
    v_mov_b32 v205, 0
    v_mov_b32 v206, 0
    v_mov_b32 v207, 0
    v_mov_b32 v208, 0
    v_mov_b32 v209, 0
    v_mov_b32 v210, 0
    v_mov_b32 v211, 0
    v_mov_b32 v212, 0
    v_mov_b32 v213, 0
    v_mov_b32 v214, 0
    v_mov_b32 v215, 0
    v_mov_b32 v216, 0
    v_mov_b32 v217, 0
    v_mov_b32 v218, 0
    v_mov_b32 v219, 0
    v_mov_b32 v220, 0
    v_mov_b32 v221, 0
    v_mov_b32 v222, 0
    v_mov_b32 v223, 0
    v_mov_b32 v12, 0
    s_lshl_b32 s28, s3, 8
    s_add_u32 s28, s28, 129024
    v_lshlrev_b32 v13, 2, v0
    v_add_u32 v13, s28, v13
    v_mov_b32 v14, 1
    s_mov_b32 s41, 0
    s_mov_b32 s81, 0
    s_mov_b32 s42, 0
    s_lshl_b32 s57, s2, 6
    s_add_u32 s57, s57, 5193728
    s_lshr_b32 s28, s3, 1
    s_lshl_b32 s28, s28, 10
    s_and_b32 s29, s3, 1
    s_lshl_b32 s29, s29, 3
    s_add_u32 s28, s28, s29
    s_add_u32 s28, s28, 103936
    v_lshlrev_b32 v7, 4, v0
    v_add_u32 v6, s28, v7
    v_add_u32 v7, 103936, v7
    v_lshrrev_b32 v148, 2, v1
    v_lshlrev_b32 v148, 11, v148
    v_and_b32 v149, 3, v1
    v_lshl_add_u32 v148, v149, 7, v148
    v_and_b32 v149, 2, v1
    v_bfe_u32 v150, v1, 2, 1
    v_or_b32 v149, v149, v150
    v_bfe_u32 v150, v1, 3, 1
    v_lshl_or_b32 v149, v150, 2, v149
    v_lshlrev_b32 v150, 1, v2
    v_xor_b32 v149, v149, v150
    v_lshl_add_u32 v148, v149, 4, v148
    v_xor_b32 v149, 16, v148
    s_lshl_b32 s28, s3, 9
    v_add_u32 v150, s28, v148
    v_add_u32 v151, s28, v149
    s_waitcnt vmcnt(6)
    v_mfma_f32_16x16x32_bf16 v[156:159], v[144:147], v[160:163], 0
    v_mfma_f32_16x16x32_bf16 v[156:159], v[144:147], v[164:167], v[156:159]
    v_lshlrev_b32 v240, 16, v160
    v_and_b32 v241, s46, v160
    v_lshlrev_b32 v242, 16, v161
    v_and_b32 v243, s46, v161
    v_lshlrev_b32 v244, 16, v162
    v_and_b32 v245, s46, v162
    v_lshlrev_b32 v246, 16, v163
    v_and_b32 v247, s46, v163
    v_lshlrev_b32 v116, 16, v164
    v_and_b32 v117, s46, v164
    v_lshlrev_b32 v118, 16, v165
    v_and_b32 v119, s46, v165
    v_lshlrev_b32 v236, 16, v166
    v_and_b32 v237, s46, v166
    v_lshlrev_b32 v238, 16, v167
    v_and_b32 v239, s46, v167
    v_mul_f32 v154, s51, v156
    v_pk_add_f32 v[240:241], v[240:241], v[154:155] op_sel_hi:[1,0] neg_lo:[0,1] neg_hi:[0,1]
    v_pk_add_f32 v[242:243], v[242:243], v[154:155] op_sel_hi:[1,0] neg_lo:[0,1] neg_hi:[0,1]
    v_pk_add_f32 v[244:245], v[244:245], v[154:155] op_sel_hi:[1,0] neg_lo:[0,1] neg_hi:[0,1]
    v_pk_add_f32 v[246:247], v[246:247], v[154:155] op_sel_hi:[1,0] neg_lo:[0,1] neg_hi:[0,1]
    v_pk_add_f32 v[116:117], v[116:117], v[154:155] op_sel_hi:[1,0] neg_lo:[0,1] neg_hi:[0,1]
    v_pk_add_f32 v[118:119], v[118:119], v[154:155] op_sel_hi:[1,0] neg_lo:[0,1] neg_hi:[0,1]
    v_pk_add_f32 v[236:237], v[236:237], v[154:155] op_sel_hi:[1,0] neg_lo:[0,1] neg_hi:[0,1]
    v_pk_add_f32 v[238:239], v[238:239], v[154:155] op_sel_hi:[1,0] neg_lo:[0,1] neg_hi:[0,1]
    v_pk_mul_f32 v[152:153], v[240:241], v[240:241]
    v_pk_mul_f32 v[154:155], v[242:243], v[242:243]
    v_pk_fma_f32 v[152:153], v[244:245], v[244:245], v[152:153]
    v_pk_fma_f32 v[154:155], v[246:247], v[246:247], v[154:155]
    v_pk_fma_f32 v[152:153], v[116:117], v[116:117], v[152:153]
    v_pk_fma_f32 v[154:155], v[118:119], v[118:119], v[154:155]
    v_pk_fma_f32 v[152:153], v[236:237], v[236:237], v[152:153]
    v_pk_fma_f32 v[154:155], v[238:239], v[238:239], v[154:155]
    v_pk_add_f32 v[152:153], v[152:153], v[154:155]
    v_add_f32 v152, v152, v153
    v_mov_b32 v154, v152
    v_mov_b32 v155, v152
    s_nop 1
    v_permlane16_swap_b32 v154, v155
    s_nop 1
    v_add_f32 v152, v154, v155
    v_mov_b32 v154, v152
    v_mov_b32 v155, v152
    s_nop 1
    v_permlane32_swap_b32 v154, v155
    s_nop 1
    v_add_f32 v152, v154, v155
    v_mov_b32 v153, s48
    v_fmac_f32 v153, s51, v152
    v_rsq_f32 v154, v153
    s_nop 0
    v_pk_mul_f32 v[240:241], v[240:241], v[154:155] op_sel_hi:[1,0]
    v_pk_mul_f32 v[242:243], v[242:243], v[154:155] op_sel_hi:[1,0]
    v_pk_mul_f32 v[244:245], v[244:245], v[154:155] op_sel_hi:[1,0]
    v_pk_mul_f32 v[246:247], v[246:247], v[154:155] op_sel_hi:[1,0]
    v_pk_mul_f32 v[116:117], v[116:117], v[154:155] op_sel_hi:[1,0]
    v_pk_mul_f32 v[118:119], v[118:119], v[154:155] op_sel_hi:[1,0]
    v_pk_mul_f32 v[236:237], v[236:237], v[154:155] op_sel_hi:[1,0]
    v_pk_mul_f32 v[238:239], v[238:239], v[154:155] op_sel_hi:[1,0]
    v_cvt_pk_bf16_f32 v112, v240, v241
    v_cvt_pk_bf16_f32 v113, v242, v243
    v_cvt_pk_bf16_f32 v114, v244, v245
    v_cvt_pk_bf16_f32 v115, v246, v247
    v_cvt_pk_bf16_f32 v116, v116, v117
    v_cvt_pk_bf16_f32 v117, v118, v119
    v_cvt_pk_bf16_f32 v118, v236, v237
    v_cvt_pk_bf16_f32 v119, v238, v239
    s_waitcnt vmcnt(4)
    v_mfma_f32_16x16x32_bf16 v[156:159], v[144:147], v[168:171], 0
    v_mfma_f32_16x16x32_bf16 v[156:159], v[144:147], v[172:175], v[156:159]
    v_lshlrev_b32 v240, 16, v168
    v_and_b32 v241, s46, v168
    v_lshlrev_b32 v242, 16, v169
    v_and_b32 v243, s46, v169
    v_lshlrev_b32 v244, 16, v170
    v_and_b32 v245, s46, v170
    v_lshlrev_b32 v246, 16, v171
    v_and_b32 v247, s46, v171
    v_lshlrev_b32 v124, 16, v172
    v_and_b32 v125, s46, v172
    v_lshlrev_b32 v126, 16, v173
    v_and_b32 v127, s46, v173
    v_lshlrev_b32 v236, 16, v174
    v_and_b32 v237, s46, v174
    v_lshlrev_b32 v238, 16, v175
    v_and_b32 v239, s46, v175
    v_mul_f32 v154, s51, v156
    v_pk_add_f32 v[240:241], v[240:241], v[154:155] op_sel_hi:[1,0] neg_lo:[0,1] neg_hi:[0,1]
    v_pk_add_f32 v[242:243], v[242:243], v[154:155] op_sel_hi:[1,0] neg_lo:[0,1] neg_hi:[0,1]
    v_pk_add_f32 v[244:245], v[244:245], v[154:155] op_sel_hi:[1,0] neg_lo:[0,1] neg_hi:[0,1]
    v_pk_add_f32 v[246:247], v[246:247], v[154:155] op_sel_hi:[1,0] neg_lo:[0,1] neg_hi:[0,1]
    v_pk_add_f32 v[124:125], v[124:125], v[154:155] op_sel_hi:[1,0] neg_lo:[0,1] neg_hi:[0,1]
    v_pk_add_f32 v[126:127], v[126:127], v[154:155] op_sel_hi:[1,0] neg_lo:[0,1] neg_hi:[0,1]
    v_pk_add_f32 v[236:237], v[236:237], v[154:155] op_sel_hi:[1,0] neg_lo:[0,1] neg_hi:[0,1]
    v_pk_add_f32 v[238:239], v[238:239], v[154:155] op_sel_hi:[1,0] neg_lo:[0,1] neg_hi:[0,1]
    v_pk_mul_f32 v[152:153], v[240:241], v[240:241]
    v_pk_mul_f32 v[154:155], v[242:243], v[242:243]
    v_pk_fma_f32 v[152:153], v[244:245], v[244:245], v[152:153]
    v_pk_fma_f32 v[154:155], v[246:247], v[246:247], v[154:155]
    v_pk_fma_f32 v[152:153], v[124:125], v[124:125], v[152:153]
    v_pk_fma_f32 v[154:155], v[126:127], v[126:127], v[154:155]
    v_pk_fma_f32 v[152:153], v[236:237], v[236:237], v[152:153]
    v_pk_fma_f32 v[154:155], v[238:239], v[238:239], v[154:155]
    v_pk_add_f32 v[152:153], v[152:153], v[154:155]
    v_add_f32 v152, v152, v153
    v_mov_b32 v154, v152
    v_mov_b32 v155, v152
    s_nop 1
    v_permlane16_swap_b32 v154, v155
    s_nop 1
    v_add_f32 v152, v154, v155
    v_mov_b32 v154, v152
    v_mov_b32 v155, v152
    s_nop 1
    v_permlane32_swap_b32 v154, v155
    s_nop 1
    v_add_f32 v152, v154, v155
    v_mov_b32 v153, s48
    v_fmac_f32 v153, s51, v152
    v_rsq_f32 v154, v153
    s_nop 0
    v_pk_mul_f32 v[240:241], v[240:241], v[154:155] op_sel_hi:[1,0]
    v_pk_mul_f32 v[242:243], v[242:243], v[154:155] op_sel_hi:[1,0]
    v_pk_mul_f32 v[244:245], v[244:245], v[154:155] op_sel_hi:[1,0]
    v_pk_mul_f32 v[246:247], v[246:247], v[154:155] op_sel_hi:[1,0]
    v_pk_mul_f32 v[124:125], v[124:125], v[154:155] op_sel_hi:[1,0]
    v_pk_mul_f32 v[126:127], v[126:127], v[154:155] op_sel_hi:[1,0]
    v_pk_mul_f32 v[236:237], v[236:237], v[154:155] op_sel_hi:[1,0]
    v_pk_mul_f32 v[238:239], v[238:239], v[154:155] op_sel_hi:[1,0]
    v_cvt_pk_bf16_f32 v120, v240, v241
    v_cvt_pk_bf16_f32 v121, v242, v243
    v_cvt_pk_bf16_f32 v122, v244, v245
    v_cvt_pk_bf16_f32 v123, v246, v247
    v_cvt_pk_bf16_f32 v124, v124, v125
    v_cvt_pk_bf16_f32 v125, v126, v127
    v_cvt_pk_bf16_f32 v126, v236, v237
    v_cvt_pk_bf16_f32 v127, v238, v239
    s_mov_b32 s50, 262144
W_91:
    ds_read_b32 v152, v15 offset:36
    s_waitcnt lgkmcnt(0)
    v_readfirstlane_b32 s29, v152
    s_nop 3
    s_cmp_ge_u32 s29, 4
    s_cbranch_scc1 W_92
    s_sleep 0
    s_sub_u32 s50, s50, 1
    s_cmp_lg_u32 s50, 0
    s_cbranch_scc1 W_91
W_92:
    ds_read_b128 v[224:227], v150 offset:32768
    ds_read_b128 v[228:231], v151 offset:32768
    ds_read_b128 v[40:43], v148 offset:42496
    ds_read_b128 v[44:47], v149 offset:42496
    ds_read_b128 v[16:19], v148 offset:40960
    ds_read_b128 v[20:23], v149 offset:40960
    ds_read_b128 v[24:27], v148 offset:41472
    ds_read_b128 v[28:31], v149 offset:41472
    ds_read_b128 v[32:35], v148 offset:41984
    ds_read_b128 v[36:39], v149 offset:41984
    s_waitcnt vmcnt(2)
    v_mfma_f32_16x16x32_bf16 v[156:159], v[144:147], v[176:179], 0
    v_mfma_f32_16x16x32_bf16 v[156:159], v[144:147], v[180:183], v[156:159]
    v_lshlrev_b32 v240, 16, v176
    v_and_b32 v241, s46, v176
    v_lshlrev_b32 v242, 16, v177
    v_and_b32 v243, s46, v177
    v_lshlrev_b32 v244, 16, v178
    v_and_b32 v245, s46, v178
    v_lshlrev_b32 v246, 16, v179
    v_and_b32 v247, s46, v179
    v_lshlrev_b32 v132, 16, v180
    v_and_b32 v133, s46, v180
    v_lshlrev_b32 v134, 16, v181
    v_and_b32 v135, s46, v181
    v_lshlrev_b32 v236, 16, v182
    v_and_b32 v237, s46, v182
    v_lshlrev_b32 v238, 16, v183
    v_and_b32 v239, s46, v183
    v_mul_f32 v154, s51, v156
    v_pk_add_f32 v[240:241], v[240:241], v[154:155] op_sel_hi:[1,0] neg_lo:[0,1] neg_hi:[0,1]
    v_pk_add_f32 v[242:243], v[242:243], v[154:155] op_sel_hi:[1,0] neg_lo:[0,1] neg_hi:[0,1]
    v_pk_add_f32 v[244:245], v[244:245], v[154:155] op_sel_hi:[1,0] neg_lo:[0,1] neg_hi:[0,1]
    v_pk_add_f32 v[246:247], v[246:247], v[154:155] op_sel_hi:[1,0] neg_lo:[0,1] neg_hi:[0,1]
    v_pk_add_f32 v[132:133], v[132:133], v[154:155] op_sel_hi:[1,0] neg_lo:[0,1] neg_hi:[0,1]
    v_pk_add_f32 v[134:135], v[134:135], v[154:155] op_sel_hi:[1,0] neg_lo:[0,1] neg_hi:[0,1]
    v_pk_add_f32 v[236:237], v[236:237], v[154:155] op_sel_hi:[1,0] neg_lo:[0,1] neg_hi:[0,1]
    v_pk_add_f32 v[238:239], v[238:239], v[154:155] op_sel_hi:[1,0] neg_lo:[0,1] neg_hi:[0,1]
    v_pk_mul_f32 v[152:153], v[240:241], v[240:241]
    v_pk_mul_f32 v[154:155], v[242:243], v[242:243]
    v_pk_fma_f32 v[152:153], v[244:245], v[244:245], v[152:153]
    v_pk_fma_f32 v[154:155], v[246:247], v[246:247], v[154:155]
    v_pk_fma_f32 v[152:153], v[132:133], v[132:133], v[152:153]
    v_pk_fma_f32 v[154:155], v[134:135], v[134:135], v[154:155]
    v_pk_fma_f32 v[152:153], v[236:237], v[236:237], v[152:153]
    v_pk_fma_f32 v[154:155], v[238:239], v[238:239], v[154:155]
    v_pk_add_f32 v[152:153], v[152:153], v[154:155]
    v_add_f32 v152, v152, v153
    v_mov_b32 v154, v152
    v_mov_b32 v155, v152
    s_nop 1
    v_permlane16_swap_b32 v154, v155
    s_nop 1
    v_add_f32 v152, v154, v155
    v_mov_b32 v154, v152
    v_mov_b32 v155, v152
    s_nop 1
    v_permlane32_swap_b32 v154, v155
    s_nop 1
    v_add_f32 v152, v154, v155
    v_mov_b32 v153, s48
    v_fmac_f32 v153, s51, v152
    v_rsq_f32 v154, v153
    s_nop 0
    v_pk_mul_f32 v[240:241], v[240:241], v[154:155] op_sel_hi:[1,0]
    v_pk_mul_f32 v[242:243], v[242:243], v[154:155] op_sel_hi:[1,0]
    v_pk_mul_f32 v[244:245], v[244:245], v[154:155] op_sel_hi:[1,0]
    v_pk_mul_f32 v[246:247], v[246:247], v[154:155] op_sel_hi:[1,0]
    v_pk_mul_f32 v[132:133], v[132:133], v[154:155] op_sel_hi:[1,0]
    v_pk_mul_f32 v[134:135], v[134:135], v[154:155] op_sel_hi:[1,0]
    v_pk_mul_f32 v[236:237], v[236:237], v[154:155] op_sel_hi:[1,0]
    v_pk_mul_f32 v[238:239], v[238:239], v[154:155] op_sel_hi:[1,0]
    v_cvt_pk_bf16_f32 v128, v240, v241
    v_cvt_pk_bf16_f32 v129, v242, v243
    v_cvt_pk_bf16_f32 v130, v244, v245
    v_cvt_pk_bf16_f32 v131, v246, v247
    v_cvt_pk_bf16_f32 v132, v132, v133
    v_cvt_pk_bf16_f32 v133, v134, v135
    v_cvt_pk_bf16_f32 v134, v236, v237
    v_cvt_pk_bf16_f32 v135, v238, v239
    s_waitcnt lgkmcnt(0)
    v_mfma_f32_16x16x32_bf16 v[244:247], v[224:227], v[40:43], 0
    v_mfma_f32_16x16x32_bf16 v[244:247], v[228:231], v[44:47], v[244:247]
    v_mfma_f32_16x16x32_bf16 v[232:235], v[224:227], v[16:19], 0
    v_mfma_f32_16x16x32_bf16 v[232:235], v[228:231], v[20:23], v[232:235]
    v_mfma_f32_16x16x32_bf16 v[236:239], v[224:227], v[24:27], 0
    v_mfma_f32_16x16x32_bf16 v[236:239], v[228:231], v[28:31], v[236:239]
    v_mfma_f32_16x16x32_bf16 v[240:243], v[224:227], v[32:35], 0
    v_mfma_f32_16x16x32_bf16 v[240:243], v[228:231], v[36:39], v[240:243]
    s_nop 1
    v_mul_f32 v152, s47, v244
    v_mul_f32 v153, s47, v245
    v_mul_f32 v154, s47, v246
    v_mul_f32 v155, s47, v247
    v_mov_b32_dpp v156, v152 row_newbcast:15 row_mask:0xf bank_mask:0xf
    v_mov_b32_dpp v157, v153 row_newbcast:15 row_mask:0xf bank_mask:0xf
    v_mov_b32_dpp v158, v154 row_newbcast:15 row_mask:0xf bank_mask:0xf
    v_mov_b32_dpp v159, v155 row_newbcast:15 row_mask:0xf bank_mask:0xf
    v_fma_f32 v244, v244, s47, -v156
    v_fma_f32 v245, v245, s47, -v157
    v_fma_f32 v246, v246, s47, -v158
    v_fma_f32 v247, v247, s47, -v159
    v_fma_f32 v232, v232, s47, -v156
    v_fma_f32 v233, v233, s47, -v157
    v_fma_f32 v234, v234, s47, -v158
    v_fma_f32 v235, v235, s47, -v159
    v_fma_f32 v236, v236, s47, -v156
    v_fma_f32 v237, v237, s47, -v157
    v_fma_f32 v238, v238, s47, -v158
    v_fma_f32 v239, v239, s47, -v159
    v_fma_f32 v240, v240, s47, -v156
    v_fma_f32 v241, v241, s47, -v157
    v_fma_f32 v242, v242, s47, -v158
    v_fma_f32 v243, v243, s47, -v159
    v_cvt_pk_bf16_f32 v224, v232, v233
    v_cvt_pk_bf16_f32 v225, v234, v235
    v_cvt_pk_bf16_f32 v226, v236, v237
    v_cvt_pk_bf16_f32 v227, v238, v239
    v_cvt_pk_bf16_f32 v228, v240, v241
    v_cvt_pk_bf16_f32 v229, v242, v243
    v_cvt_pk_bf16_f32 v230, v244, v245
    v_cvt_pk_bf16_f32 v231, v246, v247
    ds_write_b64 v6, v[224:225] offset:0
    ds_write_b64 v6, v[226:227] offset:2048
    ds_write_b64 v6, v[228:229] offset:4096
    ds_write_b64 v6, v[230:231] offset:6144
    s_waitcnt lgkmcnt(0)
    s_mov_b64 exec, 1
    ds_add_u32 v15, v14 offset:8
    s_mov_b64 exec, -1
    s_waitcnt vmcnt(0)
    v_mfma_f32_16x16x32_bf16 v[156:159], v[144:147], v[184:187], 0
    v_mfma_f32_16x16x32_bf16 v[156:159], v[144:147], v[188:191], v[156:159]
    v_lshlrev_b32 v240, 16, v184
    v_and_b32 v241, s46, v184
    v_lshlrev_b32 v242, 16, v185
    v_and_b32 v243, s46, v185
    v_lshlrev_b32 v244, 16, v186
    v_and_b32 v245, s46, v186
    v_lshlrev_b32 v246, 16, v187
    v_and_b32 v247, s46, v187
    v_lshlrev_b32 v140, 16, v188
    v_and_b32 v141, s46, v188
    v_lshlrev_b32 v142, 16, v189
    v_and_b32 v143, s46, v189
    v_lshlrev_b32 v236, 16, v190
    v_and_b32 v237, s46, v190
    v_lshlrev_b32 v238, 16, v191
    v_and_b32 v239, s46, v191
    v_mul_f32 v154, s51, v156
    v_pk_add_f32 v[240:241], v[240:241], v[154:155] op_sel_hi:[1,0] neg_lo:[0,1] neg_hi:[0,1]
    v_pk_add_f32 v[242:243], v[242:243], v[154:155] op_sel_hi:[1,0] neg_lo:[0,1] neg_hi:[0,1]
    v_pk_add_f32 v[244:245], v[244:245], v[154:155] op_sel_hi:[1,0] neg_lo:[0,1] neg_hi:[0,1]
    v_pk_add_f32 v[246:247], v[246:247], v[154:155] op_sel_hi:[1,0] neg_lo:[0,1] neg_hi:[0,1]
    v_pk_add_f32 v[140:141], v[140:141], v[154:155] op_sel_hi:[1,0] neg_lo:[0,1] neg_hi:[0,1]
    v_pk_add_f32 v[142:143], v[142:143], v[154:155] op_sel_hi:[1,0] neg_lo:[0,1] neg_hi:[0,1]
    v_pk_add_f32 v[236:237], v[236:237], v[154:155] op_sel_hi:[1,0] neg_lo:[0,1] neg_hi:[0,1]
    v_pk_add_f32 v[238:239], v[238:239], v[154:155] op_sel_hi:[1,0] neg_lo:[0,1] neg_hi:[0,1]
    v_pk_mul_f32 v[152:153], v[240:241], v[240:241]
    v_pk_mul_f32 v[154:155], v[242:243], v[242:243]
    v_pk_fma_f32 v[152:153], v[244:245], v[244:245], v[152:153]
    v_pk_fma_f32 v[154:155], v[246:247], v[246:247], v[154:155]
    v_pk_fma_f32 v[152:153], v[140:141], v[140:141], v[152:153]
    v_pk_fma_f32 v[154:155], v[142:143], v[142:143], v[154:155]
    v_pk_fma_f32 v[152:153], v[236:237], v[236:237], v[152:153]
    v_pk_fma_f32 v[154:155], v[238:239], v[238:239], v[154:155]
    v_pk_add_f32 v[152:153], v[152:153], v[154:155]
    v_add_f32 v152, v152, v153
    v_mov_b32 v154, v152
    v_mov_b32 v155, v152
    s_nop 1
    v_permlane16_swap_b32 v154, v155
    s_nop 1
    v_add_f32 v152, v154, v155
    v_mov_b32 v154, v152
    v_mov_b32 v155, v152
    s_nop 1
    v_permlane32_swap_b32 v154, v155
    s_nop 1
    v_add_f32 v152, v154, v155
    v_mov_b32 v153, s48
    v_fmac_f32 v153, s51, v152
    v_rsq_f32 v154, v153
    s_nop 0
    v_pk_mul_f32 v[240:241], v[240:241], v[154:155] op_sel_hi:[1,0]
    v_pk_mul_f32 v[242:243], v[242:243], v[154:155] op_sel_hi:[1,0]
    v_pk_mul_f32 v[244:245], v[244:245], v[154:155] op_sel_hi:[1,0]
    v_pk_mul_f32 v[246:247], v[246:247], v[154:155] op_sel_hi:[1,0]
    v_pk_mul_f32 v[140:141], v[140:141], v[154:155] op_sel_hi:[1,0]
    v_pk_mul_f32 v[142:143], v[142:143], v[154:155] op_sel_hi:[1,0]
    v_pk_mul_f32 v[236:237], v[236:237], v[154:155] op_sel_hi:[1,0]
    v_pk_mul_f32 v[238:239], v[238:239], v[154:155] op_sel_hi:[1,0]
    v_cvt_pk_bf16_f32 v136, v240, v241
    v_cvt_pk_bf16_f32 v137, v242, v243
    v_cvt_pk_bf16_f32 v138, v244, v245
    v_cvt_pk_bf16_f32 v139, v246, v247
    v_cvt_pk_bf16_f32 v140, v140, v141
    v_cvt_pk_bf16_f32 v141, v142, v143
    v_cvt_pk_bf16_f32 v142, v236, v237
    v_cvt_pk_bf16_f32 v143, v238, v239
    s_mov_b32 s50, 262144
W_93:
    ds_read_b32 v152, v15 offset:8
    s_waitcnt lgkmcnt(0)
    v_readfirstlane_b32 s29, v152
    s_nop 3
    s_cmp_ge_u32 s29, 4
    s_cbranch_scc1 W_94
    s_sleep 0
    s_sub_u32 s50, s50, 1
    s_cmp_lg_u32 s50, 0
    s_cbranch_scc1 W_93
W_94:
    ds_read_b128 v[160:163], v7 offset:0
    ds_read_b128 v[164:167], v7 offset:1024
    ds_read_b128 v[168:171], v7 offset:2048
    ds_read_b128 v[172:175], v7 offset:3072
    ds_read_b128 v[176:179], v7 offset:4096
    ds_read_b128 v[180:183], v7 offset:5120
    ds_read_b128 v[184:187], v7 offset:6144
    ds_read_b128 v[188:191], v7 offset:7168
    s_waitcnt lgkmcnt(0)
    v_mfma_f32_16x16x32_bf16 v[224:227], v[160:163], v[112:115], 0
    v_mfma_f32_16x16x32_bf16 v[224:227], v[164:167], v[116:119], v[224:227]
    v_mfma_f32_16x16x32_bf16 v[228:231], v[168:171], v[112:115], 0
    v_mfma_f32_16x16x32_bf16 v[228:231], v[172:175], v[116:119], v[228:231]
    v_mfma_f32_16x16x32_bf16 v[232:235], v[176:179], v[112:115], 0
    v_mfma_f32_16x16x32_bf16 v[232:235], v[180:183], v[116:119], v[232:235]
    v_mfma_f32_16x16x32_bf16 v[236:239], v[184:187], v[112:115], 0
    v_mfma_f32_16x16x32_bf16 v[236:239], v[188:191], v[116:119], v[236:239]
    v_mfma_f32_16x16x32_bf16 v[240:243], v[160:163], v[120:123], 0
    v_mfma_f32_16x16x32_bf16 v[240:243], v[164:167], v[124:127], v[240:243]
    v_mfma_f32_16x16x32_bf16 v[244:247], v[168:171], v[120:123], 0
    v_mfma_f32_16x16x32_bf16 v[244:247], v[172:175], v[124:127], v[244:247]
    v_mfma_f32_16x16x32_bf16 v[148:151], v[176:179], v[120:123], 0
    v_mfma_f32_16x16x32_bf16 v[148:151], v[180:183], v[124:127], v[148:151]
    v_mfma_f32_16x16x32_bf16 v[112:115], v[184:187], v[120:123], 0
    v_mfma_f32_16x16x32_bf16 v[112:115], v[188:191], v[124:127], v[112:115]
    v_pk_mul_f32 v[152:153], v[224:225], v[224:225]
    v_pk_mul_f32 v[154:155], v[226:227], v[226:227]
    v_pk_fma_f32 v[152:153], v[228:229], v[228:229], v[152:153]
    v_pk_fma_f32 v[154:155], v[230:231], v[230:231], v[154:155]
    v_pk_fma_f32 v[152:153], v[232:233], v[232:233], v[152:153]
    v_pk_fma_f32 v[154:155], v[234:235], v[234:235], v[154:155]
    v_pk_fma_f32 v[152:153], v[236:237], v[236:237], v[152:153]
    v_pk_fma_f32 v[154:155], v[238:239], v[238:239], v[154:155]
    v_pk_add_f32 v[152:153], v[152:153], v[154:155]
    v_cvt_pk_bf16_f32 v192, v152, v153
    v_cvt_pk_bf16_f32 v16, v224, v225
    v_cvt_pk_bf16_f32 v17, v226, v227
    v_mfma_f32_16x16x32_bf16 v[156:159], v[144:147], v[192:195], 0
    v_cvt_pk_bf16_f32 v18, v228, v229
    v_cvt_pk_bf16_f32 v19, v230, v231
    v_cvt_pk_bf16_f32 v20, v232, v233
    v_cvt_pk_bf16_f32 v21, v234, v235
    v_cvt_pk_bf16_f32 v22, v236, v237
    s_nop 3
    v_sqrt_f32 v152, v156
    v_mov_b32 v153, s56
    v_fmac_f32 v153, s49, v152
    v_cndmask_b32 v239, v239, v153, s[54:55]
    v_cvt_pk_bf16_f32 v23, v238, v239
    v_mfma_f32_16x16x32_bf16 v[224:227], v[160:163], v[128:131], 0
    v_mfma_f32_16x16x32_bf16 v[224:227], v[164:167], v[132:135], v[224:227]
    v_mfma_f32_16x16x32_bf16 v[228:231], v[168:171], v[128:131], 0
    v_mfma_f32_16x16x32_bf16 v[228:231], v[172:175], v[132:135], v[228:231]
    v_mfma_f32_16x16x32_bf16 v[232:235], v[176:179], v[128:131], 0
    v_mfma_f32_16x16x32_bf16 v[232:235], v[180:183], v[132:135], v[232:235]
    v_mfma_f32_16x16x32_bf16 v[236:239], v[184:187], v[128:131], 0
    v_mfma_f32_16x16x32_bf16 v[236:239], v[188:191], v[132:135], v[236:239]
    v_pk_mul_f32 v[152:153], v[240:241], v[240:241]
    v_pk_mul_f32 v[154:155], v[242:243], v[242:243]
    v_pk_fma_f32 v[152:153], v[244:245], v[244:245], v[152:153]
    v_pk_fma_f32 v[154:155], v[246:247], v[246:247], v[154:155]
    v_pk_fma_f32 v[152:153], v[148:149], v[148:149], v[152:153]
    v_pk_fma_f32 v[154:155], v[150:151], v[150:151], v[154:155]
    v_pk_fma_f32 v[152:153], v[112:113], v[112:113], v[152:153]
    v_pk_fma_f32 v[154:155], v[114:115], v[114:115], v[154:155]
    v_pk_add_f32 v[152:153], v[152:153], v[154:155]
    v_cvt_pk_bf16_f32 v192, v152, v153
    v_cvt_pk_bf16_f32 v24, v240, v241
    v_cvt_pk_bf16_f32 v25, v242, v243
    v_mfma_f32_16x16x32_bf16 v[156:159], v[144:147], v[192:195], 0
    v_cvt_pk_bf16_f32 v26, v244, v245
    v_cvt_pk_bf16_f32 v27, v246, v247
    v_cvt_pk_bf16_f32 v28, v148, v149
    v_cvt_pk_bf16_f32 v29, v150, v151
    v_cvt_pk_bf16_f32 v30, v112, v113
    s_nop 3
    v_sqrt_f32 v152, v156
    v_mov_b32 v153, s56
    v_fmac_f32 v153, s49, v152
    v_cndmask_b32 v115, v115, v153, s[54:55]
    v_cvt_pk_bf16_f32 v31, v114, v115
    v_mfma_f32_16x16x32_bf16 v[240:243], v[160:163], v[136:139], 0
    v_mfma_f32_16x16x32_bf16 v[240:243], v[164:167], v[140:143], v[240:243]
    v_mfma_f32_16x16x32_bf16 v[244:247], v[168:171], v[136:139], 0
    v_mfma_f32_16x16x32_bf16 v[244:247], v[172:175], v[140:143], v[244:247]
    v_mfma_f32_16x16x32_bf16 v[148:151], v[176:179], v[136:139], 0
    v_mfma_f32_16x16x32_bf16 v[148:151], v[180:183], v[140:143], v[148:151]
    v_mfma_f32_16x16x32_bf16 v[112:115], v[184:187], v[136:139], 0
    v_mfma_f32_16x16x32_bf16 v[112:115], v[188:191], v[140:143], v[112:115]
    v_pk_mul_f32 v[152:153], v[224:225], v[224:225]
    v_pk_mul_f32 v[154:155], v[226:227], v[226:227]
    v_pk_fma_f32 v[152:153], v[228:229], v[228:229], v[152:153]
    v_pk_fma_f32 v[154:155], v[230:231], v[230:231], v[154:155]
    v_pk_fma_f32 v[152:153], v[232:233], v[232:233], v[152:153]
    v_pk_fma_f32 v[154:155], v[234:235], v[234:235], v[154:155]
    v_pk_fma_f32 v[152:153], v[236:237], v[236:237], v[152:153]
    v_pk_fma_f32 v[154:155], v[238:239], v[238:239], v[154:155]
    v_pk_add_f32 v[152:153], v[152:153], v[154:155]
    v_cvt_pk_bf16_f32 v192, v152, v153
    v_cvt_pk_bf16_f32 v32, v224, v225
    v_cvt_pk_bf16_f32 v33, v226, v227
    v_mfma_f32_16x16x32_bf16 v[156:159], v[144:147], v[192:195], 0
    v_cvt_pk_bf16_f32 v34, v228, v229
    v_cvt_pk_bf16_f32 v35, v230, v231
    v_cvt_pk_bf16_f32 v36, v232, v233
    v_cvt_pk_bf16_f32 v37, v234, v235
    v_cvt_pk_bf16_f32 v38, v236, v237
    s_nop 3
    v_sqrt_f32 v152, v156
    v_mov_b32 v153, s56
    v_fmac_f32 v153, s49, v152
    v_cndmask_b32 v239, v239, v153, s[54:55]
    v_cvt_pk_bf16_f32 v39, v238, v239
    v_pk_mul_f32 v[152:153], v[240:241], v[240:241]
    v_pk_mul_f32 v[154:155], v[242:243], v[242:243]
    v_pk_fma_f32 v[152:153], v[244:245], v[244:245], v[152:153]
    v_pk_fma_f32 v[154:155], v[246:247], v[246:247], v[154:155]
    v_pk_fma_f32 v[152:153], v[148:149], v[148:149], v[152:153]
    v_pk_fma_f32 v[154:155], v[150:151], v[150:151], v[154:155]
    v_pk_fma_f32 v[152:153], v[112:113], v[112:113], v[152:153]
    v_pk_fma_f32 v[154:155], v[114:115], v[114:115], v[154:155]
    v_pk_add_f32 v[152:153], v[152:153], v[154:155]
    v_cvt_pk_bf16_f32 v192, v152, v153
    v_cvt_pk_bf16_f32 v40, v240, v241
    v_cvt_pk_bf16_f32 v41, v242, v243
    v_mfma_f32_16x16x32_bf16 v[156:159], v[144:147], v[192:195], 0
    v_cvt_pk_bf16_f32 v42, v244, v245
    v_cvt_pk_bf16_f32 v43, v246, v247
    v_cvt_pk_bf16_f32 v44, v148, v149
    v_cvt_pk_bf16_f32 v45, v150, v151
    v_cvt_pk_bf16_f32 v46, v112, v113
    s_nop 3
    v_sqrt_f32 v152, v156
    v_mov_b32 v153, s56
    v_fmac_f32 v153, s49, v152
    v_cndmask_b32 v115, v115, v153, s[54:55]
    v_cvt_pk_bf16_f32 v47, v114, v115
    v_mov_b32 v192, 0
    s_cmp_eq_u32 s53, 4
    s_cselect_b32 s53, -1, 1
    v_mov_b32 v152, 0
    v_mov_b32 v153, 0
    v_mov_b32 v154, 0
    v_mov_b32 v155, 0
    v_mov_b32 v156, 0
    v_mov_b32 v157, 0
    v_mov_b32 v158, 0
    v_mov_b32 v159, 0
    s_mov_b32 s50, 262144
W_95:
    ds_read_b32 v14, v15 offset:0
    s_waitcnt lgkmcnt(0)
    v_readfirstlane_b32 s29, v14
    s_nop 3
    s_cmp_ge_u32 s29, 1
    s_cbranch_scc1 W_96
    s_sleep 0
    s_sub_u32 s50, s50, 1
    s_cmp_lg_u32 s50, 0
    s_cbranch_scc1 W_95
W_96:
    s_setprio 2
    ds_read_b128 v[160:163], v4 offset:0
    ds_read_b128 v[164:167], v5 offset:0
    ds_read_b128 v[168:171], v4 offset:2048
    ds_read_b128 v[172:175], v5 offset:2048
    ds_read_b128 v[176:179], v4 offset:4096
    ds_read_b128 v[180:183], v5 offset:4096
    ds_read_b128 v[184:187], v4 offset:6144
    ds_read_b128 v[188:191], v5 offset:6144
    s_waitcnt lgkmcnt(0)
    v_mfma_f32_16x16x32_bf16 v[112:115], v[160:163], v[16:19], 0
    v_mfma_f32_16x16x32_bf16 v[112:115], v[164:167], v[20:23], v[112:115]
    v_mfma_f32_16x16x32_bf16 v[116:119], v[168:171], v[16:19], 0
    v_mfma_f32_16x16x32_bf16 v[116:119], v[172:175], v[20:23], v[116:119]
    v_mfma_f32_16x16x32_bf16 v[120:123], v[176:179], v[16:19], 0
    v_mfma_f32_16x16x32_bf16 v[120:123], v[180:183], v[20:23], v[120:123]
    v_mfma_f32_16x16x32_bf16 v[124:127], v[184:187], v[16:19], 0
    v_mfma_f32_16x16x32_bf16 v[124:127], v[188:191], v[20:23], v[124:127]
    s_nop 7
.p2align 6
F_LOOP:
    v_exp_f32 v112, v112
    v_mfma_f32_16x16x32_bf16 v[96:99], v[192:195], v[152:155], v[96:99]
    v_exp_f32 v113, v113
    v_mfma_f32_16x16x32_bf16 v[96:99], v[196:199], v[156:159], v[96:99]
    ds_read_b64_tr_b16 v[192:193], v8 offset:0
    v_cvt_pk_bf16_f32 v144, v112, v113
    v_exp_f32 v114, v114
    v_mfma_f32_16x16x32_bf16 v[100:103], v[200:203], v[152:155], v[100:103]
    ds_read_b64_tr_b16 v[194:195], v8 offset:2048
    v_exp_f32 v115, v115
    v_mfma_f32_16x16x32_bf16 v[100:103], v[204:207], v[156:159], v[100:103]
    ds_read_b64_tr_b16 v[196:197], v8 offset:4096
    v_cvt_pk_bf16_f32 v145, v114, v115
    v_exp_f32 v116, v116
    v_mfma_f32_16x16x32_bf16 v[104:107], v[208:211], v[152:155], v[104:107]
    ds_read_b64_tr_b16 v[198:199], v8 offset:6144
    v_exp_f32 v117, v117
    v_mfma_f32_16x16x32_bf16 v[104:107], v[212:215], v[156:159], v[104:107]
    ds_read_b64_tr_b16 v[200:201], v9 offset:0
    v_cvt_pk_bf16_f32 v146, v116, v117
    v_exp_f32 v118, v118
    v_mfma_f32_16x16x32_bf16 v[108:111], v[216:219], v[152:155], v[108:111]
    ds_read_b64_tr_b16 v[202:203], v9 offset:2048
    v_exp_f32 v119, v119
    v_mfma_f32_16x16x32_bf16 v[108:111], v[220:223], v[156:159], v[108:111]
    ds_read_b64_tr_b16 v[204:205], v9 offset:4096
    v_cvt_pk_bf16_f32 v147, v118, v119
    v_exp_f32 v120, v120
    v_mfma_f32_16x16x32_bf16 v[128:131], v[160:163], v[24:27], 0
    ds_read_b64_tr_b16 v[206:207], v9 offset:6144
    v_exp_f32 v121, v121
    v_mfma_f32_16x16x32_bf16 v[128:131], v[164:167], v[28:31], v[128:131]
    ds_read_b64_tr_b16 v[208:209], v10 offset:0
    v_cvt_pk_bf16_f32 v148, v120, v121
    v_exp_f32 v122, v122
    v_mfma_f32_16x16x32_bf16 v[132:135], v[168:171], v[24:27], 0
    ds_read_b64_tr_b16 v[210:211], v10 offset:2048
    v_exp_f32 v123, v123
    v_mfma_f32_16x16x32_bf16 v[132:135], v[172:175], v[28:31], v[132:135]
    ds_read_b64_tr_b16 v[212:213], v10 offset:4096
    v_cvt_pk_bf16_f32 v149, v122, v123
    v_exp_f32 v124, v124
    v_mfma_f32_16x16x32_bf16 v[136:139], v[176:179], v[24:27], 0
    ds_read_b64_tr_b16 v[214:215], v10 offset:6144
    v_exp_f32 v125, v125
    v_mfma_f32_16x16x32_bf16 v[136:139], v[180:183], v[28:31], v[136:139]
    ds_read_b64_tr_b16 v[216:217], v11 offset:0
    v_cvt_pk_bf16_f32 v150, v124, v125
    v_exp_f32 v126, v126
    v_mfma_f32_16x16x32_bf16 v[140:143], v[184:187], v[24:27], 0
    ds_read_b64_tr_b16 v[218:219], v11 offset:2048
    v_exp_f32 v127, v127
    v_mfma_f32_16x16x32_bf16 v[140:143], v[188:191], v[28:31], v[140:143]
    ds_read_b64_tr_b16 v[220:221], v11 offset:4096
    v_cvt_pk_bf16_f32 v151, v126, v127
    v_exp_f32 v128, v128
    v_mfma_f32_16x16x32_bf16 v[112:115], v[160:163], v[32:35], 0
    ds_read_b64_tr_b16 v[222:223], v11 offset:6144
    v_exp_f32 v129, v129
    v_mfma_f32_16x16x32_bf16 v[112:115], v[164:167], v[36:39], v[112:115]
    v_cvt_pk_bf16_f32 v152, v128, v129
    v_exp_f32 v130, v130
    v_mfma_f32_16x16x32_bf16 v[116:119], v[168:171], v[32:35], 0
    v_exp_f32 v131, v131
    v_mfma_f32_16x16x32_bf16 v[116:119], v[172:175], v[36:39], v[116:119]
    v_cvt_pk_bf16_f32 v153, v130, v131
    v_exp_f32 v132, v132
    v_mfma_f32_16x16x32_bf16 v[120:123], v[176:179], v[32:35], 0
    v_exp_f32 v133, v133
    v_mfma_f32_16x16x32_bf16 v[120:123], v[180:183], v[36:39], v[120:123]
    v_cvt_pk_bf16_f32 v154, v132, v133
    v_exp_f32 v134, v134
    v_mfma_f32_16x16x32_bf16 v[124:127], v[184:187], v[32:35], 0
    v_exp_f32 v135, v135
    v_mfma_f32_16x16x32_bf16 v[124:127], v[188:191], v[36:39], v[124:127]
    s_waitcnt lgkmcnt(4)
    v_cvt_pk_bf16_f32 v155, v134, v135
    v_exp_f32 v136, v136
    v_mfma_f32_16x16x32_bf16 v[48:51], v[192:195], v[144:147], v[48:51]
    v_exp_f32 v137, v137
    v_mfma_f32_16x16x32_bf16 v[48:51], v[196:199], v[148:151], v[48:51]
    v_cvt_pk_bf16_f32 v156, v136, v137
    v_exp_f32 v138, v138
    v_mfma_f32_16x16x32_bf16 v[52:55], v[200:203], v[144:147], v[52:55]
    v_exp_f32 v139, v139
    v_mfma_f32_16x16x32_bf16 v[52:55], v[204:207], v[148:151], v[52:55]
    v_cvt_pk_bf16_f32 v157, v138, v139
    v_exp_f32 v140, v140
    v_mfma_f32_16x16x32_bf16 v[56:59], v[208:211], v[144:147], v[56:59]
    s_waitcnt lgkmcnt(0)
    v_exp_f32 v141, v141
    v_mfma_f32_16x16x32_bf16 v[56:59], v[212:215], v[148:151], v[56:59]
    v_cvt_pk_bf16_f32 v158, v140, v141
    v_exp_f32 v142, v142
    v_mfma_f32_16x16x32_bf16 v[60:63], v[216:219], v[144:147], v[60:63]
    v_exp_f32 v143, v143
    v_mfma_f32_16x16x32_bf16 v[60:63], v[220:223], v[148:151], v[60:63]
    v_cvt_pk_bf16_f32 v159, v142, v143
    v_exp_f32 v112, v112
    v_mfma_f32_16x16x32_bf16 v[128:131], v[160:163], v[40:43], 0
    v_exp_f32 v113, v113
    v_mfma_f32_16x16x32_bf16 v[128:131], v[164:167], v[44:47], v[128:131]
    ds_read_b128 v[160:163], v4 offset:8192
    v_cvt_pk_bf16_f32 v144, v112, v113
    v_exp_f32 v114, v114
    v_mfma_f32_16x16x32_bf16 v[132:135], v[168:171], v[40:43], 0
    ds_read_b128 v[164:167], v5 offset:8192
    v_exp_f32 v115, v115
    v_mfma_f32_16x16x32_bf16 v[132:135], v[172:175], v[44:47], v[132:135]
    ds_read_b128 v[168:171], v4 offset:10240
    v_cvt_pk_bf16_f32 v145, v114, v115
    v_exp_f32 v116, v116
    v_mfma_f32_16x16x32_bf16 v[136:139], v[176:179], v[40:43], 0
    ds_read_b128 v[172:175], v5 offset:10240
    v_exp_f32 v117, v117
    v_mfma_f32_16x16x32_bf16 v[136:139], v[180:183], v[44:47], v[136:139]
    ds_read_b128 v[176:179], v4 offset:12288
    v_cvt_pk_bf16_f32 v146, v116, v117
    v_exp_f32 v118, v118
    v_mfma_f32_16x16x32_bf16 v[140:143], v[184:187], v[40:43], 0
    ds_read_b128 v[180:183], v5 offset:12288
    v_exp_f32 v119, v119
    v_mfma_f32_16x16x32_bf16 v[140:143], v[188:191], v[44:47], v[140:143]
    ds_read_b128 v[184:187], v4 offset:14336
    v_cvt_pk_bf16_f32 v147, v118, v119
    v_exp_f32 v120, v120
    v_mfma_f32_16x16x32_bf16 v[64:67], v[192:195], v[152:155], v[64:67]
    ds_read_b128 v[188:191], v5 offset:14336
    v_exp_f32 v121, v121
    v_mfma_f32_16x16x32_bf16 v[64:67], v[196:199], v[156:159], v[64:67]
    v_cvt_pk_bf16_f32 v148, v120, v121
    v_exp_f32 v122, v122
    v_mfma_f32_16x16x32_bf16 v[68:71], v[200:203], v[152:155], v[68:71]
    v_exp_f32 v123, v123
    v_mfma_f32_16x16x32_bf16 v[68:71], v[204:207], v[156:159], v[68:71]
    v_cvt_pk_bf16_f32 v149, v122, v123
    v_exp_f32 v124, v124
    v_mfma_f32_16x16x32_bf16 v[72:75], v[208:211], v[152:155], v[72:75]
    v_exp_f32 v125, v125
    v_mfma_f32_16x16x32_bf16 v[72:75], v[212:215], v[156:159], v[72:75]
    v_cvt_pk_bf16_f32 v150, v124, v125
    v_exp_f32 v126, v126
    v_mfma_f32_16x16x32_bf16 v[76:79], v[216:219], v[152:155], v[76:79]
    v_exp_f32 v127, v127
    v_mfma_f32_16x16x32_bf16 v[76:79], v[220:223], v[156:159], v[76:79]
    v_cvt_pk_bf16_f32 v151, v126, v127
    v_exp_f32 v128, v128
    v_mfma_f32_16x16x32_bf16 v[80:83], v[192:195], v[144:147], v[80:83]
    v_exp_f32 v129, v129
    v_mfma_f32_16x16x32_bf16 v[80:83], v[196:199], v[148:151], v[80:83]
    v_cvt_pk_bf16_f32 v152, v128, v129
    v_exp_f32 v130, v130
    v_mfma_f32_16x16x32_bf16 v[84:87], v[200:203], v[144:147], v[84:87]
    v_exp_f32 v131, v131
    v_mfma_f32_16x16x32_bf16 v[84:87], v[204:207], v[148:151], v[84:87]
    v_cvt_pk_bf16_f32 v153, v130, v131
    v_exp_f32 v132, v132
    v_mfma_f32_16x16x32_bf16 v[88:91], v[208:211], v[144:147], v[88:91]
    v_exp_f32 v133, v133
    v_mfma_f32_16x16x32_bf16 v[88:91], v[212:215], v[148:151], v[88:91]
    v_cvt_pk_bf16_f32 v154, v132, v133
    v_exp_f32 v134, v134
    v_mfma_f32_16x16x32_bf16 v[92:95], v[216:219], v[144:147], v[92:95]
    v_exp_f32 v135, v135
    v_mfma_f32_16x16x32_bf16 v[92:95], v[220:223], v[148:151], v[92:95]
    s_waitcnt lgkmcnt(0)
    v_cvt_pk_bf16_f32 v155, v134, v135
    v_exp_f32 v136, v136
    v_mfma_f32_16x16x32_bf16 v[112:115], v[160:163], v[16:19], 0
    v_exp_f32 v137, v137
    v_mfma_f32_16x16x32_bf16 v[112:115], v[164:167], v[20:23], v[112:115]
    ds_read_b32 v14, v15 offset:0
    v_cvt_pk_bf16_f32 v156, v136, v137
    v_exp_f32 v138, v138
    v_mfma_f32_16x16x32_bf16 v[116:119], v[168:171], v[16:19], 0
    v_exp_f32 v139, v139
    v_mfma_f32_16x16x32_bf16 v[116:119], v[172:175], v[20:23], v[116:119]
    v_cvt_pk_bf16_f32 v157, v138, v139
    v_exp_f32 v140, v140
    v_mfma_f32_16x16x32_bf16 v[120:123], v[176:179], v[16:19], 0
    v_exp_f32 v141, v141
    v_mfma_f32_16x16x32_bf16 v[120:123], v[180:183], v[20:23], v[120:123]
    v_cvt_pk_bf16_f32 v158, v140, v141
    v_exp_f32 v142, v142
    v_mfma_f32_16x16x32_bf16 v[124:127], v[184:187], v[16:19], 0
    v_exp_f32 v143, v143
    v_mfma_f32_16x16x32_bf16 v[124:127], v[188:191], v[20:23], v[124:127]
    v_cvt_pk_bf16_f32 v159, v142, v143
    v_exp_f32 v112, v112
    v_mfma_f32_16x16x32_bf16 v[96:99], v[192:195], v[152:155], v[96:99]
    v_exp_f32 v113, v113
    v_mfma_f32_16x16x32_bf16 v[96:99], v[196:199], v[156:159], v[96:99]
    ds_read_b64_tr_b16 v[192:193], v8 offset:8192
    v_cvt_pk_bf16_f32 v144, v112, v113
    v_exp_f32 v114, v114
    v_mfma_f32_16x16x32_bf16 v[100:103], v[200:203], v[152:155], v[100:103]
    ds_read_b64_tr_b16 v[194:195], v8 offset:10240
    v_exp_f32 v115, v115
    v_mfma_f32_16x16x32_bf16 v[100:103], v[204:207], v[156:159], v[100:103]
    ds_read_b64_tr_b16 v[196:197], v8 offset:12288
    v_cvt_pk_bf16_f32 v145, v114, v115
    v_exp_f32 v116, v116
    v_mfma_f32_16x16x32_bf16 v[104:107], v[208:211], v[152:155], v[104:107]
    ds_read_b64_tr_b16 v[198:199], v8 offset:14336
    v_exp_f32 v117, v117
    v_mfma_f32_16x16x32_bf16 v[104:107], v[212:215], v[156:159], v[104:107]
    ds_read_b64_tr_b16 v[200:201], v9 offset:8192
    v_cvt_pk_bf16_f32 v146, v116, v117
    v_exp_f32 v118, v118
    v_mfma_f32_16x16x32_bf16 v[108:111], v[216:219], v[152:155], v[108:111]
    ds_read_b64_tr_b16 v[202:203], v9 offset:10240
    v_exp_f32 v119, v119
    v_mfma_f32_16x16x32_bf16 v[108:111], v[220:223], v[156:159], v[108:111]
    ds_read_b64_tr_b16 v[204:205], v9 offset:12288
    v_cvt_pk_bf16_f32 v147, v118, v119
    v_exp_f32 v120, v120
    v_mfma_f32_16x16x32_bf16 v[128:131], v[160:163], v[24:27], 0
    ds_read_b64_tr_b16 v[206:207], v9 offset:14336
    v_exp_f32 v121, v121
    v_mfma_f32_16x16x32_bf16 v[128:131], v[164:167], v[28:31], v[128:131]
    ds_read_b64_tr_b16 v[208:209], v10 offset:8192
    v_cvt_pk_bf16_f32 v148, v120, v121
    v_exp_f32 v122, v122
    v_mfma_f32_16x16x32_bf16 v[132:135], v[168:171], v[24:27], 0
    ds_read_b64_tr_b16 v[210:211], v10 offset:10240
    v_exp_f32 v123, v123
    v_mfma_f32_16x16x32_bf16 v[132:135], v[172:175], v[28:31], v[132:135]
    ds_read_b64_tr_b16 v[212:213], v10 offset:12288
    v_cvt_pk_bf16_f32 v149, v122, v123
    v_exp_f32 v124, v124
    v_mfma_f32_16x16x32_bf16 v[136:139], v[176:179], v[24:27], 0
    ds_read_b64_tr_b16 v[214:215], v10 offset:14336
    v_exp_f32 v125, v125
    v_mfma_f32_16x16x32_bf16 v[136:139], v[180:183], v[28:31], v[136:139]
    ds_read_b64_tr_b16 v[216:217], v11 offset:8192
    v_cvt_pk_bf16_f32 v150, v124, v125
    v_exp_f32 v126, v126
    v_mfma_f32_16x16x32_bf16 v[140:143], v[184:187], v[24:27], 0
    ds_read_b64_tr_b16 v[218:219], v11 offset:10240
    v_exp_f32 v127, v127
    v_mfma_f32_16x16x32_bf16 v[140:143], v[188:191], v[28:31], v[140:143]
    ds_read_b64_tr_b16 v[220:221], v11 offset:12288
    v_cvt_pk_bf16_f32 v151, v126, v127
    v_exp_f32 v128, v128
    v_mfma_f32_16x16x32_bf16 v[112:115], v[160:163], v[32:35], 0
    ds_read_b64_tr_b16 v[222:223], v11 offset:14336
    v_exp_f32 v129, v129
    v_mfma_f32_16x16x32_bf16 v[112:115], v[164:167], v[36:39], v[112:115]
    v_cvt_pk_bf16_f32 v152, v128, v129
    v_exp_f32 v130, v130
    v_mfma_f32_16x16x32_bf16 v[116:119], v[168:171], v[32:35], 0
    v_exp_f32 v131, v131
    v_mfma_f32_16x16x32_bf16 v[116:119], v[172:175], v[36:39], v[116:119]
    s_add_u32 s41, s41, 1
    v_cvt_pk_bf16_f32 v153, v130, v131
    v_exp_f32 v132, v132
    v_mfma_f32_16x16x32_bf16 v[120:123], v[176:179], v[32:35], 0
    v_exp_f32 v133, v133
    v_mfma_f32_16x16x32_bf16 v[120:123], v[180:183], v[36:39], v[120:123]
    v_cvt_pk_bf16_f32 v154, v132, v133
    v_exp_f32 v134, v134
    v_mfma_f32_16x16x32_bf16 v[124:127], v[184:187], v[32:35], 0
    v_exp_f32 v135, v135
    v_mfma_f32_16x16x32_bf16 v[124:127], v[188:191], v[36:39], v[124:127]
    s_waitcnt lgkmcnt(4)
    v_cvt_pk_bf16_f32 v155, v134, v135
    v_exp_f32 v136, v136
    v_mfma_f32_16x16x32_bf16 v[48:51], v[192:195], v[144:147], v[48:51]
    v_exp_f32 v137, v137
    v_mfma_f32_16x16x32_bf16 v[48:51], v[196:199], v[148:151], v[48:51]
    v_readfirstlane_b32 s40, v14
    v_cvt_pk_bf16_f32 v156, v136, v137
    v_exp_f32 v138, v138
    v_mfma_f32_16x16x32_bf16 v[52:55], v[200:203], v[144:147], v[52:55]
    v_add_u32 v12, 1, v12
    v_exp_f32 v139, v139
    v_mfma_f32_16x16x32_bf16 v[52:55], v[204:207], v[148:151], v[52:55]
    v_cvt_pk_bf16_f32 v157, v138, v139
    v_exp_f32 v140, v140
    v_mfma_f32_16x16x32_bf16 v[56:59], v[208:211], v[144:147], v[56:59]
    s_waitcnt lgkmcnt(0)
    v_exp_f32 v141, v141
    v_mfma_f32_16x16x32_bf16 v[56:59], v[212:215], v[148:151], v[56:59]
    ds_write_b32 v13, v12
    v_cvt_pk_bf16_f32 v158, v140, v141
    v_exp_f32 v142, v142
    v_mfma_f32_16x16x32_bf16 v[60:63], v[216:219], v[144:147], v[60:63]
    v_exp_f32 v143, v143
    v_mfma_f32_16x16x32_bf16 v[60:63], v[220:223], v[148:151], v[60:63]
    s_cmp_gt_u32 s40, s41
    v_cvt_pk_bf16_f32 v159, v142, v143
    v_exp_f32 v112, v112
    v_mfma_f32_16x16x32_bf16 v[128:131], v[160:163], v[40:43], 0
    s_cbranch_scc0 F_POLL1
F_BACK1:
    v_exp_f32 v113, v113
    v_mfma_f32_16x16x32_bf16 v[128:131], v[164:167], v[44:47], v[128:131]
    ds_read_b128 v[160:163], v4 offset:16384
    v_cvt_pk_bf16_f32 v144, v112, v113
    v_exp_f32 v114, v114
    v_mfma_f32_16x16x32_bf16 v[132:135], v[168:171], v[40:43], 0
    ds_read_b128 v[164:167], v5 offset:16384
    v_exp_f32 v115, v115
    v_mfma_f32_16x16x32_bf16 v[132:135], v[172:175], v[44:47], v[132:135]
    ds_read_b128 v[168:171], v4 offset:18432
    v_cvt_pk_bf16_f32 v145, v114, v115
    v_exp_f32 v116, v116
    v_mfma_f32_16x16x32_bf16 v[136:139], v[176:179], v[40:43], 0
    ds_read_b128 v[172:175], v5 offset:18432
    v_exp_f32 v117, v117
    v_mfma_f32_16x16x32_bf16 v[136:139], v[180:183], v[44:47], v[136:139]
    ds_read_b128 v[176:179], v4 offset:20480
    v_cvt_pk_bf16_f32 v146, v116, v117
    v_exp_f32 v118, v118
    v_mfma_f32_16x16x32_bf16 v[140:143], v[184:187], v[40:43], 0
    ds_read_b128 v[180:183], v5 offset:20480
    v_exp_f32 v119, v119
    v_mfma_f32_16x16x32_bf16 v[140:143], v[188:191], v[44:47], v[140:143]
    ds_read_b128 v[184:187], v4 offset:22528
    v_cvt_pk_bf16_f32 v147, v118, v119
    v_exp_f32 v120, v120
    v_mfma_f32_16x16x32_bf16 v[64:67], v[192:195], v[152:155], v[64:67]
    ds_read_b128 v[188:191], v5 offset:22528
    v_exp_f32 v121, v121
    v_mfma_f32_16x16x32_bf16 v[64:67], v[196:199], v[156:159], v[64:67]
    v_cvt_pk_bf16_f32 v148, v120, v121
    v_exp_f32 v122, v122
    v_mfma_f32_16x16x32_bf16 v[68:71], v[200:203], v[152:155], v[68:71]
    v_exp_f32 v123, v123
    v_mfma_f32_16x16x32_bf16 v[68:71], v[204:207], v[156:159], v[68:71]
    v_cvt_pk_bf16_f32 v149, v122, v123
    v_exp_f32 v124, v124
    v_mfma_f32_16x16x32_bf16 v[72:75], v[208:211], v[152:155], v[72:75]
    v_exp_f32 v125, v125
    v_mfma_f32_16x16x32_bf16 v[72:75], v[212:215], v[156:159], v[72:75]
    v_cvt_pk_bf16_f32 v150, v124, v125
    v_exp_f32 v126, v126
    v_mfma_f32_16x16x32_bf16 v[76:79], v[216:219], v[152:155], v[76:79]
    v_exp_f32 v127, v127
    v_mfma_f32_16x16x32_bf16 v[76:79], v[220:223], v[156:159], v[76:79]
    v_cvt_pk_bf16_f32 v151, v126, v127
    v_exp_f32 v128, v128
    v_mfma_f32_16x16x32_bf16 v[80:83], v[192:195], v[144:147], v[80:83]
    v_exp_f32 v129, v129
    v_mfma_f32_16x16x32_bf16 v[80:83], v[196:199], v[148:151], v[80:83]
    v_cvt_pk_bf16_f32 v152, v128, v129
    v_exp_f32 v130, v130
    v_mfma_f32_16x16x32_bf16 v[84:87], v[200:203], v[144:147], v[84:87]
    v_exp_f32 v131, v131
    v_mfma_f32_16x16x32_bf16 v[84:87], v[204:207], v[148:151], v[84:87]
    v_cvt_pk_bf16_f32 v153, v130, v131
    v_exp_f32 v132, v132
    v_mfma_f32_16x16x32_bf16 v[88:91], v[208:211], v[144:147], v[88:91]
    v_exp_f32 v133, v133
    v_mfma_f32_16x16x32_bf16 v[88:91], v[212:215], v[148:151], v[88:91]
    v_cvt_pk_bf16_f32 v154, v132, v133
    v_exp_f32 v134, v134
    v_mfma_f32_16x16x32_bf16 v[92:95], v[216:219], v[144:147], v[92:95]
    v_exp_f32 v135, v135
    v_mfma_f32_16x16x32_bf16 v[92:95], v[220:223], v[148:151], v[92:95]
    s_waitcnt lgkmcnt(0)
    v_cvt_pk_bf16_f32 v155, v134, v135
    v_exp_f32 v136, v136
    v_mfma_f32_16x16x32_bf16 v[112:115], v[160:163], v[16:19], 0
    v_exp_f32 v137, v137
    v_mfma_f32_16x16x32_bf16 v[112:115], v[164:167], v[20:23], v[112:115]
    v_cvt_pk_bf16_f32 v156, v136, v137
    v_exp_f32 v138, v138
    v_mfma_f32_16x16x32_bf16 v[116:119], v[168:171], v[16:19], 0
    v_exp_f32 v139, v139
    v_mfma_f32_16x16x32_bf16 v[116:119], v[172:175], v[20:23], v[116:119]
    v_cvt_pk_bf16_f32 v157, v138, v139
    v_exp_f32 v140, v140
    v_mfma_f32_16x16x32_bf16 v[120:123], v[176:179], v[16:19], 0
    v_exp_f32 v141, v141
    v_mfma_f32_16x16x32_bf16 v[120:123], v[180:183], v[20:23], v[120:123]
    v_cvt_pk_bf16_f32 v158, v140, v141
    v_exp_f32 v142, v142
    v_mfma_f32_16x16x32_bf16 v[124:127], v[184:187], v[16:19], 0
    v_exp_f32 v143, v143
    v_mfma_f32_16x16x32_bf16 v[124:127], v[188:191], v[20:23], v[124:127]
    v_cvt_pk_bf16_f32 v159, v142, v143
    v_exp_f32 v112, v112
    v_mfma_f32_16x16x32_bf16 v[96:99], v[192:195], v[152:155], v[96:99]
    v_exp_f32 v113, v113
    v_mfma_f32_16x16x32_bf16 v[96:99], v[196:199], v[156:159], v[96:99]
    ds_read_b64_tr_b16 v[192:193], v8 offset:16384
    v_cvt_pk_bf16_f32 v144, v112, v113
    v_exp_f32 v114, v114
    v_mfma_f32_16x16x32_bf16 v[100:103], v[200:203], v[152:155], v[100:103]
    ds_read_b64_tr_b16 v[194:195], v8 offset:18432
    v_exp_f32 v115, v115
    v_mfma_f32_16x16x32_bf16 v[100:103], v[204:207], v[156:159], v[100:103]
    ds_read_b64_tr_b16 v[196:197], v8 offset:20480
    v_cvt_pk_bf16_f32 v145, v114, v115
    v_exp_f32 v116, v116
    v_mfma_f32_16x16x32_bf16 v[104:107], v[208:211], v[152:155], v[104:107]
    ds_read_b64_tr_b16 v[198:199], v8 offset:22528
    v_exp_f32 v117, v117
    v_mfma_f32_16x16x32_bf16 v[104:107], v[212:215], v[156:159], v[104:107]
    ds_read_b64_tr_b16 v[200:201], v9 offset:16384
    v_cvt_pk_bf16_f32 v146, v116, v117
    v_exp_f32 v118, v118
    v_mfma_f32_16x16x32_bf16 v[108:111], v[216:219], v[152:155], v[108:111]
    ds_read_b64_tr_b16 v[202:203], v9 offset:18432
    v_exp_f32 v119, v119
    v_mfma_f32_16x16x32_bf16 v[108:111], v[220:223], v[156:159], v[108:111]
    ds_read_b64_tr_b16 v[204:205], v9 offset:20480
    v_cvt_pk_bf16_f32 v147, v118, v119
    v_exp_f32 v120, v120
    v_mfma_f32_16x16x32_bf16 v[128:131], v[160:163], v[24:27], 0
    ds_read_b64_tr_b16 v[206:207], v9 offset:22528
    v_exp_f32 v121, v121
    v_mfma_f32_16x16x32_bf16 v[128:131], v[164:167], v[28:31], v[128:131]
    ds_read_b64_tr_b16 v[208:209], v10 offset:16384
    v_cvt_pk_bf16_f32 v148, v120, v121
    v_exp_f32 v122, v122
    v_mfma_f32_16x16x32_bf16 v[132:135], v[168:171], v[24:27], 0
    ds_read_b64_tr_b16 v[210:211], v10 offset:18432
    v_exp_f32 v123, v123
    v_mfma_f32_16x16x32_bf16 v[132:135], v[172:175], v[28:31], v[132:135]
    ds_read_b64_tr_b16 v[212:213], v10 offset:20480
    v_cvt_pk_bf16_f32 v149, v122, v123
    v_exp_f32 v124, v124
    v_mfma_f32_16x16x32_bf16 v[136:139], v[176:179], v[24:27], 0
    ds_read_b64_tr_b16 v[214:215], v10 offset:22528
    v_exp_f32 v125, v125
    v_mfma_f32_16x16x32_bf16 v[136:139], v[180:183], v[28:31], v[136:139]
    ds_read_b64_tr_b16 v[216:217], v11 offset:16384
    v_cvt_pk_bf16_f32 v150, v124, v125
    v_exp_f32 v126, v126
    v_mfma_f32_16x16x32_bf16 v[140:143], v[184:187], v[24:27], 0
    ds_read_b64_tr_b16 v[218:219], v11 offset:18432
    v_exp_f32 v127, v127
    v_mfma_f32_16x16x32_bf16 v[140:143], v[188:191], v[28:31], v[140:143]
    ds_read_b64_tr_b16 v[220:221], v11 offset:20480
    v_cvt_pk_bf16_f32 v151, v126, v127
    v_exp_f32 v128, v128
    v_mfma_f32_16x16x32_bf16 v[112:115], v[160:163], v[32:35], 0
    ds_read_b64_tr_b16 v[222:223], v11 offset:22528
    v_exp_f32 v129, v129
    v_mfma_f32_16x16x32_bf16 v[112:115], v[164:167], v[36:39], v[112:115]
    v_cvt_pk_bf16_f32 v152, v128, v129
    v_exp_f32 v130, v130
    v_mfma_f32_16x16x32_bf16 v[116:119], v[168:171], v[32:35], 0
    v_exp_f32 v131, v131
    v_mfma_f32_16x16x32_bf16 v[116:119], v[172:175], v[36:39], v[116:119]
    v_cvt_pk_bf16_f32 v153, v130, v131
    v_exp_f32 v132, v132
    v_mfma_f32_16x16x32_bf16 v[120:123], v[176:179], v[32:35], 0
    v_exp_f32 v133, v133
    v_mfma_f32_16x16x32_bf16 v[120:123], v[180:183], v[36:39], v[120:123]
    v_cvt_pk_bf16_f32 v154, v132, v133
    v_exp_f32 v134, v134
    v_mfma_f32_16x16x32_bf16 v[124:127], v[184:187], v[32:35], 0
    v_exp_f32 v135, v135
    v_mfma_f32_16x16x32_bf16 v[124:127], v[188:191], v[36:39], v[124:127]
    s_waitcnt lgkmcnt(4)
    v_cvt_pk_bf16_f32 v155, v134, v135
    v_exp_f32 v136, v136
    v_mfma_f32_16x16x32_bf16 v[48:51], v[192:195], v[144:147], v[48:51]
    v_exp_f32 v137, v137
    v_mfma_f32_16x16x32_bf16 v[48:51], v[196:199], v[148:151], v[48:51]
    v_cvt_pk_bf16_f32 v156, v136, v137
    v_exp_f32 v138, v138
    v_mfma_f32_16x16x32_bf16 v[52:55], v[200:203], v[144:147], v[52:55]
    v_exp_f32 v139, v139
    v_mfma_f32_16x16x32_bf16 v[52:55], v[204:207], v[148:151], v[52:55]
    v_cvt_pk_bf16_f32 v157, v138, v139
    v_exp_f32 v140, v140
    v_mfma_f32_16x16x32_bf16 v[56:59], v[208:211], v[144:147], v[56:59]
    s_waitcnt lgkmcnt(0)
    v_exp_f32 v141, v141
    v_mfma_f32_16x16x32_bf16 v[56:59], v[212:215], v[148:151], v[56:59]
    v_cvt_pk_bf16_f32 v158, v140, v141
    v_exp_f32 v142, v142
    v_mfma_f32_16x16x32_bf16 v[60:63], v[216:219], v[144:147], v[60:63]
    v_exp_f32 v143, v143
    v_mfma_f32_16x16x32_bf16 v[60:63], v[220:223], v[148:151], v[60:63]
    v_cvt_pk_bf16_f32 v159, v142, v143
    v_exp_f32 v112, v112
    v_mfma_f32_16x16x32_bf16 v[128:131], v[160:163], v[40:43], 0
    v_exp_f32 v113, v113
    v_mfma_f32_16x16x32_bf16 v[128:131], v[164:167], v[44:47], v[128:131]
    ds_read_b128 v[160:163], v4 offset:24576
    v_cvt_pk_bf16_f32 v144, v112, v113
    v_exp_f32 v114, v114
    v_mfma_f32_16x16x32_bf16 v[132:135], v[168:171], v[40:43], 0
    ds_read_b128 v[164:167], v5 offset:24576
    v_exp_f32 v115, v115
    v_mfma_f32_16x16x32_bf16 v[132:135], v[172:175], v[44:47], v[132:135]
    ds_read_b128 v[168:171], v4 offset:26624
    v_cvt_pk_bf16_f32 v145, v114, v115
    v_exp_f32 v116, v116
    v_mfma_f32_16x16x32_bf16 v[136:139], v[176:179], v[40:43], 0
    ds_read_b128 v[172:175], v5 offset:26624
    v_exp_f32 v117, v117
    v_mfma_f32_16x16x32_bf16 v[136:139], v[180:183], v[44:47], v[136:139]
    ds_read_b128 v[176:179], v4 offset:28672
    v_cvt_pk_bf16_f32 v146, v116, v117
    v_exp_f32 v118, v118
    v_mfma_f32_16x16x32_bf16 v[140:143], v[184:187], v[40:43], 0
    ds_read_b128 v[180:183], v5 offset:28672
    v_exp_f32 v119, v119
    v_mfma_f32_16x16x32_bf16 v[140:143], v[188:191], v[44:47], v[140:143]
    ds_read_b128 v[184:187], v4 offset:30720
    v_cvt_pk_bf16_f32 v147, v118, v119
    v_exp_f32 v120, v120
    v_mfma_f32_16x16x32_bf16 v[64:67], v[192:195], v[152:155], v[64:67]
    ds_read_b128 v[188:191], v5 offset:30720
    v_exp_f32 v121, v121
    v_mfma_f32_16x16x32_bf16 v[64:67], v[196:199], v[156:159], v[64:67]
    v_cvt_pk_bf16_f32 v148, v120, v121
    v_exp_f32 v122, v122
    v_mfma_f32_16x16x32_bf16 v[68:71], v[200:203], v[152:155], v[68:71]
    v_exp_f32 v123, v123
    v_mfma_f32_16x16x32_bf16 v[68:71], v[204:207], v[156:159], v[68:71]
    v_cvt_pk_bf16_f32 v149, v122, v123
    v_exp_f32 v124, v124
    v_mfma_f32_16x16x32_bf16 v[72:75], v[208:211], v[152:155], v[72:75]
    v_exp_f32 v125, v125
    v_mfma_f32_16x16x32_bf16 v[72:75], v[212:215], v[156:159], v[72:75]
    v_cvt_pk_bf16_f32 v150, v124, v125
    v_exp_f32 v126, v126
    v_mfma_f32_16x16x32_bf16 v[76:79], v[216:219], v[152:155], v[76:79]
    v_exp_f32 v127, v127
    v_mfma_f32_16x16x32_bf16 v[76:79], v[220:223], v[156:159], v[76:79]
    v_cvt_pk_bf16_f32 v151, v126, v127
    v_exp_f32 v128, v128
    v_mfma_f32_16x16x32_bf16 v[80:83], v[192:195], v[144:147], v[80:83]
    v_exp_f32 v129, v129
    v_mfma_f32_16x16x32_bf16 v[80:83], v[196:199], v[148:151], v[80:83]
    v_cvt_pk_bf16_f32 v152, v128, v129
    v_exp_f32 v130, v130
    v_mfma_f32_16x16x32_bf16 v[84:87], v[200:203], v[144:147], v[84:87]
    v_exp_f32 v131, v131
    v_mfma_f32_16x16x32_bf16 v[84:87], v[204:207], v[148:151], v[84:87]
    v_cvt_pk_bf16_f32 v153, v130, v131
    v_exp_f32 v132, v132
    v_mfma_f32_16x16x32_bf16 v[88:91], v[208:211], v[144:147], v[88:91]
    v_exp_f32 v133, v133
    v_mfma_f32_16x16x32_bf16 v[88:91], v[212:215], v[148:151], v[88:91]
    v_cvt_pk_bf16_f32 v154, v132, v133
    v_exp_f32 v134, v134
    v_mfma_f32_16x16x32_bf16 v[92:95], v[216:219], v[144:147], v[92:95]
    v_exp_f32 v135, v135
    v_mfma_f32_16x16x32_bf16 v[92:95], v[220:223], v[148:151], v[92:95]
    s_waitcnt lgkmcnt(0)
    v_cvt_pk_bf16_f32 v155, v134, v135
    v_exp_f32 v136, v136
    v_mfma_f32_16x16x32_bf16 v[112:115], v[160:163], v[16:19], 0
    v_exp_f32 v137, v137
    v_mfma_f32_16x16x32_bf16 v[112:115], v[164:167], v[20:23], v[112:115]
    ds_read_b32 v14, v15 offset:0
    v_cvt_pk_bf16_f32 v156, v136, v137
    v_exp_f32 v138, v138
    v_mfma_f32_16x16x32_bf16 v[116:119], v[168:171], v[16:19], 0
    v_exp_f32 v139, v139
    v_mfma_f32_16x16x32_bf16 v[116:119], v[172:175], v[20:23], v[116:119]
    v_cvt_pk_bf16_f32 v157, v138, v139
    v_exp_f32 v140, v140
    v_mfma_f32_16x16x32_bf16 v[120:123], v[176:179], v[16:19], 0
    v_exp_f32 v141, v141
    v_mfma_f32_16x16x32_bf16 v[120:123], v[180:183], v[20:23], v[120:123]
    v_cvt_pk_bf16_f32 v158, v140, v141
    v_exp_f32 v142, v142
    v_mfma_f32_16x16x32_bf16 v[124:127], v[184:187], v[16:19], 0
    v_exp_f32 v143, v143
    v_mfma_f32_16x16x32_bf16 v[124:127], v[188:191], v[20:23], v[124:127]
    v_cvt_pk_bf16_f32 v159, v142, v143
    v_exp_f32 v112, v112
    v_mfma_f32_16x16x32_bf16 v[96:99], v[192:195], v[152:155], v[96:99]
    v_exp_f32 v113, v113
    v_mfma_f32_16x16x32_bf16 v[96:99], v[196:199], v[156:159], v[96:99]
    ds_read_b64_tr_b16 v[192:193], v8 offset:24576
    v_cvt_pk_bf16_f32 v144, v112, v113
    v_exp_f32 v114, v114
    v_mfma_f32_16x16x32_bf16 v[100:103], v[200:203], v[152:155], v[100:103]
    ds_read_b64_tr_b16 v[194:195], v8 offset:26624
    v_exp_f32 v115, v115
    v_mfma_f32_16x16x32_bf16 v[100:103], v[204:207], v[156:159], v[100:103]
    ds_read_b64_tr_b16 v[196:197], v8 offset:28672
    v_cvt_pk_bf16_f32 v145, v114, v115
    v_exp_f32 v116, v116
    v_mfma_f32_16x16x32_bf16 v[104:107], v[208:211], v[152:155], v[104:107]
    ds_read_b64_tr_b16 v[198:199], v8 offset:30720
    v_exp_f32 v117, v117
    v_mfma_f32_16x16x32_bf16 v[104:107], v[212:215], v[156:159], v[104:107]
    ds_read_b64_tr_b16 v[200:201], v9 offset:24576
    v_cvt_pk_bf16_f32 v146, v116, v117
    v_exp_f32 v118, v118
    v_mfma_f32_16x16x32_bf16 v[108:111], v[216:219], v[152:155], v[108:111]
    ds_read_b64_tr_b16 v[202:203], v9 offset:26624
    v_exp_f32 v119, v119
    v_mfma_f32_16x16x32_bf16 v[108:111], v[220:223], v[156:159], v[108:111]
    ds_read_b64_tr_b16 v[204:205], v9 offset:28672
    v_cvt_pk_bf16_f32 v147, v118, v119
    v_exp_f32 v120, v120
    v_mfma_f32_16x16x32_bf16 v[128:131], v[160:163], v[24:27], 0
    ds_read_b64_tr_b16 v[206:207], v9 offset:30720
    v_exp_f32 v121, v121
    v_mfma_f32_16x16x32_bf16 v[128:131], v[164:167], v[28:31], v[128:131]
    ds_read_b64_tr_b16 v[208:209], v10 offset:24576
    v_cvt_pk_bf16_f32 v148, v120, v121
    v_exp_f32 v122, v122
    v_mfma_f32_16x16x32_bf16 v[132:135], v[168:171], v[24:27], 0
    ds_read_b64_tr_b16 v[210:211], v10 offset:26624
    v_exp_f32 v123, v123
    v_mfma_f32_16x16x32_bf16 v[132:135], v[172:175], v[28:31], v[132:135]
    ds_read_b64_tr_b16 v[212:213], v10 offset:28672
    v_cvt_pk_bf16_f32 v149, v122, v123
    v_exp_f32 v124, v124
    v_mfma_f32_16x16x32_bf16 v[136:139], v[176:179], v[24:27], 0
    ds_read_b64_tr_b16 v[214:215], v10 offset:30720
    v_exp_f32 v125, v125
    v_mfma_f32_16x16x32_bf16 v[136:139], v[180:183], v[28:31], v[136:139]
    ds_read_b64_tr_b16 v[216:217], v11 offset:24576
    v_cvt_pk_bf16_f32 v150, v124, v125
    v_exp_f32 v126, v126
    v_mfma_f32_16x16x32_bf16 v[140:143], v[184:187], v[24:27], 0
    ds_read_b64_tr_b16 v[218:219], v11 offset:26624
    v_exp_f32 v127, v127
    v_mfma_f32_16x16x32_bf16 v[140:143], v[188:191], v[28:31], v[140:143]
    ds_read_b64_tr_b16 v[220:221], v11 offset:28672
    v_cvt_pk_bf16_f32 v151, v126, v127
    v_exp_f32 v128, v128
    v_mfma_f32_16x16x32_bf16 v[112:115], v[160:163], v[32:35], 0
    ds_read_b64_tr_b16 v[222:223], v11 offset:30720
    v_exp_f32 v129, v129
    v_mfma_f32_16x16x32_bf16 v[112:115], v[164:167], v[36:39], v[112:115]
    v_cvt_pk_bf16_f32 v152, v128, v129
    v_exp_f32 v130, v130
    v_mfma_f32_16x16x32_bf16 v[116:119], v[168:171], v[32:35], 0
    v_exp_f32 v131, v131
    v_mfma_f32_16x16x32_bf16 v[116:119], v[172:175], v[36:39], v[116:119]
    s_add_u32 s41, s41, 1
    v_cvt_pk_bf16_f32 v153, v130, v131
    v_exp_f32 v132, v132
    v_mfma_f32_16x16x32_bf16 v[120:123], v[176:179], v[32:35], 0
    v_exp_f32 v133, v133
    v_mfma_f32_16x16x32_bf16 v[120:123], v[180:183], v[36:39], v[120:123]
    v_cvt_pk_bf16_f32 v154, v132, v133
    v_exp_f32 v134, v134
    v_mfma_f32_16x16x32_bf16 v[124:127], v[184:187], v[32:35], 0
    v_exp_f32 v135, v135
    v_mfma_f32_16x16x32_bf16 v[124:127], v[188:191], v[36:39], v[124:127]
    s_waitcnt lgkmcnt(4)
    v_cvt_pk_bf16_f32 v155, v134, v135
    v_exp_f32 v136, v136
    v_mfma_f32_16x16x32_bf16 v[48:51], v[192:195], v[144:147], v[48:51]
    v_exp_f32 v137, v137
    v_mfma_f32_16x16x32_bf16 v[48:51], v[196:199], v[148:151], v[48:51]
    v_readfirstlane_b32 s40, v14
    v_cvt_pk_bf16_f32 v156, v136, v137
    v_exp_f32 v138, v138
    v_mfma_f32_16x16x32_bf16 v[52:55], v[200:203], v[144:147], v[52:55]
    v_add_u32 v12, 1, v12
    v_exp_f32 v139, v139
    v_mfma_f32_16x16x32_bf16 v[52:55], v[204:207], v[148:151], v[52:55]
    v_cvt_pk_bf16_f32 v157, v138, v139
    v_exp_f32 v140, v140
    v_mfma_f32_16x16x32_bf16 v[56:59], v[208:211], v[144:147], v[56:59]
    s_waitcnt lgkmcnt(0)
    v_exp_f32 v141, v141
    v_mfma_f32_16x16x32_bf16 v[56:59], v[212:215], v[148:151], v[56:59]
    ds_write_b32 v13, v12
    v_cvt_pk_bf16_f32 v158, v140, v141
    v_exp_f32 v142, v142
    v_mfma_f32_16x16x32_bf16 v[60:63], v[216:219], v[144:147], v[60:63]
    v_exp_f32 v143, v143
    v_mfma_f32_16x16x32_bf16 v[60:63], v[220:223], v[148:151], v[60:63]
    s_cmp_gt_u32 s40, s41
    v_cvt_pk_bf16_f32 v159, v142, v143
    v_exp_f32 v112, v112
    v_mfma_f32_16x16x32_bf16 v[128:131], v[160:163], v[40:43], 0
    s_cbranch_scc0 F_POLL3
F_BACK3:
    v_exp_f32 v113, v113
    v_mfma_f32_16x16x32_bf16 v[128:131], v[164:167], v[44:47], v[128:131]
    ds_read_b128 v[160:163], v4 offset:32768
    v_cvt_pk_bf16_f32 v144, v112, v113
    v_exp_f32 v114, v114
    v_mfma_f32_16x16x32_bf16 v[132:135], v[168:171], v[40:43], 0
    ds_read_b128 v[164:167], v5 offset:32768
    v_exp_f32 v115, v115
    v_mfma_f32_16x16x32_bf16 v[132:135], v[172:175], v[44:47], v[132:135]
    ds_read_b128 v[168:171], v4 offset:34816
    v_cvt_pk_bf16_f32 v145, v114, v115
    v_exp_f32 v116, v116
    v_mfma_f32_16x16x32_bf16 v[136:139], v[176:179], v[40:43], 0
    ds_read_b128 v[172:175], v5 offset:34816
    v_exp_f32 v117, v117
    v_mfma_f32_16x16x32_bf16 v[136:139], v[180:183], v[44:47], v[136:139]
    ds_read_b128 v[176:179], v4 offset:36864
    v_cvt_pk_bf16_f32 v146, v116, v117
    v_exp_f32 v118, v118
    v_mfma_f32_16x16x32_bf16 v[140:143], v[184:187], v[40:43], 0
    ds_read_b128 v[180:183], v5 offset:36864
    v_exp_f32 v119, v119
    v_mfma_f32_16x16x32_bf16 v[140:143], v[188:191], v[44:47], v[140:143]
    ds_read_b128 v[184:187], v4 offset:38912
    v_cvt_pk_bf16_f32 v147, v118, v119
    v_exp_f32 v120, v120
    v_mfma_f32_16x16x32_bf16 v[64:67], v[192:195], v[152:155], v[64:67]
    ds_read_b128 v[188:191], v5 offset:38912
    v_exp_f32 v121, v121
    v_mfma_f32_16x16x32_bf16 v[64:67], v[196:199], v[156:159], v[64:67]
    v_cvt_pk_bf16_f32 v148, v120, v121
    v_exp_f32 v122, v122
    v_mfma_f32_16x16x32_bf16 v[68:71], v[200:203], v[152:155], v[68:71]
    v_exp_f32 v123, v123
    v_mfma_f32_16x16x32_bf16 v[68:71], v[204:207], v[156:159], v[68:71]
    v_cvt_pk_bf16_f32 v149, v122, v123
    v_exp_f32 v124, v124
    v_mfma_f32_16x16x32_bf16 v[72:75], v[208:211], v[152:155], v[72:75]
    v_exp_f32 v125, v125
    v_mfma_f32_16x16x32_bf16 v[72:75], v[212:215], v[156:159], v[72:75]
    v_cvt_pk_bf16_f32 v150, v124, v125
    v_exp_f32 v126, v126
    v_mfma_f32_16x16x32_bf16 v[76:79], v[216:219], v[152:155], v[76:79]
    v_exp_f32 v127, v127
    v_mfma_f32_16x16x32_bf16 v[76:79], v[220:223], v[156:159], v[76:79]
    v_cvt_pk_bf16_f32 v151, v126, v127
    v_exp_f32 v128, v128
    v_mfma_f32_16x16x32_bf16 v[80:83], v[192:195], v[144:147], v[80:83]
    v_exp_f32 v129, v129
    v_mfma_f32_16x16x32_bf16 v[80:83], v[196:199], v[148:151], v[80:83]
    v_cvt_pk_bf16_f32 v152, v128, v129
    v_exp_f32 v130, v130
    v_mfma_f32_16x16x32_bf16 v[84:87], v[200:203], v[144:147], v[84:87]
    v_exp_f32 v131, v131
    v_mfma_f32_16x16x32_bf16 v[84:87], v[204:207], v[148:151], v[84:87]
    v_cvt_pk_bf16_f32 v153, v130, v131
    v_exp_f32 v132, v132
    v_mfma_f32_16x16x32_bf16 v[88:91], v[208:211], v[144:147], v[88:91]
    v_exp_f32 v133, v133
    v_mfma_f32_16x16x32_bf16 v[88:91], v[212:215], v[148:151], v[88:91]
    v_cvt_pk_bf16_f32 v154, v132, v133
    v_exp_f32 v134, v134
    v_mfma_f32_16x16x32_bf16 v[92:95], v[216:219], v[144:147], v[92:95]
    v_exp_f32 v135, v135
    v_mfma_f32_16x16x32_bf16 v[92:95], v[220:223], v[148:151], v[92:95]
    s_waitcnt lgkmcnt(0)
    v_cvt_pk_bf16_f32 v155, v134, v135
    v_exp_f32 v136, v136
    v_mfma_f32_16x16x32_bf16 v[112:115], v[160:163], v[16:19], 0
    v_exp_f32 v137, v137
    v_mfma_f32_16x16x32_bf16 v[112:115], v[164:167], v[20:23], v[112:115]
    v_cvt_pk_bf16_f32 v156, v136, v137
    v_exp_f32 v138, v138
    v_mfma_f32_16x16x32_bf16 v[116:119], v[168:171], v[16:19], 0
    v_exp_f32 v139, v139
    v_mfma_f32_16x16x32_bf16 v[116:119], v[172:175], v[20:23], v[116:119]
    v_cvt_pk_bf16_f32 v157, v138, v139
    v_exp_f32 v140, v140
    v_mfma_f32_16x16x32_bf16 v[120:123], v[176:179], v[16:19], 0
    v_exp_f32 v141, v141
    v_mfma_f32_16x16x32_bf16 v[120:123], v[180:183], v[20:23], v[120:123]
    v_cvt_pk_bf16_f32 v158, v140, v141
    v_exp_f32 v142, v142
    v_mfma_f32_16x16x32_bf16 v[124:127], v[184:187], v[16:19], 0
    v_exp_f32 v143, v143
    v_mfma_f32_16x16x32_bf16 v[124:127], v[188:191], v[20:23], v[124:127]
    v_cvt_pk_bf16_f32 v159, v142, v143
    v_exp_f32 v112, v112
    v_mfma_f32_16x16x32_bf16 v[96:99], v[192:195], v[152:155], v[96:99]
    v_exp_f32 v113, v113
    v_mfma_f32_16x16x32_bf16 v[96:99], v[196:199], v[156:159], v[96:99]
    ds_read_b64_tr_b16 v[192:193], v8 offset:32768
    v_cvt_pk_bf16_f32 v144, v112, v113
    v_exp_f32 v114, v114
    v_mfma_f32_16x16x32_bf16 v[100:103], v[200:203], v[152:155], v[100:103]
    ds_read_b64_tr_b16 v[194:195], v8 offset:34816
    v_exp_f32 v115, v115
    v_mfma_f32_16x16x32_bf16 v[100:103], v[204:207], v[156:159], v[100:103]
    ds_read_b64_tr_b16 v[196:197], v8 offset:36864
    v_cvt_pk_bf16_f32 v145, v114, v115
    v_exp_f32 v116, v116
    v_mfma_f32_16x16x32_bf16 v[104:107], v[208:211], v[152:155], v[104:107]
    ds_read_b64_tr_b16 v[198:199], v8 offset:38912
    v_exp_f32 v117, v117
    v_mfma_f32_16x16x32_bf16 v[104:107], v[212:215], v[156:159], v[104:107]
    ds_read_b64_tr_b16 v[200:201], v9 offset:32768
    v_cvt_pk_bf16_f32 v146, v116, v117
    v_exp_f32 v118, v118
    v_mfma_f32_16x16x32_bf16 v[108:111], v[216:219], v[152:155], v[108:111]
    ds_read_b64_tr_b16 v[202:203], v9 offset:34816
    v_exp_f32 v119, v119
    v_mfma_f32_16x16x32_bf16 v[108:111], v[220:223], v[156:159], v[108:111]
    ds_read_b64_tr_b16 v[204:205], v9 offset:36864
    v_cvt_pk_bf16_f32 v147, v118, v119
    v_exp_f32 v120, v120
    v_mfma_f32_16x16x32_bf16 v[128:131], v[160:163], v[24:27], 0
    ds_read_b64_tr_b16 v[206:207], v9 offset:38912
    v_exp_f32 v121, v121
    v_mfma_f32_16x16x32_bf16 v[128:131], v[164:167], v[28:31], v[128:131]
    ds_read_b64_tr_b16 v[208:209], v10 offset:32768
    v_cvt_pk_bf16_f32 v148, v120, v121
    v_exp_f32 v122, v122
    v_mfma_f32_16x16x32_bf16 v[132:135], v[168:171], v[24:27], 0
    ds_read_b64_tr_b16 v[210:211], v10 offset:34816
    v_exp_f32 v123, v123
    v_mfma_f32_16x16x32_bf16 v[132:135], v[172:175], v[28:31], v[132:135]
    ds_read_b64_tr_b16 v[212:213], v10 offset:36864
    v_cvt_pk_bf16_f32 v149, v122, v123
    v_exp_f32 v124, v124
    v_mfma_f32_16x16x32_bf16 v[136:139], v[176:179], v[24:27], 0
    ds_read_b64_tr_b16 v[214:215], v10 offset:38912
    v_exp_f32 v125, v125
    v_mfma_f32_16x16x32_bf16 v[136:139], v[180:183], v[28:31], v[136:139]
    ds_read_b64_tr_b16 v[216:217], v11 offset:32768
    v_cvt_pk_bf16_f32 v150, v124, v125
    v_exp_f32 v126, v126
    v_mfma_f32_16x16x32_bf16 v[140:143], v[184:187], v[24:27], 0
    ds_read_b64_tr_b16 v[218:219], v11 offset:34816
    v_exp_f32 v127, v127
    v_mfma_f32_16x16x32_bf16 v[140:143], v[188:191], v[28:31], v[140:143]
    ds_read_b64_tr_b16 v[220:221], v11 offset:36864
    v_cvt_pk_bf16_f32 v151, v126, v127
    v_exp_f32 v128, v128
    v_mfma_f32_16x16x32_bf16 v[112:115], v[160:163], v[32:35], 0
    ds_read_b64_tr_b16 v[222:223], v11 offset:38912
    v_exp_f32 v129, v129
    v_mfma_f32_16x16x32_bf16 v[112:115], v[164:167], v[36:39], v[112:115]
    v_cvt_pk_bf16_f32 v152, v128, v129
    v_exp_f32 v130, v130
    v_mfma_f32_16x16x32_bf16 v[116:119], v[168:171], v[32:35], 0
    v_exp_f32 v131, v131
    v_mfma_f32_16x16x32_bf16 v[116:119], v[172:175], v[36:39], v[116:119]
    v_cvt_pk_bf16_f32 v153, v130, v131
    v_exp_f32 v132, v132
    v_mfma_f32_16x16x32_bf16 v[120:123], v[176:179], v[32:35], 0
    v_exp_f32 v133, v133
    v_mfma_f32_16x16x32_bf16 v[120:123], v[180:183], v[36:39], v[120:123]
    v_cvt_pk_bf16_f32 v154, v132, v133
    v_exp_f32 v134, v134
    v_mfma_f32_16x16x32_bf16 v[124:127], v[184:187], v[32:35], 0
    v_exp_f32 v135, v135
    v_mfma_f32_16x16x32_bf16 v[124:127], v[188:191], v[36:39], v[124:127]
    s_waitcnt lgkmcnt(4)
    v_cvt_pk_bf16_f32 v155, v134, v135
    v_exp_f32 v136, v136
    v_mfma_f32_16x16x32_bf16 v[48:51], v[192:195], v[144:147], v[48:51]
    v_exp_f32 v137, v137
    v_mfma_f32_16x16x32_bf16 v[48:51], v[196:199], v[148:151], v[48:51]
    v_cvt_pk_bf16_f32 v156, v136, v137
    v_exp_f32 v138, v138
    v_mfma_f32_16x16x32_bf16 v[52:55], v[200:203], v[144:147], v[52:55]
    v_exp_f32 v139, v139
    v_mfma_f32_16x16x32_bf16 v[52:55], v[204:207], v[148:151], v[52:55]
    v_cvt_pk_bf16_f32 v157, v138, v139
    v_exp_f32 v140, v140
    v_mfma_f32_16x16x32_bf16 v[56:59], v[208:211], v[144:147], v[56:59]
    s_waitcnt lgkmcnt(0)
    v_exp_f32 v141, v141
    v_mfma_f32_16x16x32_bf16 v[56:59], v[212:215], v[148:151], v[56:59]
    v_cvt_pk_bf16_f32 v158, v140, v141
    v_exp_f32 v142, v142
    v_mfma_f32_16x16x32_bf16 v[60:63], v[216:219], v[144:147], v[60:63]
    v_exp_f32 v143, v143
    v_mfma_f32_16x16x32_bf16 v[60:63], v[220:223], v[148:151], v[60:63]
    v_cvt_pk_bf16_f32 v159, v142, v143
    v_exp_f32 v112, v112
    v_mfma_f32_16x16x32_bf16 v[128:131], v[160:163], v[40:43], 0
    v_exp_f32 v113, v113
    v_mfma_f32_16x16x32_bf16 v[128:131], v[164:167], v[44:47], v[128:131]
    ds_read_b128 v[160:163], v4 offset:40960
    v_cvt_pk_bf16_f32 v144, v112, v113
    v_exp_f32 v114, v114
    v_mfma_f32_16x16x32_bf16 v[132:135], v[168:171], v[40:43], 0
    ds_read_b128 v[164:167], v5 offset:40960
    v_exp_f32 v115, v115
    v_mfma_f32_16x16x32_bf16 v[132:135], v[172:175], v[44:47], v[132:135]
    ds_read_b128 v[168:171], v4 offset:43008
    v_cvt_pk_bf16_f32 v145, v114, v115
    v_exp_f32 v116, v116
    v_mfma_f32_16x16x32_bf16 v[136:139], v[176:179], v[40:43], 0
    ds_read_b128 v[172:175], v5 offset:43008
    v_exp_f32 v117, v117
    v_mfma_f32_16x16x32_bf16 v[136:139], v[180:183], v[44:47], v[136:139]
    ds_read_b128 v[176:179], v4 offset:45056
    v_cvt_pk_bf16_f32 v146, v116, v117
    v_exp_f32 v118, v118
    v_mfma_f32_16x16x32_bf16 v[140:143], v[184:187], v[40:43], 0
    ds_read_b128 v[180:183], v5 offset:45056
    v_exp_f32 v119, v119
    v_mfma_f32_16x16x32_bf16 v[140:143], v[188:191], v[44:47], v[140:143]
    ds_read_b128 v[184:187], v4 offset:47104
    v_cvt_pk_bf16_f32 v147, v118, v119
    v_exp_f32 v120, v120
    v_mfma_f32_16x16x32_bf16 v[64:67], v[192:195], v[152:155], v[64:67]
    ds_read_b128 v[188:191], v5 offset:47104
    v_exp_f32 v121, v121
    v_mfma_f32_16x16x32_bf16 v[64:67], v[196:199], v[156:159], v[64:67]
    v_cvt_pk_bf16_f32 v148, v120, v121
    v_exp_f32 v122, v122
    v_mfma_f32_16x16x32_bf16 v[68:71], v[200:203], v[152:155], v[68:71]
    s_cmp_eq_u32 s42, s53
    v_exp_f32 v123, v123
    v_mfma_f32_16x16x32_bf16 v[68:71], v[204:207], v[156:159], v[68:71]
    s_cbranch_scc1 F_QST
F_QSB:
    v_cvt_pk_bf16_f32 v149, v122, v123
    v_exp_f32 v124, v124
    v_mfma_f32_16x16x32_bf16 v[72:75], v[208:211], v[152:155], v[72:75]
    v_exp_f32 v125, v125
    v_mfma_f32_16x16x32_bf16 v[72:75], v[212:215], v[156:159], v[72:75]
    v_cvt_pk_bf16_f32 v150, v124, v125
    v_exp_f32 v126, v126
    v_mfma_f32_16x16x32_bf16 v[76:79], v[216:219], v[152:155], v[76:79]
    v_exp_f32 v127, v127
    v_mfma_f32_16x16x32_bf16 v[76:79], v[220:223], v[156:159], v[76:79]
    v_cvt_pk_bf16_f32 v151, v126, v127
    v_exp_f32 v128, v128
    v_mfma_f32_16x16x32_bf16 v[80:83], v[192:195], v[144:147], v[80:83]
    v_exp_f32 v129, v129
    v_mfma_f32_16x16x32_bf16 v[80:83], v[196:199], v[148:151], v[80:83]
    v_cvt_pk_bf16_f32 v152, v128, v129
    v_exp_f32 v130, v130
    v_mfma_f32_16x16x32_bf16 v[84:87], v[200:203], v[144:147], v[84:87]
    v_exp_f32 v131, v131
    v_mfma_f32_16x16x32_bf16 v[84:87], v[204:207], v[148:151], v[84:87]
    v_cvt_pk_bf16_f32 v153, v130, v131
    v_exp_f32 v132, v132
    v_mfma_f32_16x16x32_bf16 v[88:91], v[208:211], v[144:147], v[88:91]
    v_exp_f32 v133, v133
    v_mfma_f32_16x16x32_bf16 v[88:91], v[212:215], v[148:151], v[88:91]
    v_cvt_pk_bf16_f32 v154, v132, v133
    v_exp_f32 v134, v134
    v_mfma_f32_16x16x32_bf16 v[92:95], v[216:219], v[144:147], v[92:95]
    v_exp_f32 v135, v135
    v_mfma_f32_16x16x32_bf16 v[92:95], v[220:223], v[148:151], v[92:95]
    s_waitcnt lgkmcnt(0)
    v_cvt_pk_bf16_f32 v155, v134, v135
    v_exp_f32 v136, v136
    v_mfma_f32_16x16x32_bf16 v[112:115], v[160:163], v[16:19], 0
    v_exp_f32 v137, v137
    v_mfma_f32_16x16x32_bf16 v[112:115], v[164:167], v[20:23], v[112:115]
    ds_read_b32 v14, v15 offset:0
    v_cvt_pk_bf16_f32 v156, v136, v137
    v_exp_f32 v138, v138
    v_mfma_f32_16x16x32_bf16 v[116:119], v[168:171], v[16:19], 0
    v_exp_f32 v139, v139
    v_mfma_f32_16x16x32_bf16 v[116:119], v[172:175], v[20:23], v[116:119]
    v_cvt_pk_bf16_f32 v157, v138, v139
    v_exp_f32 v140, v140
    v_mfma_f32_16x16x32_bf16 v[120:123], v[176:179], v[16:19], 0
    v_exp_f32 v141, v141
    v_mfma_f32_16x16x32_bf16 v[120:123], v[180:183], v[20:23], v[120:123]
    v_cvt_pk_bf16_f32 v158, v140, v141
    v_exp_f32 v142, v142
    v_mfma_f32_16x16x32_bf16 v[124:127], v[184:187], v[16:19], 0
    v_exp_f32 v143, v143
    v_mfma_f32_16x16x32_bf16 v[124:127], v[188:191], v[20:23], v[124:127]
    v_cvt_pk_bf16_f32 v159, v142, v143
    v_exp_f32 v112, v112
    v_mfma_f32_16x16x32_bf16 v[96:99], v[192:195], v[152:155], v[96:99]
    v_exp_f32 v113, v113
    v_mfma_f32_16x16x32_bf16 v[96:99], v[196:199], v[156:159], v[96:99]
    ds_read_b64_tr_b16 v[192:193], v8 offset:40960
    v_cvt_pk_bf16_f32 v144, v112, v113
    v_exp_f32 v114, v114
    v_mfma_f32_16x16x32_bf16 v[100:103], v[200:203], v[152:155], v[100:103]
    ds_read_b64_tr_b16 v[194:195], v8 offset:43008
    v_exp_f32 v115, v115
    v_mfma_f32_16x16x32_bf16 v[100:103], v[204:207], v[156:159], v[100:103]
    ds_read_b64_tr_b16 v[196:197], v8 offset:45056
    v_cvt_pk_bf16_f32 v145, v114, v115
    v_exp_f32 v116, v116
    v_mfma_f32_16x16x32_bf16 v[104:107], v[208:211], v[152:155], v[104:107]
    ds_read_b64_tr_b16 v[198:199], v8 offset:47104
    v_exp_f32 v117, v117
    v_mfma_f32_16x16x32_bf16 v[104:107], v[212:215], v[156:159], v[104:107]
    ds_read_b64_tr_b16 v[200:201], v9 offset:40960
    v_cvt_pk_bf16_f32 v146, v116, v117
    v_exp_f32 v118, v118
    v_mfma_f32_16x16x32_bf16 v[108:111], v[216:219], v[152:155], v[108:111]
    ds_read_b64_tr_b16 v[202:203], v9 offset:43008
    v_exp_f32 v119, v119
    v_mfma_f32_16x16x32_bf16 v[108:111], v[220:223], v[156:159], v[108:111]
    ds_read_b64_tr_b16 v[204:205], v9 offset:45056
    v_cvt_pk_bf16_f32 v147, v118, v119
    v_exp_f32 v120, v120
    v_mfma_f32_16x16x32_bf16 v[128:131], v[160:163], v[24:27], 0
    ds_read_b64_tr_b16 v[206:207], v9 offset:47104
    v_exp_f32 v121, v121
    v_mfma_f32_16x16x32_bf16 v[128:131], v[164:167], v[28:31], v[128:131]
    ds_read_b64_tr_b16 v[208:209], v10 offset:40960
    v_cvt_pk_bf16_f32 v148, v120, v121
    v_exp_f32 v122, v122
    v_mfma_f32_16x16x32_bf16 v[132:135], v[168:171], v[24:27], 0
    ds_read_b64_tr_b16 v[210:211], v10 offset:43008
    v_exp_f32 v123, v123
    v_mfma_f32_16x16x32_bf16 v[132:135], v[172:175], v[28:31], v[132:135]
    ds_read_b64_tr_b16 v[212:213], v10 offset:45056
    v_cvt_pk_bf16_f32 v149, v122, v123
    v_exp_f32 v124, v124
    v_mfma_f32_16x16x32_bf16 v[136:139], v[176:179], v[24:27], 0
    ds_read_b64_tr_b16 v[214:215], v10 offset:47104
    v_exp_f32 v125, v125
    v_mfma_f32_16x16x32_bf16 v[136:139], v[180:183], v[28:31], v[136:139]
    ds_read_b64_tr_b16 v[216:217], v11 offset:40960
    v_cvt_pk_bf16_f32 v150, v124, v125
    v_exp_f32 v126, v126
    v_mfma_f32_16x16x32_bf16 v[140:143], v[184:187], v[24:27], 0
    ds_read_b64_tr_b16 v[218:219], v11 offset:43008
    v_exp_f32 v127, v127
    v_mfma_f32_16x16x32_bf16 v[140:143], v[188:191], v[28:31], v[140:143]
    ds_read_b64_tr_b16 v[220:221], v11 offset:45056
    v_cvt_pk_bf16_f32 v151, v126, v127
    v_exp_f32 v128, v128
    v_mfma_f32_16x16x32_bf16 v[112:115], v[160:163], v[32:35], 0
    ds_read_b64_tr_b16 v[222:223], v11 offset:47104
    v_exp_f32 v129, v129
    v_mfma_f32_16x16x32_bf16 v[112:115], v[164:167], v[36:39], v[112:115]
    v_cvt_pk_bf16_f32 v152, v128, v129
    v_exp_f32 v130, v130
    v_mfma_f32_16x16x32_bf16 v[116:119], v[168:171], v[32:35], 0
    v_exp_f32 v131, v131
    v_mfma_f32_16x16x32_bf16 v[116:119], v[172:175], v[36:39], v[116:119]
    s_add_u32 s41, s41, 1
    v_cvt_pk_bf16_f32 v153, v130, v131
    v_exp_f32 v132, v132
    v_mfma_f32_16x16x32_bf16 v[120:123], v[176:179], v[32:35], 0
    v_exp_f32 v133, v133
    v_mfma_f32_16x16x32_bf16 v[120:123], v[180:183], v[36:39], v[120:123]
    v_cvt_pk_bf16_f32 v154, v132, v133
    v_exp_f32 v134, v134
    v_mfma_f32_16x16x32_bf16 v[124:127], v[184:187], v[32:35], 0
    v_exp_f32 v135, v135
    v_mfma_f32_16x16x32_bf16 v[124:127], v[188:191], v[36:39], v[124:127]
    s_waitcnt lgkmcnt(4)
    v_cvt_pk_bf16_f32 v155, v134, v135
    v_exp_f32 v136, v136
    v_mfma_f32_16x16x32_bf16 v[48:51], v[192:195], v[144:147], v[48:51]
    v_exp_f32 v137, v137
    v_mfma_f32_16x16x32_bf16 v[48:51], v[196:199], v[148:151], v[48:51]
    v_readfirstlane_b32 s40, v14
    v_cvt_pk_bf16_f32 v156, v136, v137
    v_exp_f32 v138, v138
    v_mfma_f32_16x16x32_bf16 v[52:55], v[200:203], v[144:147], v[52:55]
    v_add_u32 v12, 1, v12
    v_exp_f32 v139, v139
    v_mfma_f32_16x16x32_bf16 v[52:55], v[204:207], v[148:151], v[52:55]
    v_cvt_pk_bf16_f32 v157, v138, v139
    v_exp_f32 v140, v140
    v_mfma_f32_16x16x32_bf16 v[56:59], v[208:211], v[144:147], v[56:59]
    s_waitcnt lgkmcnt(0)
    v_exp_f32 v141, v141
    v_mfma_f32_16x16x32_bf16 v[56:59], v[212:215], v[148:151], v[56:59]
    ds_write_b32 v13, v12
    v_cvt_pk_bf16_f32 v158, v140, v141
    v_exp_f32 v142, v142
    v_mfma_f32_16x16x32_bf16 v[60:63], v[216:219], v[144:147], v[60:63]
    v_exp_f32 v143, v143
    v_mfma_f32_16x16x32_bf16 v[60:63], v[220:223], v[148:151], v[60:63]
    s_cmp_gt_u32 s40, s41
    v_cvt_pk_bf16_f32 v159, v142, v143
    v_exp_f32 v112, v112
    v_mfma_f32_16x16x32_bf16 v[128:131], v[160:163], v[40:43], 0
    s_cbranch_scc0 F_POLL5
F_BACK5:
    v_exp_f32 v113, v113
    v_mfma_f32_16x16x32_bf16 v[128:131], v[164:167], v[44:47], v[128:131]
    ds_read_b128 v[160:163], v4 offset:49152
    v_cvt_pk_bf16_f32 v144, v112, v113
    v_exp_f32 v114, v114
    v_mfma_f32_16x16x32_bf16 v[132:135], v[168:171], v[40:43], 0
    ds_read_b128 v[164:167], v5 offset:49152
    v_exp_f32 v115, v115
    v_mfma_f32_16x16x32_bf16 v[132:135], v[172:175], v[44:47], v[132:135]
    ds_read_b128 v[168:171], v4 offset:51200
    v_cvt_pk_bf16_f32 v145, v114, v115
    v_exp_f32 v116, v116
    v_mfma_f32_16x16x32_bf16 v[136:139], v[176:179], v[40:43], 0
    ds_read_b128 v[172:175], v5 offset:51200
    v_exp_f32 v117, v117
    v_mfma_f32_16x16x32_bf16 v[136:139], v[180:183], v[44:47], v[136:139]
    ds_read_b128 v[176:179], v4 offset:53248
    v_cvt_pk_bf16_f32 v146, v116, v117
    v_exp_f32 v118, v118
    v_mfma_f32_16x16x32_bf16 v[140:143], v[184:187], v[40:43], 0
    ds_read_b128 v[180:183], v5 offset:53248
    v_exp_f32 v119, v119
    v_mfma_f32_16x16x32_bf16 v[140:143], v[188:191], v[44:47], v[140:143]
    ds_read_b128 v[184:187], v4 offset:55296
    v_cvt_pk_bf16_f32 v147, v118, v119
    v_exp_f32 v120, v120
    v_mfma_f32_16x16x32_bf16 v[64:67], v[192:195], v[152:155], v[64:67]
    ds_read_b128 v[188:191], v5 offset:55296
    v_exp_f32 v121, v121
    v_mfma_f32_16x16x32_bf16 v[64:67], v[196:199], v[156:159], v[64:67]
    v_cvt_pk_bf16_f32 v148, v120, v121
    v_exp_f32 v122, v122
    v_mfma_f32_16x16x32_bf16 v[68:71], v[200:203], v[152:155], v[68:71]
    v_exp_f32 v123, v123
    v_mfma_f32_16x16x32_bf16 v[68:71], v[204:207], v[156:159], v[68:71]
    v_cvt_pk_bf16_f32 v149, v122, v123
    v_exp_f32 v124, v124
    v_mfma_f32_16x16x32_bf16 v[72:75], v[208:211], v[152:155], v[72:75]
    v_exp_f32 v125, v125
    v_mfma_f32_16x16x32_bf16 v[72:75], v[212:215], v[156:159], v[72:75]
    v_cvt_pk_bf16_f32 v150, v124, v125
    v_exp_f32 v126, v126
    v_mfma_f32_16x16x32_bf16 v[76:79], v[216:219], v[152:155], v[76:79]
    v_exp_f32 v127, v127
    v_mfma_f32_16x16x32_bf16 v[76:79], v[220:223], v[156:159], v[76:79]
    v_cvt_pk_bf16_f32 v151, v126, v127
    v_exp_f32 v128, v128
    v_mfma_f32_16x16x32_bf16 v[80:83], v[192:195], v[144:147], v[80:83]
    v_exp_f32 v129, v129
    v_mfma_f32_16x16x32_bf16 v[80:83], v[196:199], v[148:151], v[80:83]
    v_cvt_pk_bf16_f32 v152, v128, v129
    v_exp_f32 v130, v130
    v_mfma_f32_16x16x32_bf16 v[84:87], v[200:203], v[144:147], v[84:87]
    v_exp_f32 v131, v131
    v_mfma_f32_16x16x32_bf16 v[84:87], v[204:207], v[148:151], v[84:87]
    v_cvt_pk_bf16_f32 v153, v130, v131
    v_exp_f32 v132, v132
    v_mfma_f32_16x16x32_bf16 v[88:91], v[208:211], v[144:147], v[88:91]
    v_exp_f32 v133, v133
    v_mfma_f32_16x16x32_bf16 v[88:91], v[212:215], v[148:151], v[88:91]
    v_cvt_pk_bf16_f32 v154, v132, v133
    v_exp_f32 v134, v134
    v_mfma_f32_16x16x32_bf16 v[92:95], v[216:219], v[144:147], v[92:95]
    v_exp_f32 v135, v135
    v_mfma_f32_16x16x32_bf16 v[92:95], v[220:223], v[148:151], v[92:95]
    s_waitcnt lgkmcnt(0)
    v_cvt_pk_bf16_f32 v155, v134, v135
    v_exp_f32 v136, v136
    v_mfma_f32_16x16x32_bf16 v[112:115], v[160:163], v[16:19], 0
    v_exp_f32 v137, v137
    v_mfma_f32_16x16x32_bf16 v[112:115], v[164:167], v[20:23], v[112:115]
    v_cvt_pk_bf16_f32 v156, v136, v137
    v_exp_f32 v138, v138
    v_mfma_f32_16x16x32_bf16 v[116:119], v[168:171], v[16:19], 0
    v_exp_f32 v139, v139
    v_mfma_f32_16x16x32_bf16 v[116:119], v[172:175], v[20:23], v[116:119]
    v_cvt_pk_bf16_f32 v157, v138, v139
    v_exp_f32 v140, v140
    v_mfma_f32_16x16x32_bf16 v[120:123], v[176:179], v[16:19], 0
    v_exp_f32 v141, v141
    v_mfma_f32_16x16x32_bf16 v[120:123], v[180:183], v[20:23], v[120:123]
    v_cvt_pk_bf16_f32 v158, v140, v141
    v_exp_f32 v142, v142
    v_mfma_f32_16x16x32_bf16 v[124:127], v[184:187], v[16:19], 0
    v_exp_f32 v143, v143
    v_mfma_f32_16x16x32_bf16 v[124:127], v[188:191], v[20:23], v[124:127]
    v_cvt_pk_bf16_f32 v159, v142, v143
    v_exp_f32 v112, v112
    v_mfma_f32_16x16x32_bf16 v[96:99], v[192:195], v[152:155], v[96:99]
    v_exp_f32 v113, v113
    v_mfma_f32_16x16x32_bf16 v[96:99], v[196:199], v[156:159], v[96:99]
    ds_read_b64_tr_b16 v[192:193], v8 offset:49152
    v_cvt_pk_bf16_f32 v144, v112, v113
    v_exp_f32 v114, v114
    v_mfma_f32_16x16x32_bf16 v[100:103], v[200:203], v[152:155], v[100:103]
    ds_read_b64_tr_b16 v[194:195], v8 offset:51200
    v_exp_f32 v115, v115
    v_mfma_f32_16x16x32_bf16 v[100:103], v[204:207], v[156:159], v[100:103]
    ds_read_b64_tr_b16 v[196:197], v8 offset:53248
    v_cvt_pk_bf16_f32 v145, v114, v115
    v_exp_f32 v116, v116
    v_mfma_f32_16x16x32_bf16 v[104:107], v[208:211], v[152:155], v[104:107]
    ds_read_b64_tr_b16 v[198:199], v8 offset:55296
    v_exp_f32 v117, v117
    v_mfma_f32_16x16x32_bf16 v[104:107], v[212:215], v[156:159], v[104:107]
    ds_read_b64_tr_b16 v[200:201], v9 offset:49152
    v_cvt_pk_bf16_f32 v146, v116, v117
    v_exp_f32 v118, v118
    v_mfma_f32_16x16x32_bf16 v[108:111], v[216:219], v[152:155], v[108:111]
    ds_read_b64_tr_b16 v[202:203], v9 offset:51200
    v_exp_f32 v119, v119
    v_mfma_f32_16x16x32_bf16 v[108:111], v[220:223], v[156:159], v[108:111]
    ds_read_b64_tr_b16 v[204:205], v9 offset:53248
    v_cvt_pk_bf16_f32 v147, v118, v119
    v_exp_f32 v120, v120
    v_mfma_f32_16x16x32_bf16 v[128:131], v[160:163], v[24:27], 0
    ds_read_b64_tr_b16 v[206:207], v9 offset:55296
    v_exp_f32 v121, v121
    v_mfma_f32_16x16x32_bf16 v[128:131], v[164:167], v[28:31], v[128:131]
    ds_read_b64_tr_b16 v[208:209], v10 offset:49152
    v_cvt_pk_bf16_f32 v148, v120, v121
    v_exp_f32 v122, v122
    v_mfma_f32_16x16x32_bf16 v[132:135], v[168:171], v[24:27], 0
    ds_read_b64_tr_b16 v[210:211], v10 offset:51200
    v_exp_f32 v123, v123
    v_mfma_f32_16x16x32_bf16 v[132:135], v[172:175], v[28:31], v[132:135]
    ds_read_b64_tr_b16 v[212:213], v10 offset:53248
    v_cvt_pk_bf16_f32 v149, v122, v123
    v_exp_f32 v124, v124
    v_mfma_f32_16x16x32_bf16 v[136:139], v[176:179], v[24:27], 0
    ds_read_b64_tr_b16 v[214:215], v10 offset:55296
    v_exp_f32 v125, v125
    v_mfma_f32_16x16x32_bf16 v[136:139], v[180:183], v[28:31], v[136:139]
    ds_read_b64_tr_b16 v[216:217], v11 offset:49152
    v_cvt_pk_bf16_f32 v150, v124, v125
    v_exp_f32 v126, v126
    v_mfma_f32_16x16x32_bf16 v[140:143], v[184:187], v[24:27], 0
    ds_read_b64_tr_b16 v[218:219], v11 offset:51200
    v_exp_f32 v127, v127
    v_mfma_f32_16x16x32_bf16 v[140:143], v[188:191], v[28:31], v[140:143]
    ds_read_b64_tr_b16 v[220:221], v11 offset:53248
    v_cvt_pk_bf16_f32 v151, v126, v127
    v_exp_f32 v128, v128
    v_mfma_f32_16x16x32_bf16 v[112:115], v[160:163], v[32:35], 0
    ds_read_b64_tr_b16 v[222:223], v11 offset:55296
    v_exp_f32 v129, v129
    v_mfma_f32_16x16x32_bf16 v[112:115], v[164:167], v[36:39], v[112:115]
    v_cvt_pk_bf16_f32 v152, v128, v129
    v_exp_f32 v130, v130
    v_mfma_f32_16x16x32_bf16 v[116:119], v[168:171], v[32:35], 0
    v_exp_f32 v131, v131
    v_mfma_f32_16x16x32_bf16 v[116:119], v[172:175], v[36:39], v[116:119]
    v_cvt_pk_bf16_f32 v153, v130, v131
    v_exp_f32 v132, v132
    v_mfma_f32_16x16x32_bf16 v[120:123], v[176:179], v[32:35], 0
    v_exp_f32 v133, v133
    v_mfma_f32_16x16x32_bf16 v[120:123], v[180:183], v[36:39], v[120:123]
    v_cvt_pk_bf16_f32 v154, v132, v133
    v_exp_f32 v134, v134
    v_mfma_f32_16x16x32_bf16 v[124:127], v[184:187], v[32:35], 0
    v_exp_f32 v135, v135
    v_mfma_f32_16x16x32_bf16 v[124:127], v[188:191], v[36:39], v[124:127]
    s_waitcnt lgkmcnt(4)
    v_cvt_pk_bf16_f32 v155, v134, v135
    v_exp_f32 v136, v136
    v_mfma_f32_16x16x32_bf16 v[48:51], v[192:195], v[144:147], v[48:51]
    v_exp_f32 v137, v137
    v_mfma_f32_16x16x32_bf16 v[48:51], v[196:199], v[148:151], v[48:51]
    v_cvt_pk_bf16_f32 v156, v136, v137
    v_exp_f32 v138, v138
    v_mfma_f32_16x16x32_bf16 v[52:55], v[200:203], v[144:147], v[52:55]
    v_exp_f32 v139, v139
    v_mfma_f32_16x16x32_bf16 v[52:55], v[204:207], v[148:151], v[52:55]
    v_cvt_pk_bf16_f32 v157, v138, v139
    v_exp_f32 v140, v140
    v_mfma_f32_16x16x32_bf16 v[56:59], v[208:211], v[144:147], v[56:59]
    s_waitcnt lgkmcnt(0)
    v_exp_f32 v141, v141
    v_mfma_f32_16x16x32_bf16 v[56:59], v[212:215], v[148:151], v[56:59]
    v_cvt_pk_bf16_f32 v158, v140, v141
    v_exp_f32 v142, v142
    v_mfma_f32_16x16x32_bf16 v[60:63], v[216:219], v[144:147], v[60:63]
    v_exp_f32 v143, v143
    v_mfma_f32_16x16x32_bf16 v[60:63], v[220:223], v[148:151], v[60:63]
    v_cvt_pk_bf16_f32 v159, v142, v143
    v_exp_f32 v112, v112
    v_mfma_f32_16x16x32_bf16 v[128:131], v[160:163], v[40:43], 0
    v_exp_f32 v113, v113
    v_mfma_f32_16x16x32_bf16 v[128:131], v[164:167], v[44:47], v[128:131]
    ds_read_b128 v[160:163], v4 offset:57344
    v_cvt_pk_bf16_f32 v144, v112, v113
    v_exp_f32 v114, v114
    v_mfma_f32_16x16x32_bf16 v[132:135], v[168:171], v[40:43], 0
    ds_read_b128 v[164:167], v5 offset:57344
    v_exp_f32 v115, v115
    v_mfma_f32_16x16x32_bf16 v[132:135], v[172:175], v[44:47], v[132:135]
    ds_read_b128 v[168:171], v4 offset:59392
    v_cvt_pk_bf16_f32 v145, v114, v115
    v_exp_f32 v116, v116
    v_mfma_f32_16x16x32_bf16 v[136:139], v[176:179], v[40:43], 0
    ds_read_b128 v[172:175], v5 offset:59392
    v_exp_f32 v117, v117
    v_mfma_f32_16x16x32_bf16 v[136:139], v[180:183], v[44:47], v[136:139]
    ds_read_b128 v[176:179], v4 offset:61440
    v_cvt_pk_bf16_f32 v146, v116, v117
    v_exp_f32 v118, v118
    v_mfma_f32_16x16x32_bf16 v[140:143], v[184:187], v[40:43], 0
    ds_read_b128 v[180:183], v5 offset:61440
    v_exp_f32 v119, v119
    v_mfma_f32_16x16x32_bf16 v[140:143], v[188:191], v[44:47], v[140:143]
    ds_read_b128 v[184:187], v4 offset:63488
    v_cvt_pk_bf16_f32 v147, v118, v119
    v_exp_f32 v120, v120
    v_mfma_f32_16x16x32_bf16 v[64:67], v[192:195], v[152:155], v[64:67]
    ds_read_b128 v[188:191], v5 offset:63488
    v_exp_f32 v121, v121
    v_mfma_f32_16x16x32_bf16 v[64:67], v[196:199], v[156:159], v[64:67]
    v_cvt_pk_bf16_f32 v148, v120, v121
    v_exp_f32 v122, v122
    v_mfma_f32_16x16x32_bf16 v[68:71], v[200:203], v[152:155], v[68:71]
    v_exp_f32 v123, v123
    v_mfma_f32_16x16x32_bf16 v[68:71], v[204:207], v[156:159], v[68:71]
    v_cvt_pk_bf16_f32 v149, v122, v123
    v_exp_f32 v124, v124
    v_mfma_f32_16x16x32_bf16 v[72:75], v[208:211], v[152:155], v[72:75]
    v_exp_f32 v125, v125
    v_mfma_f32_16x16x32_bf16 v[72:75], v[212:215], v[156:159], v[72:75]
    v_cvt_pk_bf16_f32 v150, v124, v125
    v_exp_f32 v126, v126
    v_mfma_f32_16x16x32_bf16 v[76:79], v[216:219], v[152:155], v[76:79]
    v_exp_f32 v127, v127
    v_mfma_f32_16x16x32_bf16 v[76:79], v[220:223], v[156:159], v[76:79]
    v_cvt_pk_bf16_f32 v151, v126, v127
    v_exp_f32 v128, v128
    v_mfma_f32_16x16x32_bf16 v[80:83], v[192:195], v[144:147], v[80:83]
    v_exp_f32 v129, v129
    v_mfma_f32_16x16x32_bf16 v[80:83], v[196:199], v[148:151], v[80:83]
    v_cvt_pk_bf16_f32 v152, v128, v129
    v_exp_f32 v130, v130
    v_mfma_f32_16x16x32_bf16 v[84:87], v[200:203], v[144:147], v[84:87]
    v_exp_f32 v131, v131
    v_mfma_f32_16x16x32_bf16 v[84:87], v[204:207], v[148:151], v[84:87]
    v_cvt_pk_bf16_f32 v153, v130, v131
    v_exp_f32 v132, v132
    v_mfma_f32_16x16x32_bf16 v[88:91], v[208:211], v[144:147], v[88:91]
    v_exp_f32 v133, v133
    v_mfma_f32_16x16x32_bf16 v[88:91], v[212:215], v[148:151], v[88:91]
    v_cvt_pk_bf16_f32 v154, v132, v133
    v_exp_f32 v134, v134
    v_mfma_f32_16x16x32_bf16 v[92:95], v[216:219], v[144:147], v[92:95]
    v_exp_f32 v135, v135
    v_mfma_f32_16x16x32_bf16 v[92:95], v[220:223], v[148:151], v[92:95]
    s_waitcnt lgkmcnt(0)
    v_cvt_pk_bf16_f32 v155, v134, v135
    v_exp_f32 v136, v136
    v_mfma_f32_16x16x32_bf16 v[112:115], v[160:163], v[16:19], 0
    v_exp_f32 v137, v137
    v_mfma_f32_16x16x32_bf16 v[112:115], v[164:167], v[20:23], v[112:115]
    ds_read_b32 v14, v15 offset:0
    v_cvt_pk_bf16_f32 v156, v136, v137
    v_exp_f32 v138, v138
    v_mfma_f32_16x16x32_bf16 v[116:119], v[168:171], v[16:19], 0
    v_exp_f32 v139, v139
    v_mfma_f32_16x16x32_bf16 v[116:119], v[172:175], v[20:23], v[116:119]
    v_cvt_pk_bf16_f32 v157, v138, v139
    v_exp_f32 v140, v140
    v_mfma_f32_16x16x32_bf16 v[120:123], v[176:179], v[16:19], 0
    v_exp_f32 v141, v141
    v_mfma_f32_16x16x32_bf16 v[120:123], v[180:183], v[20:23], v[120:123]
    s_add_u32 s42, s42, 1
    v_cvt_pk_bf16_f32 v158, v140, v141
    v_exp_f32 v142, v142
    v_mfma_f32_16x16x32_bf16 v[124:127], v[184:187], v[16:19], 0
    s_cmp_ge_u32 s42, 5
    v_exp_f32 v143, v143
    v_mfma_f32_16x16x32_bf16 v[124:127], v[188:191], v[20:23], v[124:127]
    v_cvt_pk_bf16_f32 v159, v142, v143
    s_cbranch_scc1 F_FIN
    v_exp_f32 v112, v112
    v_mfma_f32_16x16x32_bf16 v[96:99], v[192:195], v[152:155], v[96:99]
    v_exp_f32 v113, v113
    v_mfma_f32_16x16x32_bf16 v[96:99], v[196:199], v[156:159], v[96:99]
    ds_read_b64_tr_b16 v[192:193], v8 offset:57344
    v_cvt_pk_bf16_f32 v144, v112, v113
    v_exp_f32 v114, v114
    v_mfma_f32_16x16x32_bf16 v[100:103], v[200:203], v[152:155], v[100:103]
    ds_read_b64_tr_b16 v[194:195], v8 offset:59392
    v_exp_f32 v115, v115
    v_mfma_f32_16x16x32_bf16 v[100:103], v[204:207], v[156:159], v[100:103]
    ds_read_b64_tr_b16 v[196:197], v8 offset:61440
    v_cvt_pk_bf16_f32 v145, v114, v115
    v_exp_f32 v116, v116
    v_mfma_f32_16x16x32_bf16 v[104:107], v[208:211], v[152:155], v[104:107]
    ds_read_b64_tr_b16 v[198:199], v8 offset:63488
    v_exp_f32 v117, v117
    v_mfma_f32_16x16x32_bf16 v[104:107], v[212:215], v[156:159], v[104:107]
    ds_read_b64_tr_b16 v[200:201], v9 offset:57344
    v_cvt_pk_bf16_f32 v146, v116, v117
    v_exp_f32 v118, v118
    v_mfma_f32_16x16x32_bf16 v[108:111], v[216:219], v[152:155], v[108:111]
    ds_read_b64_tr_b16 v[202:203], v9 offset:59392
    v_exp_f32 v119, v119
    v_mfma_f32_16x16x32_bf16 v[108:111], v[220:223], v[156:159], v[108:111]
    ds_read_b64_tr_b16 v[204:205], v9 offset:61440
    v_cvt_pk_bf16_f32 v147, v118, v119
    v_exp_f32 v120, v120
    v_mfma_f32_16x16x32_bf16 v[128:131], v[160:163], v[24:27], 0
    ds_read_b64_tr_b16 v[206:207], v9 offset:63488
    v_exp_f32 v121, v121
    v_mfma_f32_16x16x32_bf16 v[128:131], v[164:167], v[28:31], v[128:131]
    ds_read_b64_tr_b16 v[208:209], v10 offset:57344
    v_cvt_pk_bf16_f32 v148, v120, v121
    v_exp_f32 v122, v122
    v_mfma_f32_16x16x32_bf16 v[132:135], v[168:171], v[24:27], 0
    ds_read_b64_tr_b16 v[210:211], v10 offset:59392
    v_exp_f32 v123, v123
    v_mfma_f32_16x16x32_bf16 v[132:135], v[172:175], v[28:31], v[132:135]
    ds_read_b64_tr_b16 v[212:213], v10 offset:61440
    v_cvt_pk_bf16_f32 v149, v122, v123
    v_exp_f32 v124, v124
    v_mfma_f32_16x16x32_bf16 v[136:139], v[176:179], v[24:27], 0
    ds_read_b64_tr_b16 v[214:215], v10 offset:63488
    v_exp_f32 v125, v125
    v_mfma_f32_16x16x32_bf16 v[136:139], v[180:183], v[28:31], v[136:139]
    ds_read_b64_tr_b16 v[216:217], v11 offset:57344
    v_cvt_pk_bf16_f32 v150, v124, v125
    v_exp_f32 v126, v126
    v_mfma_f32_16x16x32_bf16 v[140:143], v[184:187], v[24:27], 0
    ds_read_b64_tr_b16 v[218:219], v11 offset:59392
    v_exp_f32 v127, v127
    v_mfma_f32_16x16x32_bf16 v[140:143], v[188:191], v[28:31], v[140:143]
    ds_read_b64_tr_b16 v[220:221], v11 offset:61440
    v_cvt_pk_bf16_f32 v151, v126, v127
    v_exp_f32 v128, v128
    v_mfma_f32_16x16x32_bf16 v[112:115], v[160:163], v[32:35], 0
    ds_read_b64_tr_b16 v[222:223], v11 offset:63488
    v_exp_f32 v129, v129
    v_mfma_f32_16x16x32_bf16 v[112:115], v[164:167], v[36:39], v[112:115]
    v_cvt_pk_bf16_f32 v152, v128, v129
    v_exp_f32 v130, v130
    v_mfma_f32_16x16x32_bf16 v[116:119], v[168:171], v[32:35], 0
    v_exp_f32 v131, v131
    v_mfma_f32_16x16x32_bf16 v[116:119], v[172:175], v[36:39], v[116:119]
    s_add_u32 s41, s41, 1
    v_cvt_pk_bf16_f32 v153, v130, v131
    v_exp_f32 v132, v132
    v_mfma_f32_16x16x32_bf16 v[120:123], v[176:179], v[32:35], 0
    v_exp_f32 v133, v133
    v_mfma_f32_16x16x32_bf16 v[120:123], v[180:183], v[36:39], v[120:123]
    v_cvt_pk_bf16_f32 v154, v132, v133
    v_exp_f32 v134, v134
    v_mfma_f32_16x16x32_bf16 v[124:127], v[184:187], v[32:35], 0
    v_exp_f32 v135, v135
    v_mfma_f32_16x16x32_bf16 v[124:127], v[188:191], v[36:39], v[124:127]
    s_waitcnt lgkmcnt(4)
    v_cvt_pk_bf16_f32 v155, v134, v135
    v_exp_f32 v136, v136
    v_mfma_f32_16x16x32_bf16 v[48:51], v[192:195], v[144:147], v[48:51]
    v_exp_f32 v137, v137
    v_mfma_f32_16x16x32_bf16 v[48:51], v[196:199], v[148:151], v[48:51]
    v_readfirstlane_b32 s40, v14
    v_cvt_pk_bf16_f32 v156, v136, v137
    v_exp_f32 v138, v138
    v_mfma_f32_16x16x32_bf16 v[52:55], v[200:203], v[144:147], v[52:55]
    v_add_u32 v12, 1, v12
    v_exp_f32 v139, v139
    v_mfma_f32_16x16x32_bf16 v[52:55], v[204:207], v[148:151], v[52:55]
    v_cvt_pk_bf16_f32 v157, v138, v139
    v_exp_f32 v140, v140
    v_mfma_f32_16x16x32_bf16 v[56:59], v[208:211], v[144:147], v[56:59]
    s_waitcnt lgkmcnt(0)
    v_exp_f32 v141, v141
    v_mfma_f32_16x16x32_bf16 v[56:59], v[212:215], v[148:151], v[56:59]
    ds_write_b32 v13, v12
    v_cvt_pk_bf16_f32 v158, v140, v141
    v_exp_f32 v142, v142
    v_mfma_f32_16x16x32_bf16 v[60:63], v[216:219], v[144:147], v[60:63]
    v_exp_f32 v143, v143
    v_mfma_f32_16x16x32_bf16 v[60:63], v[220:223], v[148:151], v[60:63]
    s_cmp_gt_u32 s40, s41
    v_cvt_pk_bf16_f32 v159, v142, v143
    v_exp_f32 v112, v112
    v_mfma_f32_16x16x32_bf16 v[128:131], v[160:163], v[40:43], 0
    s_cbranch_scc0 F_POLL7
F_BACK7:
    v_exp_f32 v113, v113
    v_mfma_f32_16x16x32_bf16 v[128:131], v[164:167], v[44:47], v[128:131]
    ds_read_b128 v[160:163], v4 offset:0
    v_cvt_pk_bf16_f32 v144, v112, v113
    v_exp_f32 v114, v114
    v_mfma_f32_16x16x32_bf16 v[132:135], v[168:171], v[40:43], 0
    ds_read_b128 v[164:167], v5 offset:0
    v_exp_f32 v115, v115
    v_mfma_f32_16x16x32_bf16 v[132:135], v[172:175], v[44:47], v[132:135]
    ds_read_b128 v[168:171], v4 offset:2048
    v_cvt_pk_bf16_f32 v145, v114, v115
    v_exp_f32 v116, v116
    v_mfma_f32_16x16x32_bf16 v[136:139], v[176:179], v[40:43], 0
    ds_read_b128 v[172:175], v5 offset:2048
    v_exp_f32 v117, v117
    v_mfma_f32_16x16x32_bf16 v[136:139], v[180:183], v[44:47], v[136:139]
    ds_read_b128 v[176:179], v4 offset:4096
    v_cvt_pk_bf16_f32 v146, v116, v117
    v_exp_f32 v118, v118
    v_mfma_f32_16x16x32_bf16 v[140:143], v[184:187], v[40:43], 0
    ds_read_b128 v[180:183], v5 offset:4096
    v_exp_f32 v119, v119
    v_mfma_f32_16x16x32_bf16 v[140:143], v[188:191], v[44:47], v[140:143]
    ds_read_b128 v[184:187], v4 offset:6144
    v_cvt_pk_bf16_f32 v147, v118, v119
    v_exp_f32 v120, v120
    v_mfma_f32_16x16x32_bf16 v[64:67], v[192:195], v[152:155], v[64:67]
    ds_read_b128 v[188:191], v5 offset:6144
    v_exp_f32 v121, v121
    v_mfma_f32_16x16x32_bf16 v[64:67], v[196:199], v[156:159], v[64:67]
    v_cvt_pk_bf16_f32 v148, v120, v121
    v_exp_f32 v122, v122
    v_mfma_f32_16x16x32_bf16 v[68:71], v[200:203], v[152:155], v[68:71]
    v_exp_f32 v123, v123
    v_mfma_f32_16x16x32_bf16 v[68:71], v[204:207], v[156:159], v[68:71]
    v_cvt_pk_bf16_f32 v149, v122, v123
    v_exp_f32 v124, v124
    v_mfma_f32_16x16x32_bf16 v[72:75], v[208:211], v[152:155], v[72:75]
    v_exp_f32 v125, v125
    v_mfma_f32_16x16x32_bf16 v[72:75], v[212:215], v[156:159], v[72:75]
    v_cvt_pk_bf16_f32 v150, v124, v125
    v_exp_f32 v126, v126
    v_mfma_f32_16x16x32_bf16 v[76:79], v[216:219], v[152:155], v[76:79]
    v_exp_f32 v127, v127
    v_mfma_f32_16x16x32_bf16 v[76:79], v[220:223], v[156:159], v[76:79]
    v_cvt_pk_bf16_f32 v151, v126, v127
    v_exp_f32 v128, v128
    v_mfma_f32_16x16x32_bf16 v[80:83], v[192:195], v[144:147], v[80:83]
    v_exp_f32 v129, v129
    v_mfma_f32_16x16x32_bf16 v[80:83], v[196:199], v[148:151], v[80:83]
    v_cvt_pk_bf16_f32 v152, v128, v129
    v_exp_f32 v130, v130
    v_mfma_f32_16x16x32_bf16 v[84:87], v[200:203], v[144:147], v[84:87]
    v_exp_f32 v131, v131
    v_mfma_f32_16x16x32_bf16 v[84:87], v[204:207], v[148:151], v[84:87]
    v_cvt_pk_bf16_f32 v153, v130, v131
    v_exp_f32 v132, v132
    v_mfma_f32_16x16x32_bf16 v[88:91], v[208:211], v[144:147], v[88:91]
    v_exp_f32 v133, v133
    v_mfma_f32_16x16x32_bf16 v[88:91], v[212:215], v[148:151], v[88:91]
    v_cvt_pk_bf16_f32 v154, v132, v133
    v_exp_f32 v134, v134
    v_mfma_f32_16x16x32_bf16 v[92:95], v[216:219], v[144:147], v[92:95]
    v_exp_f32 v135, v135
    v_mfma_f32_16x16x32_bf16 v[92:95], v[220:223], v[148:151], v[92:95]
    s_waitcnt lgkmcnt(0)
    v_cvt_pk_bf16_f32 v155, v134, v135
    v_exp_f32 v136, v136
    v_mfma_f32_16x16x32_bf16 v[112:115], v[160:163], v[16:19], 0
    v_exp_f32 v137, v137
    v_mfma_f32_16x16x32_bf16 v[112:115], v[164:167], v[20:23], v[112:115]
    v_cvt_pk_bf16_f32 v156, v136, v137
    v_exp_f32 v138, v138
    v_mfma_f32_16x16x32_bf16 v[116:119], v[168:171], v[16:19], 0
    v_exp_f32 v139, v139
    v_mfma_f32_16x16x32_bf16 v[116:119], v[172:175], v[20:23], v[116:119]
    v_cvt_pk_bf16_f32 v157, v138, v139
    v_exp_f32 v140, v140
    v_mfma_f32_16x16x32_bf16 v[120:123], v[176:179], v[16:19], 0
    v_exp_f32 v141, v141
    v_mfma_f32_16x16x32_bf16 v[120:123], v[180:183], v[20:23], v[120:123]
    v_cvt_pk_bf16_f32 v158, v140, v141
    v_exp_f32 v142, v142
    v_mfma_f32_16x16x32_bf16 v[124:127], v[184:187], v[16:19], 0
    v_exp_f32 v143, v143
    v_mfma_f32_16x16x32_bf16 v[124:127], v[188:191], v[20:23], v[124:127]
    v_cvt_pk_bf16_f32 v159, v142, v143
    s_branch F_LOOP
F_FIN:
    v_mfma_f32_16x16x32_bf16 v[128:131], v[160:163], v[24:27], 0
    v_mfma_f32_16x16x32_bf16 v[128:131], v[164:167], v[28:31], v[128:131]
    v_mfma_f32_16x16x32_bf16 v[132:135], v[160:163], v[32:35], 0
    v_mfma_f32_16x16x32_bf16 v[132:135], v[164:167], v[36:39], v[132:135]
    v_mfma_f32_16x16x32_bf16 v[136:139], v[160:163], v[40:43], 0
    v_mfma_f32_16x16x32_bf16 v[136:139], v[164:167], v[44:47], v[136:139]
    v_mfma_f32_16x16x32_bf16 v[96:99], v[192:195], v[152:155], v[96:99]
    v_exp_f32 v112, v112
    v_exp_f32 v113, v113
    v_mfma_f32_16x16x32_bf16 v[96:99], v[196:199], v[156:159], v[96:99]
    ds_read_b64_tr_b16 v[192:193], v8 offset:57344
    v_exp_f32 v114, v114
    v_exp_f32 v115, v115
    v_mfma_f32_16x16x32_bf16 v[100:103], v[200:203], v[152:155], v[100:103]
    v_exp_f32 v128, v128
    v_exp_f32 v129, v129
    v_mfma_f32_16x16x32_bf16 v[100:103], v[204:207], v[156:159], v[100:103]
    ds_read_b64_tr_b16 v[200:201], v9 offset:57344
    v_exp_f32 v130, v130
    v_exp_f32 v131, v131
    v_mfma_f32_16x16x32_bf16 v[104:107], v[208:211], v[152:155], v[104:107]
    v_exp_f32 v132, v132
    v_exp_f32 v133, v133
    v_mfma_f32_16x16x32_bf16 v[104:107], v[212:215], v[156:159], v[104:107]
    ds_read_b64_tr_b16 v[208:209], v10 offset:57344
    v_exp_f32 v134, v134
    v_exp_f32 v135, v135
    v_mfma_f32_16x16x32_bf16 v[108:111], v[216:219], v[152:155], v[108:111]
    v_exp_f32 v136, v136
    v_exp_f32 v137, v137
    v_mfma_f32_16x16x32_bf16 v[108:111], v[220:223], v[156:159], v[108:111]
    ds_read_b64_tr_b16 v[216:217], v11 offset:57344
    v_exp_f32 v138, v138
    v_exp_f32 v139, v139
    v_mov_b32 v146, 0
    v_mov_b32 v147, 0
    v_cvt_pk_bf16_f32 v144, v112, v113
    v_cvt_pk_bf16_f32 v145, v114, v115
    v_mov_b32 v150, 0
    v_mov_b32 v151, 0
    v_cvt_pk_bf16_f32 v148, v128, v129
    v_cvt_pk_bf16_f32 v149, v130, v131
    v_mov_b32 v154, 0
    v_mov_b32 v155, 0
    v_cvt_pk_bf16_f32 v152, v132, v133
    v_cvt_pk_bf16_f32 v153, v134, v135
    v_mov_b32 v158, 0
    v_mov_b32 v159, 0
    v_cvt_pk_bf16_f32 v156, v136, v137
    v_cvt_pk_bf16_f32 v157, v138, v139
    s_waitcnt lgkmcnt(0)
    v_mfma_f32_16x16x32_bf16 v[48:51], v[192:195], v[144:147], v[48:51]
    v_mfma_f32_16x16x32_bf16 v[52:55], v[200:203], v[144:147], v[52:55]
    v_mfma_f32_16x16x32_bf16 v[56:59], v[208:211], v[144:147], v[56:59]
    v_mfma_f32_16x16x32_bf16 v[60:63], v[216:219], v[144:147], v[60:63]
    v_mfma_f32_16x16x32_bf16 v[64:67], v[192:195], v[148:151], v[64:67]
    v_mfma_f32_16x16x32_bf16 v[68:71], v[200:203], v[148:151], v[68:71]
    v_mfma_f32_16x16x32_bf16 v[72:75], v[208:211], v[148:151], v[72:75]
    v_mfma_f32_16x16x32_bf16 v[76:79], v[216:219], v[148:151], v[76:79]
    v_mfma_f32_16x16x32_bf16 v[80:83], v[192:195], v[152:155], v[80:83]
    v_mfma_f32_16x16x32_bf16 v[84:87], v[200:203], v[152:155], v[84:87]
    v_mfma_f32_16x16x32_bf16 v[88:91], v[208:211], v[152:155], v[88:91]
    v_mfma_f32_16x16x32_bf16 v[92:95], v[216:219], v[152:155], v[92:95]
    v_mfma_f32_16x16x32_bf16 v[96:99], v[192:195], v[156:159], v[96:99]
    v_mfma_f32_16x16x32_bf16 v[100:103], v[200:203], v[156:159], v[100:103]
    v_mfma_f32_16x16x32_bf16 v[104:107], v[208:211], v[156:159], v[104:107]
    v_mfma_f32_16x16x32_bf16 v[108:111], v[216:219], v[156:159], v[108:111]
    s_mul_i32 s28, s45, 1605632
    s_add_u32 s28, s28, 11534336
    s_add_u32 s32, s26, s28
    s_addc_u32 s33, s27, 0
    s_mov_b32 s34, 1605632
    s_mul_i32 s28, s45, 50176
    s_add_u32 s28, s28, 20971520
    s_add_u32 s36, s26, s28
    s_addc_u32 s37, s27, 0
    s_mov_b32 s38, 50176
    v_lshlrev_b32 v3, 4, v0
    v_lshlrev_b32 v5, 2, v1
    v_mov_b32 v14, 1
    v_cvt_pk_bf16_f32 v112, v48, v49
    v_cvt_pk_bf16_f32 v113, v50, v51
    v_cvt_pk_bf16_f32 v114, v52, v53
    v_cvt_pk_bf16_f32 v115, v54, v55
    v_cvt_pk_bf16_f32 v116, v56, v57
    v_cvt_pk_bf16_f32 v117, v58, v59
    v_cvt_pk_bf16_f32 v118, v60, v61
    v_cvt_pk_bf16_f32 v119, v62, v63
    buffer_store_dwordx4 v[112:115], v3, s[32:35], s70 offen offset:0 sc1
    buffer_store_dwordx4 v[116:119], v3, s[32:35], s70 offen offset:1024 sc1
    s_lshr_b32 s70, s70, 5
    v_cvt_pk_bf16_f32 v120, v64, v65
    v_cvt_pk_bf16_f32 v121, v66, v67
    v_cvt_pk_bf16_f32 v122, v68, v69
    v_cvt_pk_bf16_f32 v123, v70, v71
    v_cvt_pk_bf16_f32 v124, v72, v73
    v_cvt_pk_bf16_f32 v125, v74, v75
    v_cvt_pk_bf16_f32 v126, v76, v77
    v_cvt_pk_bf16_f32 v127, v78, v79
    buffer_store_dwordx4 v[120:123], v3, s[32:35], s71 offen offset:0 sc1
    buffer_store_dwordx4 v[124:127], v3, s[32:35], s71 offen offset:1024 sc1
    s_lshr_b32 s71, s71, 5
    v_cvt_pk_bf16_f32 v128, v80, v81
    v_cvt_pk_bf16_f32 v129, v82, v83
    v_cvt_pk_bf16_f32 v130, v84, v85
    v_cvt_pk_bf16_f32 v131, v86, v87
    v_cvt_pk_bf16_f32 v132, v88, v89
    v_cvt_pk_bf16_f32 v133, v90, v91
    v_cvt_pk_bf16_f32 v134, v92, v93
    v_cvt_pk_bf16_f32 v135, v94, v95
    buffer_store_dwordx4 v[128:131], v3, s[32:35], s72 offen offset:0 sc1
    buffer_store_dwordx4 v[132:135], v3, s[32:35], s72 offen offset:1024 sc1
    s_lshr_b32 s72, s72, 5
    v_cvt_pk_bf16_f32 v136, v96, v97
    v_cvt_pk_bf16_f32 v137, v98, v99
    v_cvt_pk_bf16_f32 v138, v100, v101
    v_cvt_pk_bf16_f32 v139, v102, v103
    v_cvt_pk_bf16_f32 v140, v104, v105
    v_cvt_pk_bf16_f32 v141, v106, v107
    v_cvt_pk_bf16_f32 v142, v108, v109
    v_cvt_pk_bf16_f32 v143, v110, v111
    buffer_store_dwordx4 v[136:139], v3, s[32:35], s73 offen offset:0 sc1
    buffer_store_dwordx4 v[140:143], v3, s[32:35], s73 offen offset:1024 sc1
    s_lshr_b32 s73, s73, 5
    s_mov_b32 exec_lo, 0
    s_mov_b32 exec_hi, 0xffff0000
    buffer_store_dword v63, v5, s[36:39], s70 offen sc1
    buffer_store_dword v79, v5, s[36:39], s71 offen sc1
    buffer_store_dword v95, v5, s[36:39], s72 offen sc1
    buffer_store_dword v111, v5, s[36:39], s73 offen sc1
    s_mov_b64 exec, -1
    s_waitcnt vmcnt(0)
    s_mov_b64 exec, 1
    ds_add_rtn_u32 v4, v15, v14 offset:24
    s_waitcnt lgkmcnt(0)
    v_readfirstlane_b32 s29, v4
    s_mov_b64 exec, -1
    s_nop 3
    s_cmp_lg_u32 s29, 3
    s_cbranch_scc1 F_PD
    s_memrealtime s[82:83]
    v_lshl_add_u32 v6, v0, 3, s57
    s_waitcnt lgkmcnt(0)
    v_mov_b32 v4, s82
    v_mov_b32 v5, s83
    s_mov_b64 exec, 0xff
    global_store_dwordx2 v6, v[4:5], s[26:27] sc1
    s_mov_b64 exec, -1
F_PD:
    s_endpgm
F_QST:
    buffer_store_dwordx4 v[16:19], v3, s[60:63], s70 offen sc1
    buffer_store_dwordx4 v[20:23], v3, s[60:63], s70 offen offset:16 sc1
    s_lshr_b32 s28, s45, 2
    s_cmp_lg_u32 s28, s3
    s_cbranch_scc1 F_QSB
    s_not_b64 s[28:29], s[90:91]
    v_mov_b32 v240, s28
    v_mov_b32 v241, s29
    v_mov_b32 v242, 0
    s_mov_b64 exec, 1
    global_atomic_umax_x2 v242, v[240:241], s[24:25] sc1
    s_mov_b64 exec, -1
    s_nop 3
    s_branch F_QSB
F_POLL1:
    s_add_u32 s30, s41, 1
    s_mov_b32 s50, 262144
W_97:
    ds_read_b32 v14, v15 offset:0
    s_waitcnt lgkmcnt(0)
    v_readfirstlane_b32 s40, v14
    s_nop 3
    s_cmp_ge_u32 s40, s30
    s_cbranch_scc1 W_98
    s_sleep 1
    s_sub_u32 s50, s50, 1
    s_cmp_lg_u32 s50, 0
    s_cbranch_scc1 W_97
W_98:
    s_branch F_BACK1
F_POLL3:
    s_add_u32 s30, s41, 1
    s_mov_b32 s50, 262144
W_99:
    ds_read_b32 v14, v15 offset:0
    s_waitcnt lgkmcnt(0)
    v_readfirstlane_b32 s40, v14
    s_nop 3
    s_cmp_ge_u32 s40, s30
    s_cbranch_scc1 W_100
    s_sleep 1
    s_sub_u32 s50, s50, 1
    s_cmp_lg_u32 s50, 0
    s_cbranch_scc1 W_99
W_100:
    s_branch F_BACK3
F_POLL5:
    s_add_u32 s30, s41, 1
    s_mov_b32 s50, 262144
W_101:
    ds_read_b32 v14, v15 offset:0
    s_waitcnt lgkmcnt(0)
    v_readfirstlane_b32 s40, v14
    s_nop 3
    s_cmp_ge_u32 s40, s30
    s_cbranch_scc1 W_102
    s_sleep 1
    s_sub_u32 s50, s50, 1
    s_cmp_lg_u32 s50, 0
    s_cbranch_scc1 W_101
W_102:
    s_branch F_BACK5
F_POLL7:
    s_add_u32 s30, s41, 1
    s_mov_b32 s50, 262144
W_103:
    ds_read_b32 v14, v15 offset:0
    s_waitcnt lgkmcnt(0)
    v_readfirstlane_b32 s40, v14
    s_nop 3
    s_cmp_ge_u32 s40, s30
    s_cbranch_scc1 W_104
    s_sleep 1
    s_sub_u32 s50, s50, 1
    s_cmp_lg_u32 s50, 0
    s_cbranch_scc1 W_103
W_104:
    s_branch F_BACK7
F_CODE_END:
.section .rodata,"a"
.p2align 6
.amdhsa_kernel standalone__hybrid_graph_tf_graphgps__graph_kernel
  .amdhsa_next_free_vgpr 248
  .amdhsa_next_free_sgpr 102
  .amdhsa_accum_offset 248
  .amdhsa_group_segment_fixed_size 0
  .amdhsa_kernarg_size 96
  .amdhsa_user_sgpr_count 2
  .amdhsa_user_sgpr_kernarg_segment_ptr 1
  .amdhsa_system_sgpr_workgroup_id_x 1
.end_amdhsa_kernel
```
